```python
import torch

def _softmax(x, axis=-1):
    return torch.softmax(x, dim=axis)
def _gelu(x):
    return torch.nn.functional.gelu(x, approximate="tanh")
def _silu(x):
    return torch.nn.functional.silu(x)
def _sigmoid(x):
    return torch.sigmoid(x)
def _layernorm(x, axis=-1, eps=1e-5):
    m = x.mean(dim=axis, keepdim=True)
    v = x.var(dim=axis, keepdim=True, unbiased=False)
    return (x - m) / torch.sqrt(v + eps)
def _scatter_add(tgt, idx, src, axis=0):
    return tgt.clone().index_add_(axis, idx, src)
def _segment_sum(src, seg, n):
    out = torch.zeros((n,) + src.shape[1:], dtype=src.dtype)
    return out.index_add_(0, seg, src)
def _pad(x, pw):
    flat = tuple(v for pair in reversed(pw) for v in pair)
    return torch.nn.functional.pad(x, flat)

kernel_name = 'gated_mix__grouped_kv_mqa__spectral_gfnet__prompt'

def setup_inputs():

    _w = (lambda a: (lambda t: t.to(torch.bfloat16) if t.is_floating_point() else t)(torch.as_tensor(a)))
    def _A_setup():
        B, S, D, H = 1, 2048, 512, 32
        Dh = D // H
        return {
            "x": _w((lambda *s: torch.randn(*s, dtype=torch.bfloat16) * 0.05)(B, S, D)),
            "wq": _w((lambda *s: torch.randn(*s, dtype=torch.bfloat16) * 0.8)(D, H * Dh)),
            "wk": _w((lambda *s: torch.randn(*s, dtype=torch.bfloat16) * 0.8)(D, Dh)),
            "wv": _w((lambda *s: torch.randn(*s, dtype=torch.bfloat16) * 0.05)(D, Dh)),
            "wo": _w((lambda *s: torch.randn(*s, dtype=torch.bfloat16) * 0.05)(H * Dh, D)),
        }
    _A_in = _A_setup()

    def _B_setup():
        B, S, D = 1, 2048, 512
        Df = D // 2 + 1
        return {
            "x": _w((lambda *s: torch.randn(*s, dtype=torch.bfloat16) * 0.05)(B, S, D)),
            "w_r": _w((lambda *s: torch.randn(*s, dtype=torch.bfloat16) * 0.4)(S, Df) * 0.02),
            "w_i": _w((lambda *s: torch.randn(*s, dtype=torch.bfloat16) * 0.8)(S, Df) * 0.02),
        }
    _B_in = _B_setup()

    return {
        "A_x": _A_in["x"],
        "A_wq": _A_in["wq"],
        "A_wk": _A_in["wk"],
        "A_wv": _A_in["wv"],
        "A_wo": _A_in["wo"],
        "B_x": _B_in["x"],
        "B_w_r": _B_in["w_r"],
        "B_w_i": _B_in["w_i"],
        "gate_w": _w((lambda *s: torch.randn(*s, dtype=torch.bfloat16) * 0.05)(512) * 16.0),
    }

def reference(A_x, A_wq, A_wk, A_wv, A_wo, B_x, B_w_r, B_w_i, gate_w):
    def _A_ref(x, wq, wk, wv, wo):
        B, S, D = x.shape
        H = 32
        Dh = D // H
        q = (lambda x, *d: x.permute(*d))((x @ wq).reshape(B, S, H, Dh), 0, 2, 1, 3)
        k = x @ wk
        v = x @ wv
        scores = torch.einsum("bhqd,bkd->bhqk", q, k) * (Dh ** -0.5)
        p = _softmax(scores, axis=-1)
        o = torch.einsum("bhqk,bkd->bhqd", p, v)
        return (lambda x, *d: x.permute(*d))(o, 0, 2, 1, 3).reshape(B, S, H * Dh) @ wo

    def _B_ref(x, w_r, w_i):
        B, S, D = x.shape
        X = (lambda x, axes=(-2,-1): torch.fft.rfft2(x.float(), dim=axes))(x, axes=(-2, -1))
        W = w_r + 1j * w_i
        X = X * W
        y = (lambda x, s, axes=(-2,-1): torch.fft.irfft2(x, s=s, dim=axes).to(torch.bfloat16))(X, (S, D), axes=(-2, -1))
        return y

    x = A_x
    g = _sigmoid((x * gate_w).sum(-1, keepdims=True))
    a = _A_ref(x, A_wq, A_wk, A_wv, A_wo)
    b = _B_ref(x, B_w_r, B_w_i)
    return g * a + (1 - g) * b
```

```asm
; @launch grid=(256,1,1) block=(512,1,1) lds=163840
.amdgcn_target "amdgcn-amd-amdhsa--gfx950"
.text
.globl gated_mix__grouped_kv_mqa__spectral_gfnet__prompt_kernel
.p2align 8
.type gated_mix__grouped_kv_mqa__spectral_gfnet__prompt_kernel,@function
gated_mix__grouped_kv_mqa__spectral_gfnet__prompt_kernel:
  s_cmp_ge_u32 s2, 256
  s_cbranch_scc1 KG_END
  s_load_dwordx8 s[4:11], s[0:1], 0
  s_load_dwordx2 s[14:15], s[0:1], 88
  s_load_dwordx4 s[20:23], s[0:1], 64
  s_load_dwordx2 s[12:13], s[0:1], 32
  s_load_dwordx4 s[16:19], s[0:1], 48
  v_lshrrev_b32 v1, 6, v0
  v_and_b32 v0, 63, v0
  s_and_b32 s51, s2, 7
  v_readfirstlane_b32 s48, v1
  s_lshl_b32 s51, s51, 2
  s_lshr_b32 s49, s2, 6
  s_add_u32 s49, s49, s51
  s_bfe_u32 s50, s2, 0x30003
  s_mov_b32 s72, 2097152
  s_lshr_b32 s67, s2, 6
  s_lshl_b32 s67, s67, 8
  v_mov_b32 v7, 131072
  v_and_b32 v1, 15, v0
  v_lshrrev_b32 v2, 4, v0
  v_lshlrev_b32 v3, 4, v0
  s_mov_b32 s68, s48
  s_cmp_lg_u32 s48, 0
  s_cbranch_scc1 KG_N0
  s_setprio 2
  v_lshl_add_u32 v9, v0, 2, v7
  v_mov_b32 v10, 0
  ds_write_b32 v9, v10
  s_lshr_b32 s58, s50, 1
  s_and_b32 s59, s50, 1
  v_lshrrev_b32 v8, 3, v0
  v_and_b32 v9, 7, v0
  v_lshrrev_b32 v10, 2, v8
  v_and_b32 v11, 3, v8
  v_lshl_add_u32 v10, v10, 4, v11
  v_lshlrev_b32 v10, 15, v10
  s_lshl_b32 s51, s49, 10
  v_add_u32 v10, s51, v10
  v_xor_b32 v11, v2, v9
  v_lshl_add_u32 v12, v11, 4, v10
  v_xor_b32 v11, 4, v11
  v_lshl_add_u32 v13, v11, 4, v10
  v_add_u32 v13, 130048, v13
  s_lshr_b32 s53, s58, 1
  s_lshl_b32 s53, s53, 20
  s_and_b32 s54, s58, 1
  s_lshl_b32 s54, s54, 18
  s_add_u32 s53, s53, s54
  s_add_u32 s53, s53, s67
  s_lshl_b32 s54, s58, 11
  s_mov_b32 s34, 16384
  s_mov_b32 s35, 0x20000
  s_mov_b32 s26, 2097152
  s_mov_b32 s27, 0x20000
  s_mov_b32 m0, s54
  s_cmp_eq_u32 s59, 1
  s_waitcnt lgkmcnt(0)
  s_cselect_b64 s[32:33], s[10:11], s[8:9]
  s_mov_b64 s[24:25], s[4:5]
  buffer_load_dwordx4 v12, s[24:27], s53 offen lds
  buffer_load_dwordx4 v13, s[24:27], s53 offen offset:1024 lds
  s_add_u32 m0, s54, 8192
  s_add_u32 s53, s53, 128
  s_bitset0_b32 s53, 10
  buffer_load_dwordx4 v12, s[24:27], s53 offen lds
  buffer_load_dwordx4 v13, s[24:27], s53 offen offset:1024 lds
  s_add_u32 m0, s54, 16384
  s_add_u32 s53, s53, 128
  s_bitset0_b32 s53, 10
  buffer_load_dwordx4 v12, s[24:27], s53 offen lds
  buffer_load_dwordx4 v13, s[24:27], s53 offen offset:1024 lds
  s_add_u32 m0, s54, 24576
  s_add_u32 s53, s53, 128
  s_bitset0_b32 s53, 10
  buffer_load_dwordx4 v12, s[24:27], s53 offen lds
  buffer_load_dwordx4 v13, s[24:27], s53 offen offset:1024 lds
  s_add_u32 m0, s54, 32768
  s_add_u32 s53, s53, 128
  s_bitset0_b32 s53, 10
  buffer_load_dwordx4 v12, s[24:27], s53 offen lds
  buffer_load_dwordx4 v13, s[24:27], s53 offen offset:1024 lds
  s_add_u32 m0, s54, 40960
  s_add_u32 s53, s53, 128
  s_bitset0_b32 s53, 10
  buffer_load_dwordx4 v12, s[24:27], s53 offen lds
  buffer_load_dwordx4 v13, s[24:27], s53 offen offset:1024 lds
  s_add_u32 m0, s54, 49152
  s_add_u32 s53, s53, 128
  s_bitset0_b32 s53, 10
  buffer_load_dwordx4 v12, s[24:27], s53 offen lds
  buffer_load_dwordx4 v13, s[24:27], s53 offen offset:1024 lds
  s_add_u32 m0, s54, 57344
  s_add_u32 s53, s53, 128
  s_bitset0_b32 s53, 10
  buffer_load_dwordx4 v12, s[24:27], s53 offen lds
  buffer_load_dwordx4 v13, s[24:27], s53 offen offset:1024 lds
  s_mov_b32 m0, 131328
  s_lshl_b32 s51, s67, 4
  buffer_load_dwordx4 v3, s[32:35], s51 offen offset:0 lds
  buffer_load_dwordx4 v3, s[32:35], s51 offen offset:1024 lds
  buffer_load_dwordx4 v3, s[32:35], s51 offen offset:2048 lds
  buffer_load_dwordx4 v3, s[32:35], s51 offen offset:3072 lds
  s_mov_b32 m0, 135424
  s_add_u32 s51, s51, 4096
  s_bitset0_b32 s51, 14
  buffer_load_dwordx4 v3, s[32:35], s51 offen offset:0 lds
  buffer_load_dwordx4 v3, s[32:35], s51 offen offset:1024 lds
  buffer_load_dwordx4 v3, s[32:35], s51 offen offset:2048 lds
  buffer_load_dwordx4 v3, s[32:35], s51 offen offset:3072 lds
  s_mov_b32 m0, 139520
  s_add_u32 s51, s51, 4096
  s_bitset0_b32 s51, 14
  buffer_load_dwordx4 v3, s[32:35], s51 offen offset:0 lds
  buffer_load_dwordx4 v3, s[32:35], s51 offen offset:1024 lds
  buffer_load_dwordx4 v3, s[32:35], s51 offen offset:2048 lds
  buffer_load_dwordx4 v3, s[32:35], s51 offen offset:3072 lds
  s_mov_b32 m0, 143616
  s_add_u32 s51, s51, 4096
  s_bitset0_b32 s51, 14
  buffer_load_dwordx4 v3, s[32:35], s51 offen offset:0 lds
  buffer_load_dwordx4 v3, s[32:35], s51 offen offset:1024 lds
  buffer_load_dwordx4 v3, s[32:35], s51 offen offset:2048 lds
  buffer_load_dwordx4 v3, s[32:35], s51 offen offset:3072 lds
  s_mov_b32 s36, s20
  s_mov_b32 s37, s21
  s_mov_b32 s38, 1024
  s_mov_b32 s39, 0x20000
  s_mov_b32 m0, 147712
  s_lshr_b32 s53, s2, 3
  v_add_u32 v14, s67, v3
  v_and_b32 v14, 0x3ff, v14
  buffer_load_dwordx4 v14, s[36:39], 0 offen lds
  s_barrier
  s_branch KG_KV
KG_N0:
  s_cmp_lt_u32 s48, 4
  s_cbranch_scc1 KG_N1
  s_getpc_b64 s[32:33]
KG_PC:
  s_mov_b32 s34, KG_END-KG_PC
  s_mov_b32 s35, 0x20000
  s_lshr_b32 s51, s2, 3
  s_lshl_b32 s51, s51, 2
  s_add_u32 s51, s51, s48
  s_mul_i32 s51, s51, 1024
  s_and_b32 s51, s51, 0xffff
  v_lshlrev_b32 v212, 7, v0
  s_mov_b64 exec, 0xff
  buffer_load_dword v213, v212, s[32:35], s51 offen
  s_mov_b64 exec, -1
  s_barrier
  s_branch KG_ATT
KG_N1:
  s_setprio 2
  s_cmp_lg_u32 s48, 1
  s_cbranch_scc1 KG_N2
  s_mov_b32 s54, 2359296
  v_mov_b32 v10, 0
  s_waitcnt lgkmcnt(0)
  s_mov_b32 s28, s14
  s_mov_b32 s29, s15
  s_mov_b32 s30, 11599872
  s_mov_b32 s31, 0x20000
  buffer_load_dword v11, v10, s[28:31], s54 offen sc1
  s_barrier
  s_branch KG_TAG
KG_N2:
  v_and_b32 v12, 31, v0
  v_lshrrev_b32 v13, 5, v0
  v_bfe_u32 v14, v0, 1, 3
  v_lshlrev_b32 v15, 7, v12
  v_add_u32 v8, 0, v13
  v_xor_b32 v8, v8, v14
  v_lshl_add_u32 v248, v8, 4, v15
  v_add_u32 v8, 2, v13
  v_xor_b32 v8, v8, v14
  v_lshl_add_u32 v249, v8, 4, v15
  v_add_u32 v8, 4, v13
  v_xor_b32 v8, v8, v14
  v_lshl_add_u32 v250, v8, 4, v15
  v_add_u32 v8, 6, v13
  v_xor_b32 v8, v8, v14
  v_lshl_add_u32 v251, v8, 4, v15
  v_and_b32 v8, 1, v2
  v_mul_u32_u24 v8, 0x5555, v8
  v_or_b32 v252, 0x8888, v8
  s_and_b32 s51, s68, 1
  s_mul_i32 s51, s51, 5120
  s_add_u32 s51, s51, 152832
  v_bfe_u32 v8, v0, 2, 1
  v_lshrrev_b32 v9, 3, v12
  v_and_b32 v10, 3, v0
  v_lshl_add_u32 v8, v8, 4, v10
  v_lshl_add_u32 v8, v9, 2, v8
  v_mul_u32_u24 v8, 80, v8
  v_lshl_add_u32 v8, v13, 4, v8
  v_add_u32 v253, s51, v8
  v_bfe_u32 v8, v0, 2, 2
  v_lshl_add_u32 v8, v2, 3, v8
  v_mul_u32_u24 v8, 80, v8
  v_lshl_add_u32 v8, v10, 3, v8
  v_add_u32 v254, s51, v8
  v_lshlrev_b32 v8, 12, v1
  v_lshl_add_u32 v255, v2, 4, v8
  v_mov_b32 v216, 0
  v_mov_b32 v217, 0
  v_mov_b32 v218, 0
  v_mov_b32 v219, 0
  v_mov_b32 v220, 0
  v_mov_b32 v221, 0
  v_mov_b32 v222, 0
  v_mov_b32 v223, 0
  v_mov_b32 v224, 0
  v_mov_b32 v225, 0
  v_mov_b32 v226, 0
  v_mov_b32 v227, 0
  v_mov_b32 v228, 0
  v_mov_b32 v229, 0
  v_mov_b32 v230, 0
  v_mov_b32 v231, 0
  v_mov_b32 v232, 0
  v_mov_b32 v233, 0
  v_mov_b32 v234, 0
  v_mov_b32 v235, 0
  v_mov_b32 v236, 0
  v_mov_b32 v237, 0
  v_mov_b32 v238, 0
  v_mov_b32 v239, 0
  v_mov_b32 v240, 0
  v_mov_b32 v241, 0
  v_mov_b32 v242, 0
  v_mov_b32 v243, 0
  v_mov_b32 v244, 0
  v_mov_b32 v245, 0
  v_mov_b32 v246, 0
  v_mov_b32 v247, 0
  s_mov_b32 s70, -3
  s_mov_b32 s35, 0x20000
  s_cmp_eq_u32 s68, 3
  s_cbranch_scc1 KG_LDW
  v_lshrrev_b32 v8, 3, v0
  v_and_b32 v9, 7, v0
  v_lshrrev_b32 v10, 2, v8
  v_and_b32 v11, 3, v8
  v_lshl_add_u32 v10, v10, 4, v11
  v_lshlrev_b32 v10, 15, v10
  s_lshl_b32 s51, s49, 10
  v_add_u32 v10, s51, v10
  v_xor_b32 v11, v2, v9
  v_lshl_add_u32 v12, v11, 4, v10
  v_xor_b32 v11, 4, v11
  v_lshl_add_u32 v13, v11, 4, v10
  v_add_u32 v13, 130048, v13
  s_lshr_b32 s52, s50, 1
  s_add_u32 s52, s52, 1
  s_and_b32 s52, s52, 3
  s_lshr_b32 s58, s52, 1
  s_lshl_b32 s58, s58, 20
  s_and_b32 s62, s52, 1
  s_lshl_b32 s62, s62, 18
  s_add_u32 s58, s58, s62
  s_add_u32 s58, s58, s67
  s_lshl_b32 s62, s52, 11
  s_add_u32 s52, s52, 1
  s_and_b32 s52, s52, 3
  s_lshr_b32 s59, s52, 1
  s_lshl_b32 s59, s59, 20
  s_and_b32 s63, s52, 1
  s_lshl_b32 s63, s63, 18
  s_add_u32 s59, s59, s63
  s_add_u32 s59, s59, s67
  s_lshl_b32 s63, s52, 11
  s_add_u32 s52, s52, 1
  s_and_b32 s52, s52, 3
  s_lshr_b32 s60, s52, 1
  s_lshl_b32 s60, s60, 20
  s_and_b32 s64, s52, 1
  s_lshl_b32 s64, s64, 18
  s_add_u32 s60, s60, s64
  s_add_u32 s60, s60, s67
  s_lshl_b32 s64, s52, 11
  s_mov_b32 s34, 2097152
  s_mov_b32 s53, 0
  s_waitcnt lgkmcnt(0)
  s_mov_b64 s[32:33], s[4:5]
  s_barrier
KG_LLX:
  s_add_i32 s70, s70, 1
  s_mov_b32 m0, s62
  s_add_u32 s62, s62, 8192
  buffer_load_dwordx4 v12, s[32:35], s58 offen lds
  buffer_load_dwordx4 v13, s[32:35], s58 offen offset:1024 lds
  s_add_u32 s58, s58, 128
  s_bitset0_b32 s58, 10
  s_mov_b32 m0, s63
  s_add_u32 s63, s63, 8192
  buffer_load_dwordx4 v12, s[32:35], s59 offen lds
  buffer_load_dwordx4 v13, s[32:35], s59 offen offset:1024 lds
  s_add_u32 s59, s59, 128
  s_bitset0_b32 s59, 10
  s_mov_b32 m0, s64
  s_add_u32 s64, s64, 8192
  buffer_load_dwordx4 v12, s[32:35], s60 offen lds
  buffer_load_dwordx4 v13, s[32:35], s60 offen offset:1024 lds
  s_add_u32 s60, s60, 128
  s_bitset0_b32 s60, 10
  v_mov_b32 v14, s70
  s_cmp_le_i32 s70, 0
  s_cbranch_scc1 KG_LLX
  s_waitcnt vmcnt(18)
  ds_write_b32 v7, v14 offset:0
  s_cmp_lt_i32 s70, 5
  s_cbranch_scc1 KG_LLX
  v_mov_b32 v14, 6
  s_waitcnt vmcnt(12)
  ds_write_b32 v7, v14 offset:0
  v_mov_b32 v14, 7
  s_waitcnt vmcnt(6)
  ds_write_b32 v7, v14 offset:0
  v_mov_b32 v14, 8
  s_waitcnt vmcnt(0)
  ds_write_b32 v7, v14 offset:0
  s_branch KG_H2B
KG_LDW:
  s_mov_b32 s70, -2
  v_lshrrev_b32 v8, 3, v0
  v_and_b32 v9, 7, v0
  v_and_b32 v10, 1, v2
  v_lshlrev_b32 v10, 2, v10
  v_xor_b32 v10, v10, v9
  v_lshlrev_b32 v10, 4, v10
  v_lshl_add_u32 v10, v8, 10, v10
  s_lshl_b32 s51, s50, 7
  v_add_u32 v10, s51, v10
  v_add_u32 v11, 7168, v10
  v_add_u32 v12, 14336, v10
  v_add_u32 v13, 21504, v10
  s_lshl_b32 s58, s67, 9
  s_mov_b32 s62, 65536
  s_mov_b32 s34, 524288
  s_waitcnt lgkmcnt(0)
  s_mov_b64 s[32:33], s[6:7]
  s_barrier
KG_LLW:
  s_add_i32 s70, s70, 1
  s_mov_b32 m0, s62
  s_add_u32 s62, s62, 4096
  buffer_load_dwordx4 v10, s[32:35], s58 offen offset:0 lds
  buffer_load_dwordx4 v11, s[32:35], s58 offen offset:1024 lds
  buffer_load_dwordx4 v12, s[32:35], s58 offen offset:2048 lds
  buffer_load_dwordx4 v13, s[32:35], s58 offen offset:3072 lds
  s_add_u32 s58, s58, 32768
  s_waitcnt vmcnt(16)
  s_mov_b32 m0, s62
  s_add_u32 s62, s62, 4096
  buffer_load_dwordx4 v10, s[32:35], s58 offen offset:0 lds
  buffer_load_dwordx4 v11, s[32:35], s58 offen offset:1024 lds
  buffer_load_dwordx4 v12, s[32:35], s58 offen offset:2048 lds
  buffer_load_dwordx4 v13, s[32:35], s58 offen offset:3072 lds
  s_add_u32 s58, s58, 32768
  s_bitset0_b32 s58, 19
  v_mov_b32 v14, s70
  s_cmp_le_i32 s70, 0
  s_cbranch_scc1 KG_LLW
  s_waitcnt vmcnt(16)
  ds_write_b32 v7, v14 offset:4
  s_cmp_lt_i32 s70, 6
  s_cbranch_scc1 KG_LLW
  v_mov_b32 v14, 7
  s_waitcnt vmcnt(8)
  ds_write_b32 v7, v14 offset:4
  v_mov_b32 v14, 8
  s_waitcnt vmcnt(0)
  ds_write_b32 v7, v14 offset:4
  s_branch KG_H2B
KG_ATT:
  s_setprio 1
  s_and_b32 s3, s48, 1
  s_bfe_u32 s66, s48, 0x10001
  s_mov_b32 s59, 0
  v_and_b32 v1, 31, v0
  v_lshrrev_b32 v6, 5, v0
  v_bfe_u32 v200, v0, 1, 3
  s_lshl_b32 s51, s66, 12
  v_lshlrev_b32 v201, 7, v1
  v_add_u32 v201, s51, v201
  v_add_u32 v202, 0, v6
  v_xor_b32 v202, v202, v200
  v_lshl_add_u32 v192, v202, 4, v201
  v_add_u32 v202, 2, v6
  v_xor_b32 v202, v202, v200
  v_lshl_add_u32 v193, v202, 4, v201
  v_add_u32 v202, 4, v6
  v_xor_b32 v202, v202, v200
  v_lshl_add_u32 v194, v202, 4, v201
  v_add_u32 v202, 6, v6
  v_xor_b32 v202, v202, v200
  v_lshl_add_u32 v195, v202, 4, v201
  v_bfe_u32 v200, v0, 2, 2
  v_and_b32 v201, 3, v0
  v_bfe_u32 v202, v0, 4, 1
  v_lshl_add_u32 v203, v6, 3, v200
  v_lshlrev_b32 v203, 7, v203
  v_lshrrev_b32 v204, 1, v201
  v_and_b32 v205, 1, v201
  v_lshrrev_b32 v206, 1, v200
  v_lshlrev_b32 v206, 2, v206
  v_lshl_add_u32 v207, v202, 1, v204
  s_lshl_b32 s51, s3, 2
  v_add_u32 v207, s51, v207
  v_xor_b32 v207, v207, v206
  v_lshl_add_u32 v207, v207, 4, v203
  v_lshl_add_u32 v196, v205, 3, v207
  v_add_u32 v196, 65536, v196
  v_lshlrev_b32 v2, 4, v0
  v_add_u32 v210, 131328, v2
  s_lshl_b32 s51, s48, 2
  v_add_u32 v208, s51, v7
  v_mov_b32 v209, 1
  v_add_u32 v216, 65536, v2
  v_mov_b32 v217, 3
  v_mov_b32 v219, 6
  v_mov_b32 v220, 10
  s_mov_b32 s60, 0xffff
  s_mov_b32 s61, 0xffff
  v_and_b32 v200, 27, v1
  v_cmp_eq_u32 vcc, 16, v200
  v_mov_b32 v201, 0x3f803f80
  v_mov_b32 v4, 0
  v_mov_b32 v5, 0
  v_cndmask_b32 v201, 0, v201, vcc
  v_mov_b32 v128, v201
  v_mov_b32 v129, v201
  v_mov_b32 v130, v201
  v_mov_b32 v131, v201
  v_mov_b32 v132, v201
  v_mov_b32 v133, v201
  v_mov_b32 v134, v201
  v_mov_b32 v135, v201
  v_mov_b32 v136, v201
  v_mov_b32 v137, v201
  v_mov_b32 v138, v201
  v_mov_b32 v139, v201
  v_mov_b32 v140, v201
  v_mov_b32 v141, v201
  v_mov_b32 v142, v201
  v_mov_b32 v143, v201
  v_mov_b32 v144, v201
  v_mov_b32 v145, v201
  v_mov_b32 v146, v201
  v_mov_b32 v147, v201
  v_mov_b32 v148, v201
  v_mov_b32 v149, v201
  v_mov_b32 v150, v201
  v_mov_b32 v151, v201
  v_mov_b32 v152, v201
  v_mov_b32 v153, v201
  v_mov_b32 v154, v201
  v_mov_b32 v155, v201
  v_mov_b32 v156, v201
  v_mov_b32 v157, v201
  v_mov_b32 v158, v201
  v_mov_b32 v159, v201
  v_mov_b32 v160, v201
  v_mov_b32 v161, v201
  v_mov_b32 v162, v201
  v_mov_b32 v163, v201
  v_mov_b32 v164, v201
  v_mov_b32 v165, v201
  v_mov_b32 v166, v201
  v_mov_b32 v167, v201
  v_mov_b32 v168, v201
  v_mov_b32 v169, v201
  v_mov_b32 v170, v201
  v_mov_b32 v171, v201
  v_mov_b32 v172, v201
  v_mov_b32 v173, v201
  v_mov_b32 v174, v201
  v_mov_b32 v175, v201
  v_mov_b32 v176, v201
  v_mov_b32 v177, v201
  v_mov_b32 v178, v201
  v_mov_b32 v179, v201
  v_mov_b32 v180, v201
  v_mov_b32 v181, v201
  v_mov_b32 v182, v201
  v_mov_b32 v183, v201
  v_mov_b32 v184, v201
  v_mov_b32 v185, v201
  v_mov_b32 v186, v201
  v_mov_b32 v187, v201
  v_mov_b32 v188, v201
  v_mov_b32 v189, v201
  v_mov_b32 v190, v201
  v_mov_b32 v191, v201
  v_mov_b32 v224, v201
  v_mov_b32 v225, v201
  v_mov_b32 v226, v201
  v_mov_b32 v227, v201
  v_mov_b32 v228, v201
  v_mov_b32 v229, v201
  v_mov_b32 v230, v201
  v_mov_b32 v231, v201
  v_mov_b32 v232, v201
  v_mov_b32 v233, v201
  v_mov_b32 v234, v201
  v_mov_b32 v235, v201
  v_mov_b32 v236, v201
  v_mov_b32 v237, v201
  v_mov_b32 v238, v201
  v_mov_b32 v239, v201
  v_mov_b32 v240, v201
  v_mov_b32 v241, v201
  v_mov_b32 v242, v201
  v_mov_b32 v243, v201
  v_mov_b32 v244, v201
  v_mov_b32 v245, v201
  v_mov_b32 v246, v201
  v_mov_b32 v247, v201
  v_mov_b32 v248, v201
  v_mov_b32 v249, v201
  v_mov_b32 v250, v201
  v_mov_b32 v251, v201
  v_mov_b32 v252, v201
  v_mov_b32 v253, v201
  v_mov_b32 v254, v201
  v_mov_b32 v255, v201
  v_mov_b32 v223, 0xdddddddd
  v_mov_b32 v64, 0
  v_mov_b32 v65, 0
  v_mov_b32 v66, 0
  v_mov_b32 v67, 0
  v_mov_b32 v68, 0
  v_mov_b32 v69, 0
  v_mov_b32 v70, 0
  v_mov_b32 v71, 0
  v_mov_b32 v72, 0
  v_mov_b32 v73, 0
  v_mov_b32 v74, 0
  v_mov_b32 v75, 0
  v_mov_b32 v76, 0
  v_mov_b32 v77, 0
  v_mov_b32 v78, 0
  v_mov_b32 v79, 0
  v_mov_b32 v80, 0
  v_mov_b32 v81, 0
  v_mov_b32 v82, 0
  v_mov_b32 v83, 0
  v_mov_b32 v84, 0
  v_mov_b32 v85, 0
  v_mov_b32 v86, 0
  v_mov_b32 v87, 0
  v_mov_b32 v88, 0
  v_mov_b32 v89, 0
  v_mov_b32 v90, 0
  v_mov_b32 v91, 0
  v_mov_b32 v92, 0
  v_mov_b32 v93, 0
  v_mov_b32 v94, 0
  v_mov_b32 v95, 0
  v_mov_b32 v197, v196
  v_mov_b32 v16, 0
  v_mov_b32 v17, 0
  v_mov_b32 v18, 0
  v_mov_b32 v19, 0
  v_mov_b32 v20, 0
  v_mov_b32 v21, 0
  v_mov_b32 v22, 0
  v_mov_b32 v23, 0
  v_mov_b32 v24, 0
  v_mov_b32 v25, 0
  v_mov_b32 v26, 0
  v_mov_b32 v27, 0
  v_mov_b32 v28, 0
  v_mov_b32 v29, 0
  v_mov_b32 v30, 0
  v_mov_b32 v31, 0
  s_mov_b32 s71, 0
  s_waitcnt lgkmcnt(0)
  s_mov_b32 s28, s14
  s_mov_b32 s29, s15
  s_mov_b32 s30, 11599872
  s_mov_b32 s31, 0x20000
  s_mov_b32 s55, 0
  s_branch KG_QE0
KG_QS1:
  s_waitcnt lgkmcnt(6)
  v_mfma_f32_32x32x16_bf16 v[16:31], v[116:119], v[100:103], v[16:31]
  s_waitcnt lgkmcnt(3)
  v_mfma_f32_32x32x16_bf16 v[16:31], v[120:123], v[104:107], v[16:31]
  s_waitcnt lgkmcnt(0)
  v_mfma_f32_32x32x16_bf16 v[16:31], v[124:127], v[108:111], v[16:31]
KG_QE1:
  ds_read_b128 v[200:203], v7 offset:0
  s_waitcnt lgkmcnt(0)
  v_min3_u32 v200, v200, v201, v203
  s_nop 0
  v_readfirstlane_b32 s71, v200
  s_cmp_gt_u32 s71, s55
  s_cbranch_scc1 KG_QG1
  s_sub_u32 s72, s72, 1
  s_cbranch_scc0 KG_QE1
  s_mov_b32 s72, 0
KG_QG1:
  ds_read_b128 v[32:35], v192 offset:8192
  ds_read_b64_tr_b16 v[48:49], v197 offset:8192
  ds_read_b64_tr_b16 v[50:51], v197 offset:8704
  ds_read_b128 v[36:39], v193 offset:8192
  ds_read_b64_tr_b16 v[52:53], v197 offset:10240
  ds_read_b64_tr_b16 v[54:55], v197 offset:10752
  ds_read_b128 v[40:43], v194 offset:8192
  ds_read_b64_tr_b16 v[56:57], v197 offset:12288
  ds_read_b64_tr_b16 v[58:59], v197 offset:12800
  ds_read_b128 v[44:47], v195 offset:8192
  ds_read_b64_tr_b16 v[60:61], v197 offset:14336
  ds_read_b64_tr_b16 v[62:63], v197 offset:14848
  s_add_u32 s55, s55, 1
  v_add_u32 v192, 0x4000, v192
  v_add_u32 v193, 0x4000, v193
  v_add_u32 v196, 0x4000, v196
  s_branch KG_Q0
KG_QS0:
  s_cmp_eq_u32 s55, 8
  s_cbranch_scc1 KG_QX
  s_waitcnt lgkmcnt(6)
  v_mfma_f32_32x32x16_bf16 v[16:31], v[52:55], v[36:39], v[16:31]
  s_waitcnt lgkmcnt(3)
  v_mfma_f32_32x32x16_bf16 v[16:31], v[56:59], v[40:43], v[16:31]
  s_waitcnt lgkmcnt(0)
  v_mfma_f32_32x32x16_bf16 v[16:31], v[60:63], v[44:47], v[16:31]
  v_add_u32 v194, 0x4000, v194
  v_add_u32 v195, 0x4000, v195
  v_add_u32 v197, 0x4000, v197
KG_QE0:
  ds_read_b128 v[200:203], v7 offset:0
  s_waitcnt lgkmcnt(0)
  v_min3_u32 v200, v200, v201, v203
  s_nop 0
  v_readfirstlane_b32 s71, v200
  s_cmp_gt_u32 s71, s55
  s_cbranch_scc1 KG_QG0
  s_sub_u32 s72, s72, 1
  s_cbranch_scc0 KG_QE0
  s_mov_b32 s72, 0
KG_QG0:
  ds_read_b128 v[96:99], v192 offset:0
  ds_read_b64_tr_b16 v[112:113], v196 offset:0
  ds_read_b64_tr_b16 v[114:115], v196 offset:512
  ds_read_b128 v[100:103], v193 offset:0
  ds_read_b64_tr_b16 v[116:117], v196 offset:2048
  ds_read_b64_tr_b16 v[118:119], v196 offset:2560
  ds_read_b128 v[104:107], v194 offset:0
  ds_read_b64_tr_b16 v[120:121], v196 offset:4096
  ds_read_b64_tr_b16 v[122:123], v196 offset:4608
  ds_read_b128 v[108:111], v195 offset:0
  ds_read_b64_tr_b16 v[124:125], v196 offset:6144
  ds_read_b64_tr_b16 v[126:127], v196 offset:6656
  s_add_u32 s55, s55, 1
KG_Q1:
  s_waitcnt lgkmcnt(9)
  v_mfma_f32_32x32x16_bf16 v[16:31], v[112:115], v[96:99], v[16:31]
  s_cmp_gt_u32 s71, s55
  s_cbranch_scc0 KG_QS1
  ds_read_b128 v[200:203], v7 offset:0
  ds_read_b128 v[32:35], v192 offset:8192
  ds_read_b64_tr_b16 v[48:49], v197 offset:8192
  ds_read_b64_tr_b16 v[50:51], v197 offset:8704
  s_waitcnt lgkmcnt(10)
  v_mfma_f32_32x32x16_bf16 v[16:31], v[116:119], v[100:103], v[16:31]
  ds_read_b128 v[36:39], v193 offset:8192
  ds_read_b64_tr_b16 v[52:53], v197 offset:10240
  ds_read_b64_tr_b16 v[54:55], v197 offset:10752
  v_add_u32 v192, 0x4000, v192
  s_add_u32 s55, s55, 1
  s_waitcnt lgkmcnt(10)
  v_mfma_f32_32x32x16_bf16 v[16:31], v[120:123], v[104:107], v[16:31]
  ds_read_b128 v[40:43], v194 offset:8192
  ds_read_b64_tr_b16 v[56:57], v197 offset:12288
  ds_read_b64_tr_b16 v[58:59], v197 offset:12800
  v_add_u32 v193, 0x4000, v193
  v_add_u32 v196, 0x4000, v196
  s_waitcnt lgkmcnt(9)
  v_mfma_f32_32x32x16_bf16 v[16:31], v[124:127], v[108:111], v[16:31]
  v_min3_u32 v200, v200, v201, v203
  ds_read_b128 v[44:47], v195 offset:8192
  ds_read_b64_tr_b16 v[60:61], v197 offset:14336
  ds_read_b64_tr_b16 v[62:63], v197 offset:14848
  v_readfirstlane_b32 s71, v200
KG_Q0:
  s_waitcnt lgkmcnt(9)
  v_mfma_f32_32x32x16_bf16 v[16:31], v[48:51], v[32:35], v[16:31]
  s_cmp_gt_u32 s71, s55
  s_cbranch_scc0 KG_QS0
  ds_read_b128 v[200:203], v7 offset:0
  ds_read_b128 v[96:99], v192 offset:0
  ds_read_b64_tr_b16 v[112:113], v196 offset:0
  ds_read_b64_tr_b16 v[114:115], v196 offset:512
  s_waitcnt lgkmcnt(10)
  v_mfma_f32_32x32x16_bf16 v[16:31], v[52:55], v[36:39], v[16:31]
  ds_read_b128 v[100:103], v193 offset:0
  ds_read_b64_tr_b16 v[116:117], v196 offset:2048
  ds_read_b64_tr_b16 v[118:119], v196 offset:2560
  v_add_u32 v194, 0x4000, v194
  s_add_u32 s55, s55, 1
  s_waitcnt lgkmcnt(10)
  v_mfma_f32_32x32x16_bf16 v[16:31], v[56:59], v[40:43], v[16:31]
  ds_read_b128 v[104:107], v194 offset:0
  ds_read_b64_tr_b16 v[120:121], v196 offset:4096
  ds_read_b64_tr_b16 v[122:123], v196 offset:4608
  v_add_u32 v195, 0x4000, v195
  v_add_u32 v197, 0x4000, v197
  s_waitcnt lgkmcnt(9)
  v_mfma_f32_32x32x16_bf16 v[16:31], v[60:63], v[44:47], v[16:31]
  v_min3_u32 v200, v200, v201, v203
  ds_read_b128 v[108:111], v195 offset:0
  ds_read_b64_tr_b16 v[124:125], v196 offset:6144
  ds_read_b64_tr_b16 v[126:127], v196 offset:6656
  v_readfirstlane_b32 s71, v200
  s_branch KG_Q1
KG_QX:
  v_readfirstlane_b32 s59, v202
  s_cmp_lt_u32 s59, 1
  s_cbranch_scc1 KG_SP1
KG_SR1:
  ds_read_b128 v[96:99], v210 offset:0
  s_mov_b64 exec, s[60:61]
  ds_read_b128 v[128:131], v210 offset:1024
  ds_read_b128 v[132:135], v210 offset:1280
  s_mov_b64 exec, -1
  s_waitcnt lgkmcnt(9)
  v_mfma_f32_32x32x16_bf16 v[16:31], v[52:55], v[36:39], v[16:31]
  s_waitcnt lgkmcnt(6)
  v_mfma_f32_32x32x16_bf16 v[16:31], v[56:59], v[40:43], v[16:31]
  s_waitcnt lgkmcnt(3)
  v_mfma_f32_32x32x16_bf16 v[16:31], v[60:63], v[44:47], v[16:31]
  ds_write_b32 v208, v209 offset:16
  s_lshl_b32 s53, s49, 1
  s_add_u32 s53, s53, s66
  s_lshl_b32 s54, s50, 1
  s_add_u32 s54, s54, s3
  s_lshl_b32 s53, s53, 4
  s_add_u32 s53, s53, s54
  s_lshl_b32 s58, s53, 11
  s_add_u32 s58, s58, 5242880
  s_mov_b32 s51, 813694976
  s_mov_b32 s52, 1317011456
  s_nop 4
  v_cvt_pk_bf16_f32 v8, v16, v17
  v_cvt_pk_bf16_f32 v9, v18, v19
  v_cvt_pk_bf16_f32 v10, v20, v21
  v_cvt_pk_bf16_f32 v11, v22, v23
  v_cvt_pk_bf16_f32 v12, v24, v25
  v_cvt_pk_bf16_f32 v13, v26, v27
  v_cvt_pk_bf16_f32 v14, v28, v29
  v_cvt_pk_bf16_f32 v15, v30, v31
  s_waitcnt lgkmcnt(0)
  v_mfma_f32_32x32x16_bf16 v[16:31], v[96:99], v[8:11], 0
  s_mov_b32 s55, 6
  s_mov_b32 s56, 0
  s_mov_b32 s57, 1
  s_nop 4
  v_exp_f32 v16, v16
  v_exp_f32 v17, v17
  v_exp_f32 v18, v18
  v_exp_f32 v19, v19
  v_exp_f32 v20, v20
  s_cmp_lt_u32 s59, 2
  s_cbranch_scc1 KG_SP2
KG_SR2:
  ds_read_b128 v[100:103], v210 offset:2048
  s_mov_b64 exec, s[60:61]
  ds_read_b128 v[136:139], v210 offset:3072
  ds_read_b128 v[140:143], v210 offset:3328
  s_mov_b64 exec, -1
  ds_read_b32 v222, v7 offset:8
  v_exp_f32 v21, v21
  v_exp_f32 v22, v22
  v_exp_f32 v23, v23
  v_mfma_f32_32x32x16_bf16 v[32:47], v[96:99], v[12:15], 0
  v_exp_f32 v24, v24
  v_exp_f32 v25, v25
  v_exp_f32 v26, v26
  v_smfmac_f32_32x32x32_bf16 v[64:79], v[128:131], v[16:23], v223
  v_exp_f32 v27, v27
  v_exp_f32 v28, v28
  v_exp_f32 v29, v29
  v_exp_f32 v30, v30
  v_exp_f32 v31, v31
  v_exp_f32 v32, v32
  v_exp_f32 v33, v33
  v_exp_f32 v34, v34
  v_exp_f32 v35, v35
  v_exp_f32 v36, v36
  v_smfmac_f32_32x32x32_bf16 v[64:79], v[132:135], v[24:31], v223
  v_exp_f32 v37, v37
  v_exp_f32 v38, v38
  v_exp_f32 v39, v39
  s_waitcnt lgkmcnt(0)
  v_mfma_f32_32x32x16_bf16 v[16:31], v[100:103], v[8:11], 0
  v_exp_f32 v40, v40
  v_exp_f32 v41, v41
  v_exp_f32 v42, v42
  v_smfmac_f32_32x32x32_bf16 v[80:95], v[128:131], v[32:39], v223
  v_exp_f32 v43, v43
  v_exp_f32 v44, v44
  v_exp_f32 v45, v45
  v_exp_f32 v46, v46
  v_exp_f32 v47, v47
  v_readfirstlane_b32 s59, v222
  v_exp_f32 v16, v16
  v_exp_f32 v17, v17
  v_exp_f32 v18, v18
  v_exp_f32 v19, v19
  v_exp_f32 v20, v20
  v_smfmac_f32_32x32x32_bf16 v[80:95], v[132:135], v[40:47], v223
  s_cmp_lt_u32 s59, 3
  s_cbranch_scc1 KG_SP3
KG_SR3:
  ds_read_b128 v[104:107], v210 offset:4096
  s_mov_b64 exec, s[60:61]
  ds_read_b128 v[144:147], v210 offset:5120
  ds_read_b128 v[148:151], v210 offset:5376
  s_mov_b64 exec, -1
  ds_read_b32 v222, v7 offset:8
  v_exp_f32 v21, v21
  v_exp_f32 v22, v22
  v_exp_f32 v23, v23
  v_mfma_f32_32x32x16_bf16 v[32:47], v[100:103], v[12:15], 0
  v_exp_f32 v24, v24
  v_exp_f32 v25, v25
  v_exp_f32 v26, v26
  v_smfmac_f32_32x32x32_bf16 v[64:79], v[136:139], v[16:23], v223
  v_exp_f32 v27, v27
  v_exp_f32 v28, v28
  v_exp_f32 v29, v29
  v_exp_f32 v30, v30
  v_exp_f32 v31, v31
  v_exp_f32 v32, v32
  v_exp_f32 v33, v33
  v_exp_f32 v34, v34
  v_exp_f32 v35, v35
  v_exp_f32 v36, v36
  v_smfmac_f32_32x32x32_bf16 v[64:79], v[140:143], v[24:31], v223
  v_exp_f32 v37, v37
  v_exp_f32 v38, v38
  v_exp_f32 v39, v39
  s_waitcnt lgkmcnt(0)
  v_mfma_f32_32x32x16_bf16 v[16:31], v[104:107], v[8:11], 0
  v_exp_f32 v40, v40
  v_exp_f32 v41, v41
  v_exp_f32 v42, v42
  v_smfmac_f32_32x32x32_bf16 v[80:95], v[136:139], v[32:39], v223
  v_exp_f32 v43, v43
  v_exp_f32 v44, v44
  v_exp_f32 v45, v45
  v_exp_f32 v46, v46
  v_exp_f32 v47, v47
  v_readfirstlane_b32 s59, v222
  v_exp_f32 v16, v16
  v_exp_f32 v17, v17
  v_exp_f32 v18, v18
  v_exp_f32 v19, v19
  v_exp_f32 v20, v20
  v_smfmac_f32_32x32x32_bf16 v[80:95], v[140:143], v[40:47], v223
  s_cmp_lt_u32 s59, 4
  s_cbranch_scc1 KG_SP4
KG_SR4:
  ds_read_b128 v[108:111], v210 offset:6144
  s_mov_b64 exec, s[60:61]
  ds_read_b128 v[152:155], v210 offset:7168
  ds_read_b128 v[156:159], v210 offset:7424
  s_mov_b64 exec, -1
  ds_read_b32 v222, v7 offset:8
  v_exp_f32 v21, v21
  v_exp_f32 v22, v22
  v_exp_f32 v23, v23
  v_mfma_f32_32x32x16_bf16 v[32:47], v[104:107], v[12:15], 0
  v_exp_f32 v24, v24
  v_exp_f32 v25, v25
  v_exp_f32 v26, v26
  v_smfmac_f32_32x32x32_bf16 v[64:79], v[144:147], v[16:23], v223
  v_exp_f32 v27, v27
  v_exp_f32 v28, v28
  v_exp_f32 v29, v29
  v_exp_f32 v30, v30
  v_exp_f32 v31, v31
  v_exp_f32 v32, v32
  v_exp_f32 v33, v33
  v_exp_f32 v34, v34
  v_exp_f32 v35, v35
  v_exp_f32 v36, v36
  v_smfmac_f32_32x32x32_bf16 v[64:79], v[148:151], v[24:31], v223
  v_exp_f32 v37, v37
  v_exp_f32 v38, v38
  v_exp_f32 v39, v39
  s_waitcnt lgkmcnt(0)
  v_mfma_f32_32x32x16_bf16 v[16:31], v[108:111], v[8:11], 0
  v_exp_f32 v40, v40
  v_exp_f32 v41, v41
  v_exp_f32 v42, v42
  v_smfmac_f32_32x32x32_bf16 v[80:95], v[144:147], v[32:39], v223
  v_exp_f32 v43, v43
  v_exp_f32 v44, v44
  v_exp_f32 v45, v45
  v_exp_f32 v46, v46
  v_exp_f32 v47, v47
  v_readfirstlane_b32 s59, v222
  v_exp_f32 v16, v16
  v_exp_f32 v17, v17
  v_exp_f32 v18, v18
  v_exp_f32 v19, v19
  v_exp_f32 v20, v20
  v_smfmac_f32_32x32x32_bf16 v[80:95], v[148:151], v[40:47], v223
  s_cmp_lt_u32 s59, 5
  s_cbranch_scc1 KG_SP5
KG_SR5:
  ds_read_b128 v[112:115], v210 offset:8192
  s_mov_b64 exec, s[60:61]
  ds_read_b128 v[160:163], v210 offset:9216
  ds_read_b128 v[164:167], v210 offset:9472
  s_mov_b64 exec, -1
  ds_read_b32 v222, v7 offset:8
  v_exp_f32 v21, v21
  v_exp_f32 v22, v22
  v_exp_f32 v23, v23
  v_mfma_f32_32x32x16_bf16 v[32:47], v[108:111], v[12:15], 0
  v_exp_f32 v24, v24
  v_exp_f32 v25, v25
  v_exp_f32 v26, v26
  v_smfmac_f32_32x32x32_bf16 v[64:79], v[152:155], v[16:23], v223
  v_exp_f32 v27, v27
  v_exp_f32 v28, v28
  v_exp_f32 v29, v29
  v_exp_f32 v30, v30
  v_exp_f32 v31, v31
  v_exp_f32 v32, v32
  v_exp_f32 v33, v33
  v_exp_f32 v34, v34
  v_exp_f32 v35, v35
  v_exp_f32 v36, v36
  v_smfmac_f32_32x32x32_bf16 v[64:79], v[156:159], v[24:31], v223
  v_exp_f32 v37, v37
  v_exp_f32 v38, v38
  v_exp_f32 v39, v39
  s_waitcnt lgkmcnt(0)
  v_mfma_f32_32x32x16_bf16 v[16:31], v[112:115], v[8:11], 0
  v_exp_f32 v40, v40
  v_exp_f32 v41, v41
  v_exp_f32 v42, v42
  v_smfmac_f32_32x32x32_bf16 v[80:95], v[152:155], v[32:39], v223
  v_exp_f32 v43, v43
  v_exp_f32 v44, v44
  v_exp_f32 v45, v45
  v_exp_f32 v46, v46
  v_exp_f32 v47, v47
  v_readfirstlane_b32 s59, v222
  v_exp_f32 v16, v16
  v_exp_f32 v17, v17
  v_exp_f32 v18, v18
  v_exp_f32 v19, v19
  v_exp_f32 v20, v20
  v_smfmac_f32_32x32x32_bf16 v[80:95], v[156:159], v[40:47], v223
  s_cmp_lt_u32 s59, 6
  s_cbranch_scc1 KG_SP6
KG_SR6:
  ds_read_b128 v[116:119], v210 offset:10240
  s_mov_b64 exec, s[60:61]
  ds_read_b128 v[168:171], v210 offset:11264
  ds_read_b128 v[172:175], v210 offset:11520
  s_mov_b64 exec, -1
  ds_read_b32 v222, v7 offset:8
  v_exp_f32 v21, v21
  v_exp_f32 v22, v22
  v_exp_f32 v23, v23
  v_mfma_f32_32x32x16_bf16 v[32:47], v[112:115], v[12:15], 0
  v_exp_f32 v24, v24
  v_exp_f32 v25, v25
  v_exp_f32 v26, v26
  v_smfmac_f32_32x32x32_bf16 v[64:79], v[160:163], v[16:23], v223
  v_exp_f32 v27, v27
  v_exp_f32 v28, v28
  v_exp_f32 v29, v29
  v_exp_f32 v30, v30
  v_exp_f32 v31, v31
  v_exp_f32 v32, v32
  v_exp_f32 v33, v33
  v_exp_f32 v34, v34
  v_exp_f32 v35, v35
  v_exp_f32 v36, v36
  v_smfmac_f32_32x32x32_bf16 v[64:79], v[164:167], v[24:31], v223
  v_exp_f32 v37, v37
  v_exp_f32 v38, v38
  v_exp_f32 v39, v39
  s_waitcnt lgkmcnt(0)
  v_mfma_f32_32x32x16_bf16 v[16:31], v[116:119], v[8:11], 0
  v_exp_f32 v40, v40
  v_exp_f32 v41, v41
  v_exp_f32 v42, v42
  v_smfmac_f32_32x32x32_bf16 v[80:95], v[160:163], v[32:39], v223
  v_exp_f32 v43, v43
  v_exp_f32 v44, v44
  v_exp_f32 v45, v45
  v_exp_f32 v46, v46
  v_exp_f32 v47, v47
  v_readfirstlane_b32 s59, v222
  v_exp_f32 v16, v16
  v_exp_f32 v17, v17
  v_exp_f32 v18, v18
  v_exp_f32 v19, v19
  v_exp_f32 v20, v20
  v_smfmac_f32_32x32x32_bf16 v[80:95], v[164:167], v[40:47], v223
  s_cmp_lt_u32 s59, 7
  s_cbranch_scc1 KG_SP7
KG_SR7:
  ds_read_b128 v[120:123], v210 offset:12288
  s_mov_b64 exec, s[60:61]
  ds_read_b128 v[176:179], v210 offset:13312
  ds_read_b128 v[180:183], v210 offset:13568
  s_mov_b64 exec, -1
  ds_read_b32 v222, v7 offset:8
  v_exp_f32 v21, v21
  v_exp_f32 v22, v22
  v_exp_f32 v23, v23
  v_mfma_f32_32x32x16_bf16 v[32:47], v[116:119], v[12:15], 0
  v_exp_f32 v24, v24
  v_exp_f32 v25, v25
  v_exp_f32 v26, v26
  v_smfmac_f32_32x32x32_bf16 v[64:79], v[168:171], v[16:23], v223
  v_exp_f32 v27, v27
  v_exp_f32 v28, v28
  v_exp_f32 v29, v29
  v_exp_f32 v30, v30
  v_exp_f32 v31, v31
  v_exp_f32 v32, v32
  v_exp_f32 v33, v33
  v_exp_f32 v34, v34
  v_exp_f32 v35, v35
  v_exp_f32 v36, v36
  v_smfmac_f32_32x32x32_bf16 v[64:79], v[172:175], v[24:31], v223
  v_exp_f32 v37, v37
  v_exp_f32 v38, v38
  v_exp_f32 v39, v39
  s_waitcnt lgkmcnt(0)
  v_mfma_f32_32x32x16_bf16 v[16:31], v[120:123], v[8:11], 0
  v_exp_f32 v40, v40
  v_exp_f32 v41, v41
  v_exp_f32 v42, v42
  v_smfmac_f32_32x32x32_bf16 v[80:95], v[168:171], v[32:39], v223
  v_exp_f32 v43, v43
  v_exp_f32 v44, v44
  v_exp_f32 v45, v45
  v_exp_f32 v46, v46
  v_exp_f32 v47, v47
  v_readfirstlane_b32 s59, v222
  v_exp_f32 v16, v16
  v_exp_f32 v17, v17
  v_exp_f32 v18, v18
  v_exp_f32 v19, v19
  v_exp_f32 v20, v20
  v_smfmac_f32_32x32x32_bf16 v[80:95], v[172:175], v[40:47], v223
  s_cmp_lt_u32 s59, 8
  s_cbranch_scc1 KG_SP8
KG_SR8:
  ds_read_b128 v[124:127], v210 offset:14336
  s_mov_b64 exec, s[60:61]
  ds_read_b128 v[184:187], v210 offset:15360
  ds_read_b128 v[188:191], v210 offset:15616
  s_mov_b64 exec, -1
  v_exp_f32 v21, v21
  v_exp_f32 v22, v22
  v_exp_f32 v23, v23
  v_mfma_f32_32x32x16_bf16 v[32:47], v[120:123], v[12:15], 0
  v_exp_f32 v24, v24
  v_exp_f32 v25, v25
  v_exp_f32 v26, v26
  v_smfmac_f32_32x32x32_bf16 v[64:79], v[176:179], v[16:23], v223
  v_exp_f32 v27, v27
  v_exp_f32 v28, v28
  v_exp_f32 v29, v29
  v_exp_f32 v30, v30
  v_exp_f32 v31, v31
  v_exp_f32 v32, v32
  v_exp_f32 v33, v33
  v_exp_f32 v34, v34
  v_exp_f32 v35, v35
  v_exp_f32 v36, v36
  v_smfmac_f32_32x32x32_bf16 v[64:79], v[180:183], v[24:31], v223
  v_exp_f32 v37, v37
  v_exp_f32 v38, v38
  v_exp_f32 v39, v39
  s_waitcnt lgkmcnt(0)
  v_mfma_f32_32x32x16_bf16 v[16:31], v[124:127], v[8:11], 0
  ds_read_b32 v221, v7 offset:48
  v_exp_f32 v40, v40
  v_exp_f32 v41, v41
  v_exp_f32 v42, v42
  v_smfmac_f32_32x32x32_bf16 v[80:95], v[176:179], v[32:39], v223
  v_exp_f32 v43, v43
  v_exp_f32 v44, v44
  v_exp_f32 v45, v45
  v_exp_f32 v46, v46
  v_exp_f32 v47, v47
  v_exp_f32 v16, v16
  v_exp_f32 v17, v17
  v_exp_f32 v18, v18
  v_exp_f32 v19, v19
  v_exp_f32 v20, v20
  v_smfmac_f32_32x32x32_bf16 v[80:95], v[180:183], v[40:47], v223
  s_waitcnt lgkmcnt(0)
  v_readfirstlane_b32 s56, v221
  v_exp_f32 v21, v21
  v_exp_f32 v22, v22
  v_exp_f32 v23, v23
  v_mfma_f32_32x32x16_bf16 v[32:47], v[124:127], v[12:15], 0
  s_cmp_lt_u32 s56, 1
  s_cbranch_scc1 KG_SP9
KG_SR9:
  ds_read_b128 v[96:99], v216 offset:0
  ds_read_b128 v[100:103], v216 offset:2048
  ds_read_b128 v[104:107], v216 offset:4096
  ds_read_b128 v[108:111], v216 offset:6144
  s_mov_b64 exec, s[60:61]
  ds_read_b128 v[128:131], v216 offset:1024
  ds_read_b128 v[132:135], v216 offset:1280
  ds_read_b128 v[136:139], v216 offset:3072
  ds_read_b128 v[140:143], v216 offset:3328
  ds_read_b128 v[144:147], v216 offset:5120
  ds_read_b128 v[148:151], v216 offset:5376
  ds_read_b128 v[152:155], v216 offset:7168
  ds_read_b128 v[156:159], v216 offset:7424
  s_mov_b64 exec, -1
  v_exp_f32 v24, v24
  v_exp_f32 v25, v25
  v_exp_f32 v26, v26
  v_smfmac_f32_32x32x32_bf16 v[64:79], v[184:187], v[16:23], v223
  v_exp_f32 v27, v27
  v_exp_f32 v28, v28
  v_exp_f32 v29, v29
  v_exp_f32 v30, v30
  v_exp_f32 v31, v31
  v_exp_f32 v32, v32
  v_exp_f32 v33, v33
  v_exp_f32 v34, v34
  v_exp_f32 v35, v35
  v_exp_f32 v36, v36
  v_smfmac_f32_32x32x32_bf16 v[64:79], v[188:191], v[24:31], v223
  v_exp_f32 v37, v37
  v_exp_f32 v38, v38
  v_exp_f32 v39, v39
  s_waitcnt lgkmcnt(8)
  v_mfma_f32_32x32x16_bf16 v[16:31], v[96:99], v[8:11], 0
  v_exp_f32 v40, v40
  v_exp_f32 v41, v41
  v_exp_f32 v42, v42
  v_smfmac_f32_32x32x32_bf16 v[80:95], v[184:187], v[32:39], v223
  v_exp_f32 v43, v43
  v_exp_f32 v44, v44
  v_exp_f32 v45, v45
  v_exp_f32 v46, v46
  v_exp_f32 v47, v47
  v_exp_f32 v16, v16
  v_exp_f32 v17, v17
  v_exp_f32 v18, v18
  v_exp_f32 v19, v19
  v_exp_f32 v20, v20
  v_smfmac_f32_32x32x32_bf16 v[80:95], v[188:191], v[40:47], v223
  v_exp_f32 v21, v21
  v_exp_f32 v22, v22
  v_exp_f32 v23, v23
  v_mfma_f32_32x32x16_bf16 v[32:47], v[96:99], v[12:15], 0
  ds_read_b128 v[112:115], v216 offset:8192
  ds_read_b128 v[116:119], v216 offset:10240
  ds_read_b128 v[120:123], v216 offset:12288
  ds_read_b128 v[124:127], v216 offset:14336
  s_mov_b64 exec, s[60:61]
  ds_read_b128 v[160:163], v216 offset:9216
  ds_read_b128 v[164:167], v216 offset:9472
  ds_read_b128 v[168:171], v216 offset:11264
  ds_read_b128 v[172:175], v216 offset:11520
  ds_read_b128 v[176:179], v216 offset:13312
  ds_read_b128 v[180:183], v216 offset:13568
  ds_read_b128 v[184:187], v216 offset:15360
  ds_read_b128 v[188:191], v216 offset:15616
  s_mov_b64 exec, -1
  v_exp_f32 v24, v24
  v_exp_f32 v25, v25
  v_exp_f32 v26, v26
  s_waitcnt lgkmcnt(12)
  v_smfmac_f32_32x32x32_bf16 v[64:79], v[128:131], v[16:23], v223
  v_exp_f32 v27, v27
  v_exp_f32 v28, v28
  v_exp_f32 v29, v29
  v_exp_f32 v30, v30
  v_exp_f32 v31, v31
  v_exp_f32 v32, v32
  v_exp_f32 v33, v33
  v_exp_f32 v34, v34
  v_exp_f32 v35, v35
  v_exp_f32 v36, v36
  v_smfmac_f32_32x32x32_bf16 v[64:79], v[132:135], v[24:31], v223
  v_exp_f32 v37, v37
  v_exp_f32 v38, v38
  v_exp_f32 v39, v39
  v_mfma_f32_32x32x16_bf16 v[16:31], v[100:103], v[8:11], 0
  v_exp_f32 v40, v40
  v_exp_f32 v41, v41
  v_exp_f32 v42, v42
  v_smfmac_f32_32x32x32_bf16 v[80:95], v[128:131], v[32:39], v223
  v_exp_f32 v43, v43
  v_exp_f32 v44, v44
  v_exp_f32 v45, v45
  v_exp_f32 v46, v46
  v_exp_f32 v47, v47
  v_exp_f32 v16, v16
  v_exp_f32 v17, v17
  v_exp_f32 v18, v18
  v_exp_f32 v19, v19
  v_exp_f32 v20, v20
  v_smfmac_f32_32x32x32_bf16 v[80:95], v[132:135], v[40:47], v223
  v_exp_f32 v21, v21
  v_exp_f32 v22, v22
  v_exp_f32 v23, v23
  v_mfma_f32_32x32x16_bf16 v[32:47], v[100:103], v[12:15], 0
  v_exp_f32 v24, v24
  v_exp_f32 v25, v25
  v_exp_f32 v26, v26
  v_smfmac_f32_32x32x32_bf16 v[64:79], v[136:139], v[16:23], v223
  v_exp_f32 v27, v27
  v_exp_f32 v28, v28
  v_exp_f32 v29, v29
  v_exp_f32 v30, v30
  v_exp_f32 v31, v31
  v_exp_f32 v32, v32
  v_exp_f32 v33, v33
  v_exp_f32 v34, v34
  v_exp_f32 v35, v35
  v_exp_f32 v36, v36
  v_smfmac_f32_32x32x32_bf16 v[64:79], v[140:143], v[24:31], v223
  s_waitcnt lgkmcnt(0)
  v_exp_f32 v37, v37
  v_exp_f32 v38, v38
  v_exp_f32 v39, v39
  v_mfma_f32_32x32x16_bf16 v[16:31], v[104:107], v[8:11], 0
  ds_write_b32 v208, v217 offset:16
  v_exp_f32 v40, v40
  v_exp_f32 v41, v41
  v_exp_f32 v42, v42
  v_smfmac_f32_32x32x32_bf16 v[80:95], v[136:139], v[32:39], v223
  v_exp_f32 v43, v43
  v_exp_f32 v44, v44
  v_exp_f32 v45, v45
  v_exp_f32 v46, v46
  v_exp_f32 v47, v47
  v_exp_f32 v16, v16
  v_exp_f32 v17, v17
  v_exp_f32 v18, v18
  v_exp_f32 v19, v19
  v_exp_f32 v20, v20
  v_smfmac_f32_32x32x32_bf16 v[80:95], v[140:143], v[40:47], v223
  v_exp_f32 v21, v21
  v_exp_f32 v22, v22
  v_exp_f32 v23, v23
  v_mfma_f32_32x32x16_bf16 v[32:47], v[104:107], v[12:15], 0
  v_exp_f32 v24, v24
  v_exp_f32 v25, v25
  v_exp_f32 v26, v26
  v_smfmac_f32_32x32x32_bf16 v[64:79], v[144:147], v[16:23], v223
  v_exp_f32 v27, v27
  v_exp_f32 v28, v28
  v_exp_f32 v29, v29
  v_exp_f32 v30, v30
  v_exp_f32 v31, v31
  v_exp_f32 v32, v32
  v_exp_f32 v33, v33
  v_exp_f32 v34, v34
  v_exp_f32 v35, v35
  v_exp_f32 v36, v36
  v_smfmac_f32_32x32x32_bf16 v[64:79], v[148:151], v[24:31], v223
  v_exp_f32 v37, v37
  v_exp_f32 v38, v38
  v_exp_f32 v39, v39
  v_mfma_f32_32x32x16_bf16 v[16:31], v[108:111], v[8:11], 0
  v_exp_f32 v40, v40
  v_exp_f32 v41, v41
  v_exp_f32 v42, v42
  v_smfmac_f32_32x32x32_bf16 v[80:95], v[144:147], v[32:39], v223
  v_exp_f32 v43, v43
  v_exp_f32 v44, v44
  v_exp_f32 v45, v45
  v_exp_f32 v46, v46
  v_exp_f32 v47, v47
  v_exp_f32 v16, v16
  v_exp_f32 v17, v17
  v_exp_f32 v18, v18
  v_exp_f32 v19, v19
  v_exp_f32 v20, v20
  v_smfmac_f32_32x32x32_bf16 v[80:95], v[148:151], v[40:47], v223
  v_exp_f32 v21, v21
  v_exp_f32 v22, v22
  v_exp_f32 v23, v23
  v_mfma_f32_32x32x16_bf16 v[32:47], v[108:111], v[12:15], 0
  v_exp_f32 v24, v24
  v_exp_f32 v25, v25
  v_exp_f32 v26, v26
  v_smfmac_f32_32x32x32_bf16 v[64:79], v[152:155], v[16:23], v223
  v_exp_f32 v27, v27
  v_exp_f32 v28, v28
  v_exp_f32 v29, v29
  v_exp_f32 v30, v30
  v_exp_f32 v31, v31
  v_exp_f32 v32, v32
  v_exp_f32 v33, v33
  v_exp_f32 v34, v34
  v_exp_f32 v35, v35
  v_exp_f32 v36, v36
  v_smfmac_f32_32x32x32_bf16 v[64:79], v[156:159], v[24:31], v223
  v_exp_f32 v37, v37
  v_exp_f32 v38, v38
  v_exp_f32 v39, v39
  v_mfma_f32_32x32x16_bf16 v[16:31], v[112:115], v[8:11], 0
  ds_read_b32 v221, v7 offset:48
  v_exp_f32 v40, v40
  v_exp_f32 v41, v41
  v_exp_f32 v42, v42
  v_smfmac_f32_32x32x32_bf16 v[80:95], v[152:155], v[32:39], v223
  v_exp_f32 v43, v43
  v_exp_f32 v44, v44
  v_exp_f32 v45, v45
  v_exp_f32 v46, v46
  v_exp_f32 v47, v47
  v_exp_f32 v16, v16
  v_exp_f32 v17, v17
  v_exp_f32 v18, v18
  v_exp_f32 v19, v19
  v_exp_f32 v20, v20
  v_smfmac_f32_32x32x32_bf16 v[80:95], v[156:159], v[40:47], v223
  s_waitcnt lgkmcnt(0)
  v_readfirstlane_b32 s56, v221
  v_exp_f32 v21, v21
  v_exp_f32 v22, v22
  v_exp_f32 v23, v23
  v_mfma_f32_32x32x16_bf16 v[32:47], v[112:115], v[12:15], 0
  s_cmp_lt_u32 s56, 2
  s_cbranch_scc1 KG_SP10
KG_SR10:
  ds_read_b128 v[96:99], v216 offset:16384
  ds_read_b128 v[100:103], v216 offset:18432
  ds_read_b128 v[104:107], v216 offset:20480
  ds_read_b128 v[108:111], v216 offset:22528
  s_mov_b64 exec, s[60:61]
  ds_read_b128 v[128:131], v216 offset:17408
  ds_read_b128 v[132:135], v216 offset:17664
  ds_read_b128 v[136:139], v216 offset:19456
  ds_read_b128 v[140:143], v216 offset:19712
  ds_read_b128 v[144:147], v216 offset:21504
  ds_read_b128 v[148:151], v216 offset:21760
  ds_read_b128 v[152:155], v216 offset:23552
  ds_read_b128 v[156:159], v216 offset:23808
  s_mov_b64 exec, -1
  v_exp_f32 v24, v24
  v_exp_f32 v25, v25
  v_exp_f32 v26, v26
  v_smfmac_f32_32x32x32_bf16 v[64:79], v[160:163], v[16:23], v223
  v_exp_f32 v27, v27
  v_exp_f32 v28, v28
  v_exp_f32 v29, v29
  v_exp_f32 v30, v30
  v_exp_f32 v31, v31
  v_exp_f32 v32, v32
  v_exp_f32 v33, v33
  v_exp_f32 v34, v34
  v_exp_f32 v35, v35
  v_exp_f32 v36, v36
  v_smfmac_f32_32x32x32_bf16 v[64:79], v[164:167], v[24:31], v223
  v_exp_f32 v37, v37
  v_exp_f32 v38, v38
  v_exp_f32 v39, v39
  v_mfma_f32_32x32x16_bf16 v[16:31], v[116:119], v[8:11], 0
  v_exp_f32 v40, v40
  v_exp_f32 v41, v41
  v_exp_f32 v42, v42
  v_smfmac_f32_32x32x32_bf16 v[80:95], v[160:163], v[32:39], v223
  v_exp_f32 v43, v43
  v_exp_f32 v44, v44
  v_exp_f32 v45, v45
  v_exp_f32 v46, v46
  v_exp_f32 v47, v47
  v_exp_f32 v16, v16
  v_exp_f32 v17, v17
  v_exp_f32 v18, v18
  v_exp_f32 v19, v19
  v_exp_f32 v20, v20
  v_smfmac_f32_32x32x32_bf16 v[80:95], v[164:167], v[40:47], v223
  v_exp_f32 v21, v21
  v_exp_f32 v22, v22
  v_exp_f32 v23, v23
  v_mfma_f32_32x32x16_bf16 v[32:47], v[116:119], v[12:15], 0
  v_exp_f32 v24, v24
  v_exp_f32 v25, v25
  v_exp_f32 v26, v26
  v_smfmac_f32_32x32x32_bf16 v[64:79], v[168:171], v[16:23], v223
  v_exp_f32 v27, v27
  v_exp_f32 v28, v28
  v_exp_f32 v29, v29
  v_exp_f32 v30, v30
  v_exp_f32 v31, v31
  v_exp_f32 v32, v32
  v_exp_f32 v33, v33
  v_exp_f32 v34, v34
  v_exp_f32 v35, v35
  v_exp_f32 v36, v36
  v_smfmac_f32_32x32x32_bf16 v[64:79], v[172:175], v[24:31], v223
  v_exp_f32 v37, v37
  v_exp_f32 v38, v38
  v_exp_f32 v39, v39
  v_mfma_f32_32x32x16_bf16 v[16:31], v[120:123], v[8:11], 0
  v_exp_f32 v40, v40
  v_exp_f32 v41, v41
  v_exp_f32 v42, v42
  v_smfmac_f32_32x32x32_bf16 v[80:95], v[168:171], v[32:39], v223
  v_exp_f32 v43, v43
  v_exp_f32 v44, v44
  v_exp_f32 v45, v45
  v_exp_f32 v46, v46
  v_exp_f32 v47, v47
  v_exp_f32 v16, v16
  v_exp_f32 v17, v17
  v_exp_f32 v18, v18
  v_exp_f32 v19, v19
  v_exp_f32 v20, v20
  v_smfmac_f32_32x32x32_bf16 v[80:95], v[172:175], v[40:47], v223
  v_exp_f32 v21, v21
  v_exp_f32 v22, v22
  v_exp_f32 v23, v23
  v_mfma_f32_32x32x16_bf16 v[32:47], v[120:123], v[12:15], 0
  v_exp_f32 v24, v24
  v_exp_f32 v25, v25
  v_exp_f32 v26, v26
  v_smfmac_f32_32x32x32_bf16 v[64:79], v[176:179], v[16:23], v223
  v_exp_f32 v27, v27
  v_exp_f32 v28, v28
  v_exp_f32 v29, v29
  v_exp_f32 v30, v30
  v_exp_f32 v31, v31
  v_exp_f32 v32, v32
  v_exp_f32 v33, v33
  v_exp_f32 v34, v34
  v_exp_f32 v35, v35
  v_exp_f32 v36, v36
  v_smfmac_f32_32x32x32_bf16 v[64:79], v[180:183], v[24:31], v223
  v_exp_f32 v37, v37
  v_exp_f32 v38, v38
  v_exp_f32 v39, v39
  v_mfma_f32_32x32x16_bf16 v[16:31], v[124:127], v[8:11], 0
  v_exp_f32 v40, v40
  v_exp_f32 v41, v41
  v_exp_f32 v42, v42
  v_smfmac_f32_32x32x32_bf16 v[80:95], v[176:179], v[32:39], v223
  v_exp_f32 v43, v43
  v_exp_f32 v44, v44
  v_exp_f32 v45, v45
  v_exp_f32 v46, v46
  v_exp_f32 v47, v47
  v_exp_f32 v16, v16
  v_exp_f32 v17, v17
  v_exp_f32 v18, v18
  v_exp_f32 v19, v19
  v_exp_f32 v20, v20
  v_smfmac_f32_32x32x32_bf16 v[80:95], v[180:183], v[40:47], v223
  v_exp_f32 v21, v21
  v_exp_f32 v22, v22
  v_exp_f32 v23, v23
  v_mfma_f32_32x32x16_bf16 v[32:47], v[124:127], v[12:15], 0
  v_exp_f32 v24, v24
  v_exp_f32 v25, v25
  v_exp_f32 v26, v26
  v_smfmac_f32_32x32x32_bf16 v[64:79], v[184:187], v[16:23], v223
  v_exp_f32 v27, v27
  v_exp_f32 v28, v28
  v_exp_f32 v29, v29
  v_exp_f32 v30, v30
  v_exp_f32 v31, v31
  v_exp_f32 v32, v32
  v_exp_f32 v33, v33
  v_exp_f32 v34, v34
  v_exp_f32 v35, v35
  v_exp_f32 v36, v36
  v_smfmac_f32_32x32x32_bf16 v[64:79], v[188:191], v[24:31], v223
  s_waitcnt lgkmcnt(0)
  v_exp_f32 v37, v37
  v_exp_f32 v38, v38
  v_exp_f32 v39, v39
  v_mfma_f32_32x32x16_bf16 v[16:31], v[96:99], v[8:11], 0
  v_exp_f32 v40, v40
  v_exp_f32 v41, v41
  v_exp_f32 v42, v42
  v_smfmac_f32_32x32x32_bf16 v[80:95], v[184:187], v[32:39], v223
  v_exp_f32 v43, v43
  v_exp_f32 v44, v44
  v_exp_f32 v45, v45
  v_exp_f32 v46, v46
  v_exp_f32 v47, v47
  v_exp_f32 v16, v16
  v_exp_f32 v17, v17
  v_exp_f32 v18, v18
  v_exp_f32 v19, v19
  v_exp_f32 v20, v20
  v_smfmac_f32_32x32x32_bf16 v[80:95], v[188:191], v[40:47], v223
  v_exp_f32 v21, v21
  v_exp_f32 v22, v22
  v_exp_f32 v23, v23
  v_mfma_f32_32x32x16_bf16 v[32:47], v[96:99], v[12:15], 0
  ds_read_b128 v[112:115], v216 offset:24576
  ds_read_b128 v[116:119], v216 offset:26624
  ds_read_b128 v[120:123], v216 offset:28672
  ds_read_b128 v[124:127], v216 offset:30720
  s_mov_b64 exec, s[60:61]
  ds_read_b128 v[160:163], v216 offset:25600
  ds_read_b128 v[164:167], v216 offset:25856
  ds_read_b128 v[168:171], v216 offset:27648
  ds_read_b128 v[172:175], v216 offset:27904
  ds_read_b128 v[176:179], v216 offset:29696
  ds_read_b128 v[180:183], v216 offset:29952
  ds_read_b128 v[184:187], v216 offset:31744
  ds_read_b128 v[188:191], v216 offset:32000
  s_mov_b64 exec, -1
  v_exp_f32 v24, v24
  v_exp_f32 v25, v25
  v_exp_f32 v26, v26
  v_smfmac_f32_32x32x32_bf16 v[64:79], v[128:131], v[16:23], v223
  v_exp_f32 v27, v27
  v_exp_f32 v28, v28
  v_exp_f32 v29, v29
  v_exp_f32 v30, v30
  v_exp_f32 v31, v31
  v_exp_f32 v32, v32
  v_exp_f32 v33, v33
  v_exp_f32 v34, v34
  v_exp_f32 v35, v35
  v_exp_f32 v36, v36
  v_smfmac_f32_32x32x32_bf16 v[64:79], v[132:135], v[24:31], v223
  v_exp_f32 v37, v37
  v_exp_f32 v38, v38
  v_exp_f32 v39, v39
  v_mfma_f32_32x32x16_bf16 v[16:31], v[100:103], v[8:11], 0
  v_exp_f32 v40, v40
  v_exp_f32 v41, v41
  v_exp_f32 v42, v42
  v_smfmac_f32_32x32x32_bf16 v[80:95], v[128:131], v[32:39], v223
  v_exp_f32 v43, v43
  v_exp_f32 v44, v44
  v_exp_f32 v45, v45
  v_exp_f32 v46, v46
  v_exp_f32 v47, v47
  v_exp_f32 v16, v16
  v_exp_f32 v17, v17
  v_exp_f32 v18, v18
  v_exp_f32 v19, v19
  v_exp_f32 v20, v20
  v_smfmac_f32_32x32x32_bf16 v[80:95], v[132:135], v[40:47], v223
  v_exp_f32 v21, v21
  v_exp_f32 v22, v22
  v_exp_f32 v23, v23
  v_mfma_f32_32x32x16_bf16 v[32:47], v[100:103], v[12:15], 0
  v_exp_f32 v24, v24
  v_exp_f32 v25, v25
  v_exp_f32 v26, v26
  v_smfmac_f32_32x32x32_bf16 v[64:79], v[136:139], v[16:23], v223
  v_exp_f32 v27, v27
  v_exp_f32 v28, v28
  v_exp_f32 v29, v29
  v_exp_f32 v30, v30
  v_exp_f32 v31, v31
  v_exp_f32 v32, v32
  v_exp_f32 v33, v33
  v_exp_f32 v34, v34
  v_exp_f32 v35, v35
  v_exp_f32 v36, v36
  v_smfmac_f32_32x32x32_bf16 v[64:79], v[140:143], v[24:31], v223
  s_waitcnt lgkmcnt(0)
  v_exp_f32 v37, v37
  v_exp_f32 v38, v38
  v_exp_f32 v39, v39
  v_mfma_f32_32x32x16_bf16 v[16:31], v[104:107], v[8:11], 0
  v_exp_f32 v40, v40
  v_exp_f32 v41, v41
  v_exp_f32 v42, v42
  v_smfmac_f32_32x32x32_bf16 v[80:95], v[136:139], v[32:39], v223
  v_exp_f32 v43, v43
  v_exp_f32 v44, v44
  v_exp_f32 v45, v45
  v_exp_f32 v46, v46
  v_exp_f32 v47, v47
  v_exp_f32 v16, v16
  v_exp_f32 v17, v17
  v_exp_f32 v18, v18
  v_exp_f32 v19, v19
  v_exp_f32 v20, v20
  v_smfmac_f32_32x32x32_bf16 v[80:95], v[140:143], v[40:47], v223
  v_exp_f32 v21, v21
  v_exp_f32 v22, v22
  v_exp_f32 v23, v23
  v_mfma_f32_32x32x16_bf16 v[32:47], v[104:107], v[12:15], 0
  v_exp_f32 v24, v24
  v_exp_f32 v25, v25
  v_exp_f32 v26, v26
  v_smfmac_f32_32x32x32_bf16 v[64:79], v[144:147], v[16:23], v223
  v_exp_f32 v27, v27
  v_exp_f32 v28, v28
  v_exp_f32 v29, v29
  v_exp_f32 v30, v30
  v_exp_f32 v31, v31
  v_exp_f32 v32, v32
  v_exp_f32 v33, v33
  v_exp_f32 v34, v34
  v_exp_f32 v35, v35
  v_exp_f32 v36, v36
  v_smfmac_f32_32x32x32_bf16 v[64:79], v[148:151], v[24:31], v223
  v_exp_f32 v37, v37
  v_exp_f32 v38, v38
  v_exp_f32 v39, v39
  v_mfma_f32_32x32x16_bf16 v[16:31], v[108:111], v[8:11], 0
  v_exp_f32 v40, v40
  v_exp_f32 v41, v41
  v_exp_f32 v42, v42
  v_smfmac_f32_32x32x32_bf16 v[80:95], v[144:147], v[32:39], v223
  v_exp_f32 v43, v43
  v_exp_f32 v44, v44
  v_exp_f32 v45, v45
  v_exp_f32 v46, v46
  v_exp_f32 v47, v47
  v_exp_f32 v16, v16
  v_exp_f32 v17, v17
  v_exp_f32 v18, v18
  v_exp_f32 v19, v19
  v_exp_f32 v20, v20
  v_smfmac_f32_32x32x32_bf16 v[80:95], v[148:151], v[40:47], v223
  v_exp_f32 v21, v21
  v_exp_f32 v22, v22
  v_exp_f32 v23, v23
  v_mfma_f32_32x32x16_bf16 v[32:47], v[108:111], v[12:15], 0
  v_exp_f32 v24, v24
  v_exp_f32 v25, v25
  v_exp_f32 v26, v26
  v_smfmac_f32_32x32x32_bf16 v[64:79], v[152:155], v[16:23], v223
  v_exp_f32 v27, v27
  v_exp_f32 v28, v28
  v_exp_f32 v29, v29
  v_exp_f32 v30, v30
  v_exp_f32 v31, v31
  v_exp_f32 v32, v32
  v_exp_f32 v33, v33
  v_exp_f32 v34, v34
  v_exp_f32 v35, v35
  v_exp_f32 v36, v36
  v_smfmac_f32_32x32x32_bf16 v[64:79], v[156:159], v[24:31], v223
  v_exp_f32 v37, v37
  v_exp_f32 v38, v38
  v_exp_f32 v39, v39
  v_mfma_f32_32x32x16_bf16 v[16:31], v[112:115], v[8:11], 0
  ds_read_b32 v221, v7 offset:48
  v_exp_f32 v40, v40
  v_exp_f32 v41, v41
  v_exp_f32 v42, v42
  v_smfmac_f32_32x32x32_bf16 v[80:95], v[152:155], v[32:39], v223
  v_exp_f32 v43, v43
  v_exp_f32 v44, v44
  v_exp_f32 v45, v45
  v_exp_f32 v46, v46
  v_exp_f32 v47, v47
  v_exp_f32 v16, v16
  v_exp_f32 v17, v17
  v_exp_f32 v18, v18
  v_exp_f32 v19, v19
  v_exp_f32 v20, v20
  v_smfmac_f32_32x32x32_bf16 v[80:95], v[156:159], v[40:47], v223
  s_waitcnt lgkmcnt(0)
  v_readfirstlane_b32 s56, v221
  v_exp_f32 v21, v21
  v_exp_f32 v22, v22
  v_exp_f32 v23, v23
  v_mfma_f32_32x32x16_bf16 v[32:47], v[112:115], v[12:15], 0
  s_cmp_lt_u32 s56, 3
  s_cbranch_scc1 KG_SP11
KG_SR11:
  ds_read_b128 v[96:99], v216 offset:32768
  ds_read_b128 v[100:103], v216 offset:34816
  ds_read_b128 v[104:107], v216 offset:36864
  ds_read_b128 v[108:111], v216 offset:38912
  s_mov_b64 exec, s[60:61]
  ds_read_b128 v[128:131], v216 offset:33792
  ds_read_b128 v[132:135], v216 offset:34048
  ds_read_b128 v[136:139], v216 offset:35840
  ds_read_b128 v[140:143], v216 offset:36096
  ds_read_b128 v[144:147], v216 offset:37888
  ds_read_b128 v[148:151], v216 offset:38144
  ds_read_b128 v[152:155], v216 offset:39936
  ds_read_b128 v[156:159], v216 offset:40192
  s_mov_b64 exec, -1
  v_exp_f32 v24, v24
  v_exp_f32 v25, v25
  v_exp_f32 v26, v26
  v_smfmac_f32_32x32x32_bf16 v[64:79], v[160:163], v[16:23], v223
  v_exp_f32 v27, v27
  v_exp_f32 v28, v28
  v_exp_f32 v29, v29
  v_exp_f32 v30, v30
  v_exp_f32 v31, v31
  v_exp_f32 v32, v32
  v_exp_f32 v33, v33
  v_exp_f32 v34, v34
  v_exp_f32 v35, v35
  v_exp_f32 v36, v36
  v_smfmac_f32_32x32x32_bf16 v[64:79], v[164:167], v[24:31], v223
  v_exp_f32 v37, v37
  v_exp_f32 v38, v38
  v_exp_f32 v39, v39
  v_mfma_f32_32x32x16_bf16 v[16:31], v[116:119], v[8:11], 0
  v_exp_f32 v40, v40
  v_exp_f32 v41, v41
  v_exp_f32 v42, v42
  v_smfmac_f32_32x32x32_bf16 v[80:95], v[160:163], v[32:39], v223
  v_exp_f32 v43, v43
  v_exp_f32 v44, v44
  v_exp_f32 v45, v45
  v_exp_f32 v46, v46
  v_exp_f32 v47, v47
  v_exp_f32 v16, v16
  v_exp_f32 v17, v17
  v_exp_f32 v18, v18
  v_exp_f32 v19, v19
  v_exp_f32 v20, v20
  v_smfmac_f32_32x32x32_bf16 v[80:95], v[164:167], v[40:47], v223
  v_exp_f32 v21, v21
  v_exp_f32 v22, v22
  v_exp_f32 v23, v23
  v_mfma_f32_32x32x16_bf16 v[32:47], v[116:119], v[12:15], 0
  v_exp_f32 v24, v24
  v_exp_f32 v25, v25
  v_exp_f32 v26, v26
  v_smfmac_f32_32x32x32_bf16 v[64:79], v[168:171], v[16:23], v223
  v_exp_f32 v27, v27
  v_exp_f32 v28, v28
  v_exp_f32 v29, v29
  v_exp_f32 v30, v30
  v_exp_f32 v31, v31
  v_exp_f32 v32, v32
  v_exp_f32 v33, v33
  v_exp_f32 v34, v34
  v_exp_f32 v35, v35
  v_exp_f32 v36, v36
  v_smfmac_f32_32x32x32_bf16 v[64:79], v[172:175], v[24:31], v223
  v_exp_f32 v37, v37
  v_exp_f32 v38, v38
  v_exp_f32 v39, v39
  v_mfma_f32_32x32x16_bf16 v[16:31], v[120:123], v[8:11], 0
  v_exp_f32 v40, v40
  v_exp_f32 v41, v41
  v_exp_f32 v42, v42
  v_smfmac_f32_32x32x32_bf16 v[80:95], v[168:171], v[32:39], v223
  v_exp_f32 v43, v43
  v_exp_f32 v44, v44
  v_exp_f32 v45, v45
  v_exp_f32 v46, v46
  v_exp_f32 v47, v47
  v_exp_f32 v16, v16
  v_exp_f32 v17, v17
  v_exp_f32 v18, v18
  v_exp_f32 v19, v19
  v_exp_f32 v20, v20
  v_smfmac_f32_32x32x32_bf16 v[80:95], v[172:175], v[40:47], v223
  v_exp_f32 v21, v21
  v_exp_f32 v22, v22
  v_exp_f32 v23, v23
  v_mfma_f32_32x32x16_bf16 v[32:47], v[120:123], v[12:15], 0
  v_exp_f32 v24, v24
  v_exp_f32 v25, v25
  v_exp_f32 v26, v26
  v_smfmac_f32_32x32x32_bf16 v[64:79], v[176:179], v[16:23], v223
  v_exp_f32 v27, v27
  v_exp_f32 v28, v28
  v_exp_f32 v29, v29
  v_exp_f32 v30, v30
  v_exp_f32 v31, v31
  v_exp_f32 v32, v32
  v_exp_f32 v33, v33
  v_exp_f32 v34, v34
  v_exp_f32 v35, v35
  v_exp_f32 v36, v36
  v_smfmac_f32_32x32x32_bf16 v[64:79], v[180:183], v[24:31], v223
  v_exp_f32 v37, v37
  v_exp_f32 v38, v38
  v_exp_f32 v39, v39
  v_mfma_f32_32x32x16_bf16 v[16:31], v[124:127], v[8:11], 0
  v_exp_f32 v40, v40
  v_exp_f32 v41, v41
  v_exp_f32 v42, v42
  v_smfmac_f32_32x32x32_bf16 v[80:95], v[176:179], v[32:39], v223
  v_exp_f32 v43, v43
  v_exp_f32 v44, v44
  v_exp_f32 v45, v45
  v_exp_f32 v46, v46
  v_exp_f32 v47, v47
  v_exp_f32 v16, v16
  v_exp_f32 v17, v17
  v_exp_f32 v18, v18
  v_exp_f32 v19, v19
  v_exp_f32 v20, v20
  v_smfmac_f32_32x32x32_bf16 v[80:95], v[180:183], v[40:47], v223
  v_exp_f32 v21, v21
  v_exp_f32 v22, v22
  v_exp_f32 v23, v23
  v_mfma_f32_32x32x16_bf16 v[32:47], v[124:127], v[12:15], 0
  v_exp_f32 v24, v24
  v_exp_f32 v25, v25
  v_exp_f32 v26, v26
  v_smfmac_f32_32x32x32_bf16 v[64:79], v[184:187], v[16:23], v223
  v_exp_f32 v27, v27
  v_exp_f32 v28, v28
  v_exp_f32 v29, v29
  v_exp_f32 v30, v30
  v_exp_f32 v31, v31
  v_exp_f32 v32, v32
  v_exp_f32 v33, v33
  v_exp_f32 v34, v34
  v_exp_f32 v35, v35
  v_exp_f32 v36, v36
  v_smfmac_f32_32x32x32_bf16 v[64:79], v[188:191], v[24:31], v223
  s_waitcnt lgkmcnt(0)
  v_exp_f32 v37, v37
  v_exp_f32 v38, v38
  v_exp_f32 v39, v39
  v_mfma_f32_32x32x16_bf16 v[16:31], v[96:99], v[8:11], 0
  v_exp_f32 v40, v40
  v_exp_f32 v41, v41
  v_exp_f32 v42, v42
  v_smfmac_f32_32x32x32_bf16 v[80:95], v[184:187], v[32:39], v223
  v_exp_f32 v43, v43
  v_exp_f32 v44, v44
  v_exp_f32 v45, v45
  v_exp_f32 v46, v46
  v_exp_f32 v47, v47
  v_exp_f32 v16, v16
  v_exp_f32 v17, v17
  v_exp_f32 v18, v18
  v_exp_f32 v19, v19
  v_exp_f32 v20, v20
  v_smfmac_f32_32x32x32_bf16 v[80:95], v[188:191], v[40:47], v223
  v_exp_f32 v21, v21
  v_exp_f32 v22, v22
  v_exp_f32 v23, v23
  v_mfma_f32_32x32x16_bf16 v[32:47], v[96:99], v[12:15], 0
  ds_read_b128 v[112:115], v216 offset:40960
  ds_read_b128 v[116:119], v216 offset:43008
  ds_read_b128 v[120:123], v216 offset:45056
  ds_read_b128 v[124:127], v216 offset:47104
  s_mov_b64 exec, s[60:61]
  ds_read_b128 v[160:163], v216 offset:41984
  ds_read_b128 v[164:167], v216 offset:42240
  ds_read_b128 v[168:171], v216 offset:44032
  ds_read_b128 v[172:175], v216 offset:44288
  ds_read_b128 v[176:179], v216 offset:46080
  ds_read_b128 v[180:183], v216 offset:46336
  ds_read_b128 v[184:187], v216 offset:48128
  ds_read_b128 v[188:191], v216 offset:48384
  s_mov_b64 exec, -1
  v_exp_f32 v24, v24
  v_exp_f32 v25, v25
  v_exp_f32 v26, v26
  v_smfmac_f32_32x32x32_bf16 v[64:79], v[128:131], v[16:23], v223
  v_exp_f32 v27, v27
  v_exp_f32 v28, v28
  v_exp_f32 v29, v29
  v_exp_f32 v30, v30
  v_exp_f32 v31, v31
  v_exp_f32 v32, v32
  v_exp_f32 v33, v33
  v_exp_f32 v34, v34
  v_exp_f32 v35, v35
  v_exp_f32 v36, v36
  v_smfmac_f32_32x32x32_bf16 v[64:79], v[132:135], v[24:31], v223
  v_exp_f32 v37, v37
  v_exp_f32 v38, v38
  v_exp_f32 v39, v39
  v_mfma_f32_32x32x16_bf16 v[16:31], v[100:103], v[8:11], 0
  v_exp_f32 v40, v40
  v_exp_f32 v41, v41
  v_exp_f32 v42, v42
  v_smfmac_f32_32x32x32_bf16 v[80:95], v[128:131], v[32:39], v223
  v_exp_f32 v43, v43
  v_exp_f32 v44, v44
  v_exp_f32 v45, v45
  v_exp_f32 v46, v46
  v_exp_f32 v47, v47
  v_exp_f32 v16, v16
  v_exp_f32 v17, v17
  v_exp_f32 v18, v18
  v_exp_f32 v19, v19
  v_exp_f32 v20, v20
  v_smfmac_f32_32x32x32_bf16 v[80:95], v[132:135], v[40:47], v223
  v_exp_f32 v21, v21
  v_exp_f32 v22, v22
  v_exp_f32 v23, v23
  v_mfma_f32_32x32x16_bf16 v[32:47], v[100:103], v[12:15], 0
  v_exp_f32 v24, v24
  v_exp_f32 v25, v25
  v_exp_f32 v26, v26
  v_smfmac_f32_32x32x32_bf16 v[64:79], v[136:139], v[16:23], v223
  v_exp_f32 v27, v27
  v_exp_f32 v28, v28
  v_exp_f32 v29, v29
  v_exp_f32 v30, v30
  v_exp_f32 v31, v31
  v_exp_f32 v32, v32
  v_exp_f32 v33, v33
  v_exp_f32 v34, v34
  v_exp_f32 v35, v35
  v_exp_f32 v36, v36
  v_smfmac_f32_32x32x32_bf16 v[64:79], v[140:143], v[24:31], v223
  s_waitcnt lgkmcnt(0)
  v_exp_f32 v37, v37
  v_exp_f32 v38, v38
  v_exp_f32 v39, v39
  v_mfma_f32_32x32x16_bf16 v[16:31], v[104:107], v[8:11], 0
  v_exp_f32 v40, v40
  v_exp_f32 v41, v41
  v_exp_f32 v42, v42
  v_smfmac_f32_32x32x32_bf16 v[80:95], v[136:139], v[32:39], v223
  v_exp_f32 v43, v43
  v_exp_f32 v44, v44
  v_exp_f32 v45, v45
  v_exp_f32 v46, v46
  v_exp_f32 v47, v47
  v_exp_f32 v16, v16
  v_exp_f32 v17, v17
  v_exp_f32 v18, v18
  v_exp_f32 v19, v19
  v_exp_f32 v20, v20
  v_smfmac_f32_32x32x32_bf16 v[80:95], v[140:143], v[40:47], v223
  v_exp_f32 v21, v21
  v_exp_f32 v22, v22
  v_exp_f32 v23, v23
  v_mfma_f32_32x32x16_bf16 v[32:47], v[104:107], v[12:15], 0
  v_exp_f32 v24, v24
  v_exp_f32 v25, v25
  v_exp_f32 v26, v26
  v_smfmac_f32_32x32x32_bf16 v[64:79], v[144:147], v[16:23], v223
  v_exp_f32 v27, v27
  v_exp_f32 v28, v28
  v_exp_f32 v29, v29
  v_exp_f32 v30, v30
  v_exp_f32 v31, v31
  v_exp_f32 v32, v32
  v_exp_f32 v33, v33
  v_exp_f32 v34, v34
  v_exp_f32 v35, v35
  v_exp_f32 v36, v36
  v_smfmac_f32_32x32x32_bf16 v[64:79], v[148:151], v[24:31], v223
  v_exp_f32 v37, v37
  v_exp_f32 v38, v38
  v_exp_f32 v39, v39
  v_mfma_f32_32x32x16_bf16 v[16:31], v[108:111], v[8:11], 0
  v_exp_f32 v40, v40
  v_exp_f32 v41, v41
  v_exp_f32 v42, v42
  v_smfmac_f32_32x32x32_bf16 v[80:95], v[144:147], v[32:39], v223
  v_exp_f32 v43, v43
  v_exp_f32 v44, v44
  v_exp_f32 v45, v45
  v_exp_f32 v46, v46
  v_exp_f32 v47, v47
  v_exp_f32 v16, v16
  v_exp_f32 v17, v17
  v_exp_f32 v18, v18
  v_exp_f32 v19, v19
  v_exp_f32 v20, v20
  v_smfmac_f32_32x32x32_bf16 v[80:95], v[148:151], v[40:47], v223
  v_exp_f32 v21, v21
  v_exp_f32 v22, v22
  v_exp_f32 v23, v23
  v_mfma_f32_32x32x16_bf16 v[32:47], v[108:111], v[12:15], 0
  v_exp_f32 v24, v24
  v_exp_f32 v25, v25
  v_exp_f32 v26, v26
  v_smfmac_f32_32x32x32_bf16 v[64:79], v[152:155], v[16:23], v223
  v_exp_f32 v27, v27
  v_exp_f32 v28, v28
  v_exp_f32 v29, v29
  v_exp_f32 v30, v30
  v_exp_f32 v31, v31
  v_exp_f32 v32, v32
  v_exp_f32 v33, v33
  v_exp_f32 v34, v34
  v_exp_f32 v35, v35
  v_exp_f32 v36, v36
  v_smfmac_f32_32x32x32_bf16 v[64:79], v[156:159], v[24:31], v223
  v_exp_f32 v37, v37
  v_exp_f32 v38, v38
  v_exp_f32 v39, v39
  v_mfma_f32_32x32x16_bf16 v[16:31], v[112:115], v[8:11], 0
  v_exp_f32 v40, v40
  v_exp_f32 v41, v41
  v_exp_f32 v42, v42
  v_smfmac_f32_32x32x32_bf16 v[80:95], v[152:155], v[32:39], v223
  v_exp_f32 v43, v43
  v_exp_f32 v44, v44
  v_exp_f32 v45, v45
  v_exp_f32 v46, v46
  v_exp_f32 v47, v47
  v_exp_f32 v16, v16
  v_exp_f32 v17, v17
  v_exp_f32 v18, v18
  v_exp_f32 v19, v19
  v_exp_f32 v20, v20
  v_smfmac_f32_32x32x32_bf16 v[80:95], v[156:159], v[40:47], v223
  v_exp_f32 v21, v21
  v_exp_f32 v22, v22
  v_exp_f32 v23, v23
  v_mfma_f32_32x32x16_bf16 v[32:47], v[112:115], v[12:15], 0
  s_cmp_lt_u32 s56, 4
  s_cbranch_scc1 KG_SP12
KG_SR12:
  ds_read_b128 v[96:99], v216 offset:49152
  ds_read_b128 v[100:103], v216 offset:51200
  ds_read_b128 v[104:107], v216 offset:53248
  ds_read_b128 v[108:111], v216 offset:55296
  s_mov_b64 exec, s[60:61]
  ds_read_b128 v[128:131], v216 offset:50176
  ds_read_b128 v[132:135], v216 offset:50432
  ds_read_b128 v[136:139], v216 offset:52224
  ds_read_b128 v[140:143], v216 offset:52480
  ds_read_b128 v[144:147], v216 offset:54272
  ds_read_b128 v[148:151], v216 offset:54528
  ds_read_b128 v[152:155], v216 offset:56320
  ds_read_b128 v[156:159], v216 offset:56576
  s_mov_b64 exec, -1
  v_exp_f32 v24, v24
  v_exp_f32 v25, v25
  v_exp_f32 v26, v26
  v_smfmac_f32_32x32x32_bf16 v[64:79], v[160:163], v[16:23], v223
  v_exp_f32 v27, v27
  v_exp_f32 v28, v28
  v_exp_f32 v29, v29
  v_exp_f32 v30, v30
  v_exp_f32 v31, v31
  v_exp_f32 v32, v32
  v_exp_f32 v33, v33
  v_exp_f32 v34, v34
  v_exp_f32 v35, v35
  v_exp_f32 v36, v36
  v_smfmac_f32_32x32x32_bf16 v[64:79], v[164:167], v[24:31], v223
  v_exp_f32 v37, v37
  v_exp_f32 v38, v38
  v_exp_f32 v39, v39
  v_mfma_f32_32x32x16_bf16 v[16:31], v[116:119], v[8:11], 0
  v_exp_f32 v40, v40
  v_exp_f32 v41, v41
  v_exp_f32 v42, v42
  v_smfmac_f32_32x32x32_bf16 v[80:95], v[160:163], v[32:39], v223
  v_exp_f32 v43, v43
  v_exp_f32 v44, v44
  v_exp_f32 v45, v45
  v_exp_f32 v46, v46
  v_exp_f32 v47, v47
  v_exp_f32 v16, v16
  v_exp_f32 v17, v17
  v_exp_f32 v18, v18
  v_exp_f32 v19, v19
  v_exp_f32 v20, v20
  v_smfmac_f32_32x32x32_bf16 v[80:95], v[164:167], v[40:47], v223
  v_exp_f32 v21, v21
  v_exp_f32 v22, v22
  v_exp_f32 v23, v23
  v_mfma_f32_32x32x16_bf16 v[32:47], v[116:119], v[12:15], 0
  v_exp_f32 v24, v24
  v_exp_f32 v25, v25
  v_exp_f32 v26, v26
  v_smfmac_f32_32x32x32_bf16 v[64:79], v[168:171], v[16:23], v223
  v_exp_f32 v27, v27
  v_exp_f32 v28, v28
  v_exp_f32 v29, v29
  v_exp_f32 v30, v30
  v_exp_f32 v31, v31
  v_exp_f32 v32, v32
  v_exp_f32 v33, v33
  v_exp_f32 v34, v34
  v_exp_f32 v35, v35
  v_exp_f32 v36, v36
  v_smfmac_f32_32x32x32_bf16 v[64:79], v[172:175], v[24:31], v223
  v_exp_f32 v37, v37
  v_exp_f32 v38, v38
  v_exp_f32 v39, v39
  v_mfma_f32_32x32x16_bf16 v[16:31], v[120:123], v[8:11], 0
  v_exp_f32 v40, v40
  v_exp_f32 v41, v41
  v_exp_f32 v42, v42
  v_smfmac_f32_32x32x32_bf16 v[80:95], v[168:171], v[32:39], v223
  v_exp_f32 v43, v43
  v_exp_f32 v44, v44
  v_exp_f32 v45, v45
  v_exp_f32 v46, v46
  v_exp_f32 v47, v47
  v_exp_f32 v16, v16
  v_exp_f32 v17, v17
  v_exp_f32 v18, v18
  v_exp_f32 v19, v19
  v_exp_f32 v20, v20
  v_smfmac_f32_32x32x32_bf16 v[80:95], v[172:175], v[40:47], v223
  v_exp_f32 v21, v21
  v_exp_f32 v22, v22
  v_exp_f32 v23, v23
  v_mfma_f32_32x32x16_bf16 v[32:47], v[120:123], v[12:15], 0
  v_exp_f32 v24, v24
  v_exp_f32 v25, v25
  v_exp_f32 v26, v26
  v_smfmac_f32_32x32x32_bf16 v[64:79], v[176:179], v[16:23], v223
  v_exp_f32 v27, v27
  v_exp_f32 v28, v28
  v_exp_f32 v29, v29
  v_exp_f32 v30, v30
  v_exp_f32 v31, v31
  v_exp_f32 v32, v32
  v_exp_f32 v33, v33
  v_exp_f32 v34, v34
  v_exp_f32 v35, v35
  v_exp_f32 v36, v36
  v_smfmac_f32_32x32x32_bf16 v[64:79], v[180:183], v[24:31], v223
  v_exp_f32 v37, v37
  v_exp_f32 v38, v38
  v_exp_f32 v39, v39
  v_mfma_f32_32x32x16_bf16 v[16:31], v[124:127], v[8:11], 0
  v_exp_f32 v40, v40
  v_exp_f32 v41, v41
  v_exp_f32 v42, v42
  v_smfmac_f32_32x32x32_bf16 v[80:95], v[176:179], v[32:39], v223
  v_exp_f32 v43, v43
  v_exp_f32 v44, v44
  v_exp_f32 v45, v45
  v_exp_f32 v46, v46
  v_exp_f32 v47, v47
  v_exp_f32 v16, v16
  v_exp_f32 v17, v17
  v_exp_f32 v18, v18
  v_exp_f32 v19, v19
  v_exp_f32 v20, v20
  v_smfmac_f32_32x32x32_bf16 v[80:95], v[180:183], v[40:47], v223
  v_exp_f32 v21, v21
  v_exp_f32 v22, v22
  v_exp_f32 v23, v23
  v_mfma_f32_32x32x16_bf16 v[32:47], v[124:127], v[12:15], 0
  v_exp_f32 v24, v24
  v_exp_f32 v25, v25
  v_exp_f32 v26, v26
  v_smfmac_f32_32x32x32_bf16 v[64:79], v[184:187], v[16:23], v223
  v_exp_f32 v27, v27
  v_exp_f32 v28, v28
  v_exp_f32 v29, v29
  v_exp_f32 v30, v30
  v_exp_f32 v31, v31
  v_exp_f32 v32, v32
  v_exp_f32 v33, v33
  v_exp_f32 v34, v34
  v_exp_f32 v35, v35
  v_exp_f32 v36, v36
  v_smfmac_f32_32x32x32_bf16 v[64:79], v[188:191], v[24:31], v223
  s_waitcnt lgkmcnt(0)
  v_exp_f32 v37, v37
  v_exp_f32 v38, v38
  v_exp_f32 v39, v39
  v_mfma_f32_32x32x16_bf16 v[16:31], v[96:99], v[8:11], 0
  v_exp_f32 v40, v40
  v_exp_f32 v41, v41
  v_exp_f32 v42, v42
  v_smfmac_f32_32x32x32_bf16 v[80:95], v[184:187], v[32:39], v223
  v_exp_f32 v43, v43
  v_exp_f32 v44, v44
  v_exp_f32 v45, v45
  v_exp_f32 v46, v46
  v_exp_f32 v47, v47
  v_exp_f32 v16, v16
  v_exp_f32 v17, v17
  v_exp_f32 v18, v18
  v_exp_f32 v19, v19
  v_exp_f32 v20, v20
  v_smfmac_f32_32x32x32_bf16 v[80:95], v[188:191], v[40:47], v223
  v_exp_f32 v21, v21
  v_exp_f32 v22, v22
  v_exp_f32 v23, v23
  v_mfma_f32_32x32x16_bf16 v[32:47], v[96:99], v[12:15], 0
  ds_read_b128 v[112:115], v216 offset:57344
  ds_read_b128 v[116:119], v216 offset:59392
  ds_read_b128 v[120:123], v216 offset:61440
  ds_read_b128 v[124:127], v216 offset:63488
  s_mov_b64 exec, s[60:61]
  ds_read_b128 v[160:163], v216 offset:58368
  ds_read_b128 v[164:167], v216 offset:58624
  ds_read_b128 v[168:171], v216 offset:60416
  ds_read_b128 v[172:175], v216 offset:60672
  ds_read_b128 v[176:179], v216 offset:62464
  ds_read_b128 v[180:183], v216 offset:62720
  ds_read_b128 v[184:187], v216 offset:64512
  ds_read_b128 v[188:191], v216 offset:64768
  s_mov_b64 exec, -1
  v_exp_f32 v24, v24
  v_exp_f32 v25, v25
  v_exp_f32 v26, v26
  v_smfmac_f32_32x32x32_bf16 v[64:79], v[128:131], v[16:23], v223
  v_exp_f32 v27, v27
  v_exp_f32 v28, v28
  v_exp_f32 v29, v29
  v_exp_f32 v30, v30
  v_exp_f32 v31, v31
  v_exp_f32 v32, v32
  v_exp_f32 v33, v33
  v_exp_f32 v34, v34
  v_exp_f32 v35, v35
  v_exp_f32 v36, v36
  v_smfmac_f32_32x32x32_bf16 v[64:79], v[132:135], v[24:31], v223
  v_exp_f32 v37, v37
  v_exp_f32 v38, v38
  v_exp_f32 v39, v39
  v_mfma_f32_32x32x16_bf16 v[16:31], v[100:103], v[8:11], 0
  v_exp_f32 v40, v40
  v_exp_f32 v41, v41
  v_exp_f32 v42, v42
  v_smfmac_f32_32x32x32_bf16 v[80:95], v[128:131], v[32:39], v223
  v_exp_f32 v43, v43
  v_exp_f32 v44, v44
  v_exp_f32 v45, v45
  v_exp_f32 v46, v46
  v_exp_f32 v47, v47
  v_exp_f32 v16, v16
  v_exp_f32 v17, v17
  v_exp_f32 v18, v18
  v_exp_f32 v19, v19
  v_exp_f32 v20, v20
  v_smfmac_f32_32x32x32_bf16 v[80:95], v[132:135], v[40:47], v223
  v_exp_f32 v21, v21
  v_exp_f32 v22, v22
  v_exp_f32 v23, v23
  v_mfma_f32_32x32x16_bf16 v[32:47], v[100:103], v[12:15], 0
  v_exp_f32 v24, v24
  v_exp_f32 v25, v25
  v_exp_f32 v26, v26
  v_smfmac_f32_32x32x32_bf16 v[64:79], v[136:139], v[16:23], v223
  v_exp_f32 v27, v27
  v_exp_f32 v28, v28
  v_exp_f32 v29, v29
  v_exp_f32 v30, v30
  v_exp_f32 v31, v31
  v_exp_f32 v32, v32
  v_exp_f32 v33, v33
  v_exp_f32 v34, v34
  v_exp_f32 v35, v35
  v_exp_f32 v36, v36
  v_smfmac_f32_32x32x32_bf16 v[64:79], v[140:143], v[24:31], v223
  s_waitcnt lgkmcnt(0)
  v_exp_f32 v37, v37
  v_exp_f32 v38, v38
  v_exp_f32 v39, v39
  v_mfma_f32_32x32x16_bf16 v[16:31], v[104:107], v[8:11], 0
  ds_write_b32 v208, v219 offset:16
  v_exp_f32 v40, v40
  v_exp_f32 v41, v41
  v_exp_f32 v42, v42
  v_smfmac_f32_32x32x32_bf16 v[80:95], v[136:139], v[32:39], v223
  v_exp_f32 v43, v43
  v_exp_f32 v44, v44
  v_exp_f32 v45, v45
  v_exp_f32 v46, v46
  v_exp_f32 v47, v47
  v_exp_f32 v16, v16
  v_exp_f32 v17, v17
  v_exp_f32 v18, v18
  v_exp_f32 v19, v19
  v_exp_f32 v20, v20
  v_smfmac_f32_32x32x32_bf16 v[80:95], v[140:143], v[40:47], v223
  v_exp_f32 v21, v21
  v_exp_f32 v22, v22
  v_exp_f32 v23, v23
  v_mfma_f32_32x32x16_bf16 v[32:47], v[104:107], v[12:15], 0
  v_exp_f32 v24, v24
  v_exp_f32 v25, v25
  v_exp_f32 v26, v26
  v_smfmac_f32_32x32x32_bf16 v[64:79], v[144:147], v[16:23], v223
  v_exp_f32 v27, v27
  v_exp_f32 v28, v28
  v_exp_f32 v29, v29
  v_exp_f32 v30, v30
  v_exp_f32 v31, v31
  v_exp_f32 v32, v32
  v_exp_f32 v33, v33
  v_exp_f32 v34, v34
  v_exp_f32 v35, v35
  v_exp_f32 v36, v36
  v_smfmac_f32_32x32x32_bf16 v[64:79], v[148:151], v[24:31], v223
  v_exp_f32 v37, v37
  v_exp_f32 v38, v38
  v_exp_f32 v39, v39
  v_mfma_f32_32x32x16_bf16 v[16:31], v[108:111], v[8:11], 0
  v_exp_f32 v40, v40
  v_exp_f32 v41, v41
  v_exp_f32 v42, v42
  v_smfmac_f32_32x32x32_bf16 v[80:95], v[144:147], v[32:39], v223
  v_exp_f32 v43, v43
  v_exp_f32 v44, v44
  v_exp_f32 v45, v45
  v_exp_f32 v46, v46
  v_exp_f32 v47, v47
  v_exp_f32 v16, v16
  v_exp_f32 v17, v17
  v_exp_f32 v18, v18
  v_exp_f32 v19, v19
  v_exp_f32 v20, v20
  v_smfmac_f32_32x32x32_bf16 v[80:95], v[148:151], v[40:47], v223
  v_exp_f32 v21, v21
  v_exp_f32 v22, v22
  v_exp_f32 v23, v23
  v_mfma_f32_32x32x16_bf16 v[32:47], v[108:111], v[12:15], 0
  v_exp_f32 v24, v24
  v_exp_f32 v25, v25
  v_exp_f32 v26, v26
  v_smfmac_f32_32x32x32_bf16 v[64:79], v[152:155], v[16:23], v223
  v_exp_f32 v27, v27
  v_exp_f32 v28, v28
  v_exp_f32 v29, v29
  v_exp_f32 v30, v30
  v_exp_f32 v31, v31
  v_exp_f32 v32, v32
  v_exp_f32 v33, v33
  v_exp_f32 v34, v34
  v_exp_f32 v35, v35
  v_exp_f32 v36, v36
  v_smfmac_f32_32x32x32_bf16 v[64:79], v[156:159], v[24:31], v223
  v_exp_f32 v37, v37
  v_exp_f32 v38, v38
  v_exp_f32 v39, v39
  v_mfma_f32_32x32x16_bf16 v[16:31], v[112:115], v[8:11], 0
  ds_read_b32 v221, v7 offset:48
  v_exp_f32 v40, v40
  v_exp_f32 v41, v41
  v_exp_f32 v42, v42
  v_smfmac_f32_32x32x32_bf16 v[80:95], v[152:155], v[32:39], v223
  v_exp_f32 v43, v43
  v_exp_f32 v44, v44
  v_exp_f32 v45, v45
  v_exp_f32 v46, v46
  v_exp_f32 v47, v47
  v_exp_f32 v16, v16
  v_exp_f32 v17, v17
  v_exp_f32 v18, v18
  v_exp_f32 v19, v19
  v_exp_f32 v20, v20
  v_smfmac_f32_32x32x32_bf16 v[80:95], v[156:159], v[40:47], v223
  s_waitcnt lgkmcnt(0)
  v_readfirstlane_b32 s56, v221
  v_exp_f32 v21, v21
  v_exp_f32 v22, v22
  v_exp_f32 v23, v23
  v_mfma_f32_32x32x16_bf16 v[32:47], v[112:115], v[12:15], 0
  s_cmp_lt_u32 s56, 8
  s_cbranch_scc1 KG_SP13
KG_SR13:
  ds_read_b128 v[96:99], v2 offset:0
  ds_read_b128 v[100:103], v2 offset:2048
  ds_read_b128 v[104:107], v2 offset:4096
  ds_read_b128 v[108:111], v2 offset:6144
  s_mov_b64 exec, s[60:61]
  ds_read_b128 v[128:131], v2 offset:1024
  ds_read_b128 v[132:135], v2 offset:1280
  ds_read_b128 v[136:139], v2 offset:3072
  ds_read_b128 v[140:143], v2 offset:3328
  ds_read_b128 v[144:147], v2 offset:5120
  ds_read_b128 v[148:151], v2 offset:5376
  ds_read_b128 v[152:155], v2 offset:7168
  ds_read_b128 v[156:159], v2 offset:7424
  s_mov_b64 exec, -1
  v_exp_f32 v24, v24
  v_exp_f32 v25, v25
  v_exp_f32 v26, v26
  v_smfmac_f32_32x32x32_bf16 v[64:79], v[160:163], v[16:23], v223
  v_exp_f32 v27, v27
  v_exp_f32 v28, v28
  v_exp_f32 v29, v29
  v_exp_f32 v30, v30
  v_exp_f32 v31, v31
  v_exp_f32 v32, v32
  v_exp_f32 v33, v33
  v_exp_f32 v34, v34
  v_exp_f32 v35, v35
  v_exp_f32 v36, v36
  v_smfmac_f32_32x32x32_bf16 v[64:79], v[164:167], v[24:31], v223
  v_exp_f32 v37, v37
  v_exp_f32 v38, v38
  v_exp_f32 v39, v39
  v_mfma_f32_32x32x16_bf16 v[16:31], v[116:119], v[8:11], 0
  v_exp_f32 v40, v40
  v_exp_f32 v41, v41
  v_exp_f32 v42, v42
  v_smfmac_f32_32x32x32_bf16 v[80:95], v[160:163], v[32:39], v223
  v_exp_f32 v43, v43
  v_exp_f32 v44, v44
  v_exp_f32 v45, v45
  v_exp_f32 v46, v46
  v_exp_f32 v47, v47
  v_exp_f32 v16, v16
  v_exp_f32 v17, v17
  v_exp_f32 v18, v18
  v_exp_f32 v19, v19
  v_exp_f32 v20, v20
  v_smfmac_f32_32x32x32_bf16 v[80:95], v[164:167], v[40:47], v223
  v_exp_f32 v21, v21
  v_exp_f32 v22, v22
  v_exp_f32 v23, v23
  v_mfma_f32_32x32x16_bf16 v[32:47], v[116:119], v[12:15], 0
  v_exp_f32 v24, v24
  v_exp_f32 v25, v25
  v_exp_f32 v26, v26
  v_smfmac_f32_32x32x32_bf16 v[64:79], v[168:171], v[16:23], v223
  v_exp_f32 v27, v27
  v_exp_f32 v28, v28
  v_exp_f32 v29, v29
  v_exp_f32 v30, v30
  v_exp_f32 v31, v31
  v_exp_f32 v32, v32
  v_exp_f32 v33, v33
  v_exp_f32 v34, v34
  v_exp_f32 v35, v35
  v_exp_f32 v36, v36
  v_smfmac_f32_32x32x32_bf16 v[64:79], v[172:175], v[24:31], v223
  v_exp_f32 v37, v37
  v_exp_f32 v38, v38
  v_exp_f32 v39, v39
  v_mfma_f32_32x32x16_bf16 v[16:31], v[120:123], v[8:11], 0
  v_exp_f32 v40, v40
  v_exp_f32 v41, v41
  v_exp_f32 v42, v42
  v_smfmac_f32_32x32x32_bf16 v[80:95], v[168:171], v[32:39], v223
  v_exp_f32 v43, v43
  v_exp_f32 v44, v44
  v_exp_f32 v45, v45
  v_exp_f32 v46, v46
  v_exp_f32 v47, v47
  v_exp_f32 v16, v16
  v_exp_f32 v17, v17
  v_exp_f32 v18, v18
  v_exp_f32 v19, v19
  v_exp_f32 v20, v20
  v_smfmac_f32_32x32x32_bf16 v[80:95], v[172:175], v[40:47], v223
  v_exp_f32 v21, v21
  v_exp_f32 v22, v22
  v_exp_f32 v23, v23
  v_mfma_f32_32x32x16_bf16 v[32:47], v[120:123], v[12:15], 0
  v_exp_f32 v24, v24
  v_exp_f32 v25, v25
  v_exp_f32 v26, v26
  v_smfmac_f32_32x32x32_bf16 v[64:79], v[176:179], v[16:23], v223
  v_exp_f32 v27, v27
  v_exp_f32 v28, v28
  v_exp_f32 v29, v29
  v_exp_f32 v30, v30
  v_exp_f32 v31, v31
  v_exp_f32 v32, v32
  v_exp_f32 v33, v33
  v_exp_f32 v34, v34
  v_exp_f32 v35, v35
  v_exp_f32 v36, v36
  v_smfmac_f32_32x32x32_bf16 v[64:79], v[180:183], v[24:31], v223
  v_exp_f32 v37, v37
  v_exp_f32 v38, v38
  v_exp_f32 v39, v39
  v_mfma_f32_32x32x16_bf16 v[16:31], v[124:127], v[8:11], 0
  v_exp_f32 v40, v40
  v_exp_f32 v41, v41
  v_exp_f32 v42, v42
  v_smfmac_f32_32x32x32_bf16 v[80:95], v[176:179], v[32:39], v223
  v_exp_f32 v43, v43
  v_exp_f32 v44, v44
  v_exp_f32 v45, v45
  v_exp_f32 v46, v46
  v_exp_f32 v47, v47
  v_exp_f32 v16, v16
  v_exp_f32 v17, v17
  v_exp_f32 v18, v18
  v_exp_f32 v19, v19
  v_exp_f32 v20, v20
  v_smfmac_f32_32x32x32_bf16 v[80:95], v[180:183], v[40:47], v223
  v_exp_f32 v21, v21
  v_exp_f32 v22, v22
  v_exp_f32 v23, v23
  v_mfma_f32_32x32x16_bf16 v[32:47], v[124:127], v[12:15], 0
  v_exp_f32 v24, v24
  v_exp_f32 v25, v25
  v_exp_f32 v26, v26
  v_smfmac_f32_32x32x32_bf16 v[64:79], v[184:187], v[16:23], v223
  v_exp_f32 v27, v27
  v_exp_f32 v28, v28
  v_exp_f32 v29, v29
  v_exp_f32 v30, v30
  v_exp_f32 v31, v31
  v_exp_f32 v32, v32
  v_exp_f32 v33, v33
  v_exp_f32 v34, v34
  v_exp_f32 v35, v35
  v_exp_f32 v36, v36
  v_smfmac_f32_32x32x32_bf16 v[64:79], v[188:191], v[24:31], v223
  s_waitcnt lgkmcnt(0)
  v_exp_f32 v37, v37
  v_exp_f32 v38, v38
  v_exp_f32 v39, v39
  v_mfma_f32_32x32x16_bf16 v[16:31], v[96:99], v[8:11], 0
  v_exp_f32 v40, v40
  v_exp_f32 v41, v41
  v_exp_f32 v42, v42
  v_smfmac_f32_32x32x32_bf16 v[80:95], v[184:187], v[32:39], v223
  v_exp_f32 v43, v43
  v_exp_f32 v44, v44
  v_exp_f32 v45, v45
  v_exp_f32 v46, v46
  v_exp_f32 v47, v47
  v_exp_f32 v16, v16
  v_exp_f32 v17, v17
  v_exp_f32 v18, v18
  v_exp_f32 v19, v19
  v_exp_f32 v20, v20
  v_smfmac_f32_32x32x32_bf16 v[80:95], v[188:191], v[40:47], v223
  v_exp_f32 v21, v21
  v_exp_f32 v22, v22
  v_exp_f32 v23, v23
  v_mfma_f32_32x32x16_bf16 v[32:47], v[96:99], v[12:15], 0
  ds_read_b128 v[112:115], v2 offset:8192
  ds_read_b128 v[116:119], v2 offset:10240
  ds_read_b128 v[120:123], v2 offset:12288
  ds_read_b128 v[124:127], v2 offset:14336
  s_mov_b64 exec, s[60:61]
  ds_read_b128 v[160:163], v2 offset:9216
  ds_read_b128 v[164:167], v2 offset:9472
  ds_read_b128 v[168:171], v2 offset:11264
  ds_read_b128 v[172:175], v2 offset:11520
  ds_read_b128 v[176:179], v2 offset:13312
  ds_read_b128 v[180:183], v2 offset:13568
  ds_read_b128 v[184:187], v2 offset:15360
  ds_read_b128 v[188:191], v2 offset:15616
  s_mov_b64 exec, -1
  v_exp_f32 v24, v24
  v_exp_f32 v25, v25
  v_exp_f32 v26, v26
  v_smfmac_f32_32x32x32_bf16 v[64:79], v[128:131], v[16:23], v223
  v_exp_f32 v27, v27
  v_exp_f32 v28, v28
  v_exp_f32 v29, v29
  v_exp_f32 v30, v30
  v_exp_f32 v31, v31
  v_exp_f32 v32, v32
  v_exp_f32 v33, v33
  v_exp_f32 v34, v34
  v_exp_f32 v35, v35
  v_exp_f32 v36, v36
  v_smfmac_f32_32x32x32_bf16 v[64:79], v[132:135], v[24:31], v223
  v_exp_f32 v37, v37
  v_exp_f32 v38, v38
  v_exp_f32 v39, v39
  v_mfma_f32_32x32x16_bf16 v[16:31], v[100:103], v[8:11], 0
  v_exp_f32 v40, v40
  v_exp_f32 v41, v41
  v_exp_f32 v42, v42
  v_smfmac_f32_32x32x32_bf16 v[80:95], v[128:131], v[32:39], v223
  v_exp_f32 v43, v43
  v_exp_f32 v44, v44
  v_exp_f32 v45, v45
  v_exp_f32 v46, v46
  v_exp_f32 v47, v47
  v_exp_f32 v16, v16
  v_exp_f32 v17, v17
  v_exp_f32 v18, v18
  v_exp_f32 v19, v19
  v_exp_f32 v20, v20
  v_smfmac_f32_32x32x32_bf16 v[80:95], v[132:135], v[40:47], v223
  v_exp_f32 v21, v21
  v_exp_f32 v22, v22
  v_exp_f32 v23, v23
  v_mfma_f32_32x32x16_bf16 v[32:47], v[100:103], v[12:15], 0
  v_exp_f32 v24, v24
  v_exp_f32 v25, v25
  v_exp_f32 v26, v26
  v_smfmac_f32_32x32x32_bf16 v[64:79], v[136:139], v[16:23], v223
  v_exp_f32 v27, v27
  v_exp_f32 v28, v28
  v_exp_f32 v29, v29
  v_exp_f32 v30, v30
  v_exp_f32 v31, v31
  v_exp_f32 v32, v32
  v_exp_f32 v33, v33
  v_exp_f32 v34, v34
  v_exp_f32 v35, v35
  v_exp_f32 v36, v36
  v_smfmac_f32_32x32x32_bf16 v[64:79], v[140:143], v[24:31], v223
  s_waitcnt lgkmcnt(0)
  v_exp_f32 v37, v37
  v_exp_f32 v38, v38
  v_exp_f32 v39, v39
  v_mfma_f32_32x32x16_bf16 v[16:31], v[104:107], v[8:11], 0
  v_exp_f32 v40, v40
  v_exp_f32 v41, v41
  v_exp_f32 v42, v42
  v_smfmac_f32_32x32x32_bf16 v[80:95], v[136:139], v[32:39], v223
  v_exp_f32 v43, v43
  v_exp_f32 v44, v44
  v_exp_f32 v45, v45
  v_exp_f32 v46, v46
  v_exp_f32 v47, v47
  v_exp_f32 v16, v16
  v_exp_f32 v17, v17
  v_exp_f32 v18, v18
  v_exp_f32 v19, v19
  v_exp_f32 v20, v20
  v_smfmac_f32_32x32x32_bf16 v[80:95], v[140:143], v[40:47], v223
  v_exp_f32 v21, v21
  v_exp_f32 v22, v22
  v_exp_f32 v23, v23
  v_mfma_f32_32x32x16_bf16 v[32:47], v[104:107], v[12:15], 0
  v_exp_f32 v24, v24
  v_exp_f32 v25, v25
  v_exp_f32 v26, v26
  v_smfmac_f32_32x32x32_bf16 v[64:79], v[144:147], v[16:23], v223
  v_exp_f32 v27, v27
  v_exp_f32 v28, v28
  v_exp_f32 v29, v29
  v_exp_f32 v30, v30
  v_exp_f32 v31, v31
  v_exp_f32 v32, v32
  v_exp_f32 v33, v33
  v_exp_f32 v34, v34
  v_exp_f32 v35, v35
  v_exp_f32 v36, v36
  v_smfmac_f32_32x32x32_bf16 v[64:79], v[148:151], v[24:31], v223
  v_exp_f32 v37, v37
  v_exp_f32 v38, v38
  v_exp_f32 v39, v39
  v_mfma_f32_32x32x16_bf16 v[16:31], v[108:111], v[8:11], 0
  v_exp_f32 v40, v40
  v_exp_f32 v41, v41
  v_exp_f32 v42, v42
  v_smfmac_f32_32x32x32_bf16 v[80:95], v[144:147], v[32:39], v223
  v_exp_f32 v43, v43
  v_exp_f32 v44, v44
  v_exp_f32 v45, v45
  v_exp_f32 v46, v46
  v_exp_f32 v47, v47
  v_exp_f32 v16, v16
  v_exp_f32 v17, v17
  v_exp_f32 v18, v18
  v_exp_f32 v19, v19
  v_exp_f32 v20, v20
  v_smfmac_f32_32x32x32_bf16 v[80:95], v[148:151], v[40:47], v223
  v_exp_f32 v21, v21
  v_exp_f32 v22, v22
  v_exp_f32 v23, v23
  v_mfma_f32_32x32x16_bf16 v[32:47], v[108:111], v[12:15], 0
  v_exp_f32 v24, v24
  v_exp_f32 v25, v25
  v_exp_f32 v26, v26
  v_smfmac_f32_32x32x32_bf16 v[64:79], v[152:155], v[16:23], v223
  v_exp_f32 v27, v27
  v_exp_f32 v28, v28
  v_exp_f32 v29, v29
  v_exp_f32 v30, v30
  v_exp_f32 v31, v31
  v_exp_f32 v32, v32
  v_exp_f32 v33, v33
  v_exp_f32 v34, v34
  v_exp_f32 v35, v35
  v_exp_f32 v36, v36
  v_smfmac_f32_32x32x32_bf16 v[64:79], v[156:159], v[24:31], v223
  v_exp_f32 v37, v37
  v_exp_f32 v38, v38
  v_exp_f32 v39, v39
  v_mfma_f32_32x32x16_bf16 v[16:31], v[112:115], v[8:11], 0
  v_exp_f32 v40, v40
  v_exp_f32 v41, v41
  v_exp_f32 v42, v42
  v_smfmac_f32_32x32x32_bf16 v[80:95], v[152:155], v[32:39], v223
  v_exp_f32 v43, v43
  v_exp_f32 v44, v44
  v_exp_f32 v45, v45
  v_exp_f32 v46, v46
  v_exp_f32 v47, v47
  v_exp_f32 v16, v16
  v_exp_f32 v17, v17
  v_exp_f32 v18, v18
  v_exp_f32 v19, v19
  v_exp_f32 v20, v20
  v_smfmac_f32_32x32x32_bf16 v[80:95], v[156:159], v[40:47], v223
  v_exp_f32 v21, v21
  v_exp_f32 v22, v22
  v_exp_f32 v23, v23
  v_mfma_f32_32x32x16_bf16 v[32:47], v[112:115], v[12:15], 0
  ds_read_b128 v[96:99], v2 offset:16384
  ds_read_b128 v[100:103], v2 offset:18432
  ds_read_b128 v[104:107], v2 offset:20480
  ds_read_b128 v[108:111], v2 offset:22528
  s_mov_b64 exec, s[60:61]
  ds_read_b128 v[128:131], v2 offset:17408
  ds_read_b128 v[132:135], v2 offset:17664
  ds_read_b128 v[136:139], v2 offset:19456
  ds_read_b128 v[140:143], v2 offset:19712
  ds_read_b128 v[144:147], v2 offset:21504
  ds_read_b128 v[148:151], v2 offset:21760
  ds_read_b128 v[152:155], v2 offset:23552
  ds_read_b128 v[156:159], v2 offset:23808
  s_mov_b64 exec, -1
  v_exp_f32 v24, v24
  v_exp_f32 v25, v25
  v_exp_f32 v26, v26
  v_smfmac_f32_32x32x32_bf16 v[64:79], v[160:163], v[16:23], v223
  v_exp_f32 v27, v27
  v_exp_f32 v28, v28
  v_exp_f32 v29, v29
  v_exp_f32 v30, v30
  v_exp_f32 v31, v31
  v_exp_f32 v32, v32
  v_exp_f32 v33, v33
  v_exp_f32 v34, v34
  v_exp_f32 v35, v35
  v_exp_f32 v36, v36
  v_smfmac_f32_32x32x32_bf16 v[64:79], v[164:167], v[24:31], v223
  v_exp_f32 v37, v37
  v_exp_f32 v38, v38
  v_exp_f32 v39, v39
  v_mfma_f32_32x32x16_bf16 v[16:31], v[116:119], v[8:11], 0
  v_exp_f32 v40, v40
  v_exp_f32 v41, v41
  v_exp_f32 v42, v42
  v_smfmac_f32_32x32x32_bf16 v[80:95], v[160:163], v[32:39], v223
  v_exp_f32 v43, v43
  v_exp_f32 v44, v44
  v_exp_f32 v45, v45
  v_exp_f32 v46, v46
  v_exp_f32 v47, v47
  v_exp_f32 v16, v16
  v_exp_f32 v17, v17
  v_exp_f32 v18, v18
  v_exp_f32 v19, v19
  v_exp_f32 v20, v20
  v_smfmac_f32_32x32x32_bf16 v[80:95], v[164:167], v[40:47], v223
  v_exp_f32 v21, v21
  v_exp_f32 v22, v22
  v_exp_f32 v23, v23
  v_mfma_f32_32x32x16_bf16 v[32:47], v[116:119], v[12:15], 0
  v_exp_f32 v24, v24
  v_exp_f32 v25, v25
  v_exp_f32 v26, v26
  v_smfmac_f32_32x32x32_bf16 v[64:79], v[168:171], v[16:23], v223
  v_exp_f32 v27, v27
  v_exp_f32 v28, v28
  v_exp_f32 v29, v29
  v_exp_f32 v30, v30
  v_exp_f32 v31, v31
  v_exp_f32 v32, v32
  v_exp_f32 v33, v33
  v_exp_f32 v34, v34
  v_exp_f32 v35, v35
  v_exp_f32 v36, v36
  v_smfmac_f32_32x32x32_bf16 v[64:79], v[172:175], v[24:31], v223
  v_exp_f32 v37, v37
  v_exp_f32 v38, v38
  v_exp_f32 v39, v39
  v_mfma_f32_32x32x16_bf16 v[16:31], v[120:123], v[8:11], 0
  v_exp_f32 v40, v40
  v_exp_f32 v41, v41
  v_exp_f32 v42, v42
  v_smfmac_f32_32x32x32_bf16 v[80:95], v[168:171], v[32:39], v223
  v_exp_f32 v43, v43
  v_exp_f32 v44, v44
  v_exp_f32 v45, v45
  v_exp_f32 v46, v46
  v_exp_f32 v47, v47
  v_exp_f32 v16, v16
  v_exp_f32 v17, v17
  v_exp_f32 v18, v18
  v_exp_f32 v19, v19
  v_exp_f32 v20, v20
  v_smfmac_f32_32x32x32_bf16 v[80:95], v[172:175], v[40:47], v223
  v_exp_f32 v21, v21
  v_exp_f32 v22, v22
  v_exp_f32 v23, v23
  v_mfma_f32_32x32x16_bf16 v[32:47], v[120:123], v[12:15], 0
  v_exp_f32 v24, v24
  v_exp_f32 v25, v25
  v_exp_f32 v26, v26
  v_smfmac_f32_32x32x32_bf16 v[64:79], v[176:179], v[16:23], v223
  v_exp_f32 v27, v27
  v_exp_f32 v28, v28
  v_exp_f32 v29, v29
  v_exp_f32 v30, v30
  v_exp_f32 v31, v31
  v_exp_f32 v32, v32
  v_exp_f32 v33, v33
  v_exp_f32 v34, v34
  v_exp_f32 v35, v35
  v_exp_f32 v36, v36
  v_smfmac_f32_32x32x32_bf16 v[64:79], v[180:183], v[24:31], v223
  v_exp_f32 v37, v37
  v_exp_f32 v38, v38
  v_exp_f32 v39, v39
  v_mfma_f32_32x32x16_bf16 v[16:31], v[124:127], v[8:11], 0
  v_exp_f32 v40, v40
  v_exp_f32 v41, v41
  v_exp_f32 v42, v42
  v_smfmac_f32_32x32x32_bf16 v[80:95], v[176:179], v[32:39], v223
  v_exp_f32 v43, v43
  v_exp_f32 v44, v44
  v_exp_f32 v45, v45
  v_exp_f32 v46, v46
  v_exp_f32 v47, v47
  v_exp_f32 v16, v16
  v_exp_f32 v17, v17
  v_exp_f32 v18, v18
  v_exp_f32 v19, v19
  v_exp_f32 v20, v20
  v_smfmac_f32_32x32x32_bf16 v[80:95], v[180:183], v[40:47], v223
  v_exp_f32 v21, v21
  v_exp_f32 v22, v22
  v_exp_f32 v23, v23
  v_mfma_f32_32x32x16_bf16 v[32:47], v[124:127], v[12:15], 0
  v_exp_f32 v24, v24
  v_exp_f32 v25, v25
  v_exp_f32 v26, v26
  v_smfmac_f32_32x32x32_bf16 v[64:79], v[184:187], v[16:23], v223
  v_exp_f32 v27, v27
  v_exp_f32 v28, v28
  v_exp_f32 v29, v29
  v_exp_f32 v30, v30
  v_exp_f32 v31, v31
  v_exp_f32 v32, v32
  v_exp_f32 v33, v33
  v_exp_f32 v34, v34
  v_exp_f32 v35, v35
  v_exp_f32 v36, v36
  v_smfmac_f32_32x32x32_bf16 v[64:79], v[188:191], v[24:31], v223
  s_waitcnt lgkmcnt(0)
  v_exp_f32 v37, v37
  v_exp_f32 v38, v38
  v_exp_f32 v39, v39
  v_mfma_f32_32x32x16_bf16 v[16:31], v[96:99], v[8:11], 0
  v_exp_f32 v40, v40
  v_exp_f32 v41, v41
  v_exp_f32 v42, v42
  v_smfmac_f32_32x32x32_bf16 v[80:95], v[184:187], v[32:39], v223
  v_exp_f32 v43, v43
  v_exp_f32 v44, v44
  v_exp_f32 v45, v45
  v_exp_f32 v46, v46
  v_exp_f32 v47, v47
  v_exp_f32 v16, v16
  v_exp_f32 v17, v17
  v_exp_f32 v18, v18
  v_exp_f32 v19, v19
  v_exp_f32 v20, v20
  v_smfmac_f32_32x32x32_bf16 v[80:95], v[188:191], v[40:47], v223
  v_exp_f32 v21, v21
  v_exp_f32 v22, v22
  v_exp_f32 v23, v23
  v_mfma_f32_32x32x16_bf16 v[32:47], v[96:99], v[12:15], 0
  ds_read_b128 v[112:115], v2 offset:24576
  ds_read_b128 v[116:119], v2 offset:26624
  ds_read_b128 v[120:123], v2 offset:28672
  ds_read_b128 v[124:127], v2 offset:30720
  s_mov_b64 exec, s[60:61]
  ds_read_b128 v[160:163], v2 offset:25600
  ds_read_b128 v[164:167], v2 offset:25856
  ds_read_b128 v[168:171], v2 offset:27648
  ds_read_b128 v[172:175], v2 offset:27904
  ds_read_b128 v[176:179], v2 offset:29696
  ds_read_b128 v[180:183], v2 offset:29952
  ds_read_b128 v[184:187], v2 offset:31744
  ds_read_b128 v[188:191], v2 offset:32000
  s_mov_b64 exec, -1
  v_exp_f32 v24, v24
  v_exp_f32 v25, v25
  v_exp_f32 v26, v26
  v_smfmac_f32_32x32x32_bf16 v[64:79], v[128:131], v[16:23], v223
  v_exp_f32 v27, v27
  v_exp_f32 v28, v28
  v_exp_f32 v29, v29
  v_exp_f32 v30, v30
  v_exp_f32 v31, v31
  v_exp_f32 v32, v32
  v_exp_f32 v33, v33
  v_exp_f32 v34, v34
  v_exp_f32 v35, v35
  v_exp_f32 v36, v36
  v_smfmac_f32_32x32x32_bf16 v[64:79], v[132:135], v[24:31], v223
  v_exp_f32 v37, v37
  v_exp_f32 v38, v38
  v_exp_f32 v39, v39
  v_mfma_f32_32x32x16_bf16 v[16:31], v[100:103], v[8:11], 0
  v_exp_f32 v40, v40
  v_exp_f32 v41, v41
  v_exp_f32 v42, v42
  v_smfmac_f32_32x32x32_bf16 v[80:95], v[128:131], v[32:39], v223
  v_exp_f32 v43, v43
  v_exp_f32 v44, v44
  v_exp_f32 v45, v45
  v_exp_f32 v46, v46
  v_exp_f32 v47, v47
  v_exp_f32 v16, v16
  v_exp_f32 v17, v17
  v_exp_f32 v18, v18
  v_exp_f32 v19, v19
  v_exp_f32 v20, v20
  v_smfmac_f32_32x32x32_bf16 v[80:95], v[132:135], v[40:47], v223
  v_exp_f32 v21, v21
  v_exp_f32 v22, v22
  v_exp_f32 v23, v23
  v_mfma_f32_32x32x16_bf16 v[32:47], v[100:103], v[12:15], 0
  v_exp_f32 v24, v24
  v_exp_f32 v25, v25
  v_exp_f32 v26, v26
  v_smfmac_f32_32x32x32_bf16 v[64:79], v[136:139], v[16:23], v223
  v_exp_f32 v27, v27
  v_exp_f32 v28, v28
  v_exp_f32 v29, v29
  v_exp_f32 v30, v30
  v_exp_f32 v31, v31
  v_exp_f32 v32, v32
  v_exp_f32 v33, v33
  v_exp_f32 v34, v34
  v_exp_f32 v35, v35
  v_exp_f32 v36, v36
  v_smfmac_f32_32x32x32_bf16 v[64:79], v[140:143], v[24:31], v223
  s_waitcnt lgkmcnt(0)
  v_exp_f32 v37, v37
  v_exp_f32 v38, v38
  v_exp_f32 v39, v39
  v_mfma_f32_32x32x16_bf16 v[16:31], v[104:107], v[8:11], 0
  v_exp_f32 v40, v40
  v_exp_f32 v41, v41
  v_exp_f32 v42, v42
  v_smfmac_f32_32x32x32_bf16 v[80:95], v[136:139], v[32:39], v223
  v_exp_f32 v43, v43
  v_exp_f32 v44, v44
  v_exp_f32 v45, v45
  v_exp_f32 v46, v46
  v_exp_f32 v47, v47
  v_exp_f32 v16, v16
  v_exp_f32 v17, v17
  v_exp_f32 v18, v18
  v_exp_f32 v19, v19
  v_exp_f32 v20, v20
  v_smfmac_f32_32x32x32_bf16 v[80:95], v[140:143], v[40:47], v223
  v_exp_f32 v21, v21
  v_exp_f32 v22, v22
  v_exp_f32 v23, v23
  v_mfma_f32_32x32x16_bf16 v[32:47], v[104:107], v[12:15], 0
  ds_read_b128 v[48:51], v2 offset:40960
  ds_read_b128 v[52:55], v2 offset:43008
  ds_read_b128 v[56:59], v2 offset:45056
  ds_read_b128 v[60:63], v2 offset:47104
  s_mov_b64 exec, s[60:61]
  ds_read_b128 v[224:227], v2 offset:41984
  ds_read_b128 v[228:231], v2 offset:42240
  ds_read_b128 v[232:235], v2 offset:44032
  ds_read_b128 v[236:239], v2 offset:44288
  ds_read_b128 v[240:243], v2 offset:46080
  ds_read_b128 v[244:247], v2 offset:46336
  ds_read_b128 v[248:251], v2 offset:48128
  ds_read_b128 v[252:255], v2 offset:48384
  s_mov_b64 exec, -1
  ds_read_b32 v194, v7 offset:56
  v_exp_f32 v24, v24
  v_exp_f32 v25, v25
  v_exp_f32 v26, v26
  v_smfmac_f32_32x32x32_bf16 v[64:79], v[144:147], v[16:23], v223
  v_exp_f32 v27, v27
  v_exp_f32 v28, v28
  v_exp_f32 v29, v29
  v_exp_f32 v30, v30
  v_exp_f32 v31, v31
  v_exp_f32 v32, v32
  v_exp_f32 v33, v33
  v_exp_f32 v34, v34
  v_exp_f32 v35, v35
  v_exp_f32 v36, v36
  v_smfmac_f32_32x32x32_bf16 v[64:79], v[148:151], v[24:31], v223
  v_exp_f32 v37, v37
  v_exp_f32 v38, v38
  v_exp_f32 v39, v39
  v_mfma_f32_32x32x16_bf16 v[16:31], v[108:111], v[8:11], 0
  v_exp_f32 v40, v40
  v_exp_f32 v41, v41
  v_exp_f32 v42, v42
  v_smfmac_f32_32x32x32_bf16 v[80:95], v[144:147], v[32:39], v223
  v_exp_f32 v43, v43
  v_exp_f32 v44, v44
  v_exp_f32 v45, v45
  v_exp_f32 v46, v46
  v_exp_f32 v47, v47
  v_exp_f32 v16, v16
  v_exp_f32 v17, v17
  v_exp_f32 v18, v18
  v_exp_f32 v19, v19
  v_exp_f32 v20, v20
  v_smfmac_f32_32x32x32_bf16 v[80:95], v[148:151], v[40:47], v223
  v_exp_f32 v21, v21
  v_exp_f32 v22, v22
  v_exp_f32 v23, v23
  v_mfma_f32_32x32x16_bf16 v[32:47], v[108:111], v[12:15], 0
  v_exp_f32 v24, v24
  v_exp_f32 v25, v25
  v_exp_f32 v26, v26
  v_smfmac_f32_32x32x32_bf16 v[64:79], v[152:155], v[16:23], v223
  v_exp_f32 v27, v27
  v_exp_f32 v28, v28
  v_exp_f32 v29, v29
  v_exp_f32 v30, v30
  v_exp_f32 v31, v31
  v_exp_f32 v32, v32
  v_exp_f32 v33, v33
  v_exp_f32 v34, v34
  v_exp_f32 v35, v35
  v_exp_f32 v36, v36
  v_smfmac_f32_32x32x32_bf16 v[64:79], v[156:159], v[24:31], v223
  s_waitcnt lgkmcnt(0)
  v_exp_f32 v37, v37
  v_exp_f32 v38, v38
  v_exp_f32 v39, v39
  v_mfma_f32_32x32x16_bf16 v[16:31], v[112:115], v[8:11], 0
  v_readfirstlane_b32 s69, v194
  v_exp_f32 v40, v40
  v_exp_f32 v41, v41
  v_exp_f32 v42, v42
  v_smfmac_f32_32x32x32_bf16 v[80:95], v[152:155], v[32:39], v223
  v_exp_f32 v43, v43
  v_exp_f32 v44, v44
  v_exp_f32 v45, v45
  v_exp_f32 v46, v46
  v_exp_f32 v47, v47
  v_exp_f32 v16, v16
  v_exp_f32 v17, v17
  v_exp_f32 v18, v18
  v_exp_f32 v19, v19
  v_exp_f32 v20, v20
  v_smfmac_f32_32x32x32_bf16 v[80:95], v[156:159], v[40:47], v223
  v_exp_f32 v21, v21
  v_exp_f32 v22, v22
  v_exp_f32 v23, v23
  v_mfma_f32_32x32x16_bf16 v[32:47], v[116:119], v[8:11], 0
  ds_read_b128 v[96:99], v2 offset:32768
  ds_read_b128 v[100:103], v2 offset:34816
  ds_read_b128 v[104:107], v2 offset:36864
  ds_read_b128 v[108:111], v2 offset:38912
  s_mov_b64 exec, s[60:61]
  ds_read_b128 v[128:131], v2 offset:33792
  ds_read_b128 v[132:135], v2 offset:34048
  ds_read_b128 v[136:139], v2 offset:35840
  ds_read_b128 v[140:143], v2 offset:36096
  ds_read_b128 v[144:147], v2 offset:37888
  ds_read_b128 v[148:151], v2 offset:38144
  ds_read_b128 v[152:155], v2 offset:39936
  ds_read_b128 v[156:159], v2 offset:40192
  s_mov_b64 exec, -1
  v_exp_f32 v24, v24
  v_exp_f32 v25, v25
  v_exp_f32 v26, v26
  v_smfmac_f32_32x32x32_bf16 v[64:79], v[160:163], v[16:23], v223
  v_exp_f32 v27, v27
  v_exp_f32 v28, v28
  v_exp_f32 v29, v29
  v_exp_f32 v30, v30
  v_exp_f32 v31, v31
  v_exp_f32 v32, v32
  v_exp_f32 v33, v33
  v_exp_f32 v34, v34
  v_exp_f32 v35, v35
  v_exp_f32 v36, v36
  v_smfmac_f32_32x32x32_bf16 v[64:79], v[164:167], v[24:31], v223
  v_exp_f32 v37, v37
  v_exp_f32 v38, v38
  v_exp_f32 v39, v39
  v_mfma_f32_32x32x16_bf16 v[16:31], v[120:123], v[8:11], 0
  v_exp_f32 v40, v40
  v_exp_f32 v41, v41
  v_exp_f32 v42, v42
  v_smfmac_f32_32x32x32_bf16 v[64:79], v[168:171], v[32:39], v223
  v_exp_f32 v43, v43
  v_exp_f32 v44, v44
  v_exp_f32 v45, v45
  v_exp_f32 v46, v46
  v_exp_f32 v47, v47
  v_exp_f32 v16, v16
  v_exp_f32 v17, v17
  v_exp_f32 v18, v18
  v_exp_f32 v19, v19
  v_exp_f32 v20, v20
  v_smfmac_f32_32x32x32_bf16 v[64:79], v[172:175], v[40:47], v223
  v_exp_f32 v21, v21
  v_exp_f32 v22, v22
  v_exp_f32 v23, v23
  v_mfma_f32_32x32x16_bf16 v[32:47], v[124:127], v[8:11], 0
  v_exp_f32 v24, v24
  v_exp_f32 v25, v25
  v_exp_f32 v26, v26
  v_smfmac_f32_32x32x32_bf16 v[64:79], v[176:179], v[16:23], v223
  v_exp_f32 v27, v27
  v_exp_f32 v28, v28
  v_exp_f32 v29, v29
  v_exp_f32 v30, v30
  v_exp_f32 v31, v31
  v_exp_f32 v32, v32
  v_exp_f32 v33, v33
  v_exp_f32 v34, v34
  v_exp_f32 v35, v35
  v_exp_f32 v36, v36
  v_smfmac_f32_32x32x32_bf16 v[64:79], v[180:183], v[24:31], v223
  v_exp_f32 v37, v37
  v_exp_f32 v38, v38
  v_exp_f32 v39, v39
  v_mfma_f32_32x32x16_bf16 v[16:31], v[48:51], v[8:11], 0
  v_exp_f32 v40, v40
  v_exp_f32 v41, v41
  v_exp_f32 v42, v42
  v_smfmac_f32_32x32x32_bf16 v[64:79], v[184:187], v[32:39], v223
  v_exp_f32 v43, v43
  v_exp_f32 v44, v44
  v_exp_f32 v45, v45
  v_exp_f32 v46, v46
  v_exp_f32 v47, v47
  v_exp_f32 v16, v16
  v_exp_f32 v17, v17
  v_exp_f32 v18, v18
  v_exp_f32 v19, v19
  v_exp_f32 v20, v20
  v_smfmac_f32_32x32x32_bf16 v[64:79], v[188:191], v[40:47], v223
  v_exp_f32 v21, v21
  v_exp_f32 v22, v22
  v_exp_f32 v23, v23
  v_mfma_f32_32x32x16_bf16 v[32:47], v[52:55], v[8:11], 0
  v_exp_f32 v24, v24
  v_exp_f32 v25, v25
  v_exp_f32 v26, v26
  v_smfmac_f32_32x32x32_bf16 v[64:79], v[224:227], v[16:23], v223
  v_exp_f32 v27, v27
  v_exp_f32 v28, v28
  v_exp_f32 v29, v29
  v_exp_f32 v30, v30
  v_exp_f32 v31, v31
  v_exp_f32 v32, v32
  v_exp_f32 v33, v33
  v_exp_f32 v34, v34
  v_exp_f32 v35, v35
  v_exp_f32 v36, v36
  v_smfmac_f32_32x32x32_bf16 v[64:79], v[228:231], v[24:31], v223
  s_waitcnt lgkmcnt(0)
  v_exp_f32 v37, v37
  v_exp_f32 v38, v38
  v_exp_f32 v39, v39
  v_mfma_f32_32x32x16_bf16 v[16:31], v[56:59], v[8:11], 0
  v_exp_f32 v40, v40
  v_exp_f32 v41, v41
  v_exp_f32 v42, v42
  v_smfmac_f32_32x32x32_bf16 v[64:79], v[232:235], v[32:39], v223
  v_exp_f32 v43, v43
  v_exp_f32 v44, v44
  v_exp_f32 v45, v45
  v_exp_f32 v46, v46
  v_exp_f32 v47, v47
  v_exp_f32 v16, v16
  v_exp_f32 v17, v17
  v_exp_f32 v18, v18
  v_exp_f32 v19, v19
  v_exp_f32 v20, v20
  v_smfmac_f32_32x32x32_bf16 v[64:79], v[236:239], v[40:47], v223
  v_exp_f32 v21, v21
  v_exp_f32 v22, v22
  v_exp_f32 v23, v23
  v_mfma_f32_32x32x16_bf16 v[32:47], v[60:63], v[8:11], 0
  v_exp_f32 v24, v24
  v_exp_f32 v25, v25
  v_exp_f32 v26, v26
  v_smfmac_f32_32x32x32_bf16 v[64:79], v[240:243], v[16:23], v223
  v_exp_f32 v27, v27
  v_exp_f32 v28, v28
  v_exp_f32 v29, v29
  v_exp_f32 v30, v30
  v_exp_f32 v31, v31
  v_exp_f32 v32, v32
  v_exp_f32 v33, v33
  v_exp_f32 v34, v34
  v_exp_f32 v35, v35
  v_exp_f32 v36, v36
  v_smfmac_f32_32x32x32_bf16 v[64:79], v[244:247], v[24:31], v223
  v_exp_f32 v37, v37
  v_exp_f32 v38, v38
  v_exp_f32 v39, v39
  v_mfma_f32_32x32x16_bf16 v[16:31], v[96:99], v[8:11], 0
  v_exp_f32 v40, v40
  v_exp_f32 v41, v41
  v_exp_f32 v42, v42
  v_smfmac_f32_32x32x32_bf16 v[64:79], v[248:251], v[32:39], v223
  v_exp_f32 v43, v43
  v_exp_f32 v44, v44
  v_exp_f32 v45, v45
  v_exp_f32 v46, v46
  v_exp_f32 v47, v47
  v_exp_f32 v16, v16
  v_exp_f32 v17, v17
  v_exp_f32 v18, v18
  v_exp_f32 v19, v19
  v_exp_f32 v20, v20
  v_smfmac_f32_32x32x32_bf16 v[64:79], v[252:255], v[40:47], v223
  v_exp_f32 v21, v21
  v_exp_f32 v22, v22
  v_exp_f32 v23, v23
  v_mfma_f32_32x32x16_bf16 v[32:47], v[100:103], v[8:11], 0
  v_exp_f32 v24, v24
  v_exp_f32 v25, v25
  v_exp_f32 v26, v26
  v_smfmac_f32_32x32x32_bf16 v[64:79], v[128:131], v[16:23], v223
  v_exp_f32 v27, v27
  v_exp_f32 v28, v28
  v_exp_f32 v29, v29
  v_exp_f32 v30, v30
  v_exp_f32 v31, v31
  v_exp_f32 v32, v32
  v_exp_f32 v33, v33
  v_exp_f32 v34, v34
  v_exp_f32 v35, v35
  v_exp_f32 v36, v36
  v_smfmac_f32_32x32x32_bf16 v[64:79], v[132:135], v[24:31], v223
  v_exp_f32 v37, v37
  v_exp_f32 v38, v38
  v_exp_f32 v39, v39
  v_mfma_f32_32x32x16_bf16 v[16:31], v[104:107], v[8:11], 0
  v_exp_f32 v40, v40
  v_exp_f32 v41, v41
  v_exp_f32 v42, v42
  v_smfmac_f32_32x32x32_bf16 v[64:79], v[136:139], v[32:39], v223
  v_exp_f32 v43, v43
  v_exp_f32 v44, v44
  v_exp_f32 v45, v45
  v_exp_f32 v46, v46
  v_exp_f32 v47, v47
  v_exp_f32 v16, v16
  v_exp_f32 v17, v17
  v_exp_f32 v18, v18
  v_exp_f32 v19, v19
  v_exp_f32 v20, v20
  v_smfmac_f32_32x32x32_bf16 v[64:79], v[140:143], v[40:47], v223
  v_exp_f32 v21, v21
  v_exp_f32 v22, v22
  v_exp_f32 v23, v23
  v_mfma_f32_32x32x16_bf16 v[32:47], v[108:111], v[8:11], 0
  v_exp_f32 v24, v24
  v_exp_f32 v25, v25
  v_exp_f32 v26, v26
  v_smfmac_f32_32x32x32_bf16 v[64:79], v[144:147], v[16:23], v223
  v_exp_f32 v27, v27
  v_exp_f32 v28, v28
  v_exp_f32 v29, v29
  v_exp_f32 v30, v30
  v_exp_f32 v31, v31
  v_exp_f32 v32, v32
  v_exp_f32 v33, v33
  v_exp_f32 v34, v34
  v_exp_f32 v35, v35
  v_exp_f32 v36, v36
  v_smfmac_f32_32x32x32_bf16 v[64:79], v[148:151], v[24:31], v223
  v_exp_f32 v37, v37
  v_exp_f32 v38, v38
  v_exp_f32 v39, v39
  v_mfma_f32_32x32x16_bf16 v[16:31], v[112:115], v[12:15], 0
  v_exp_f32 v40, v40
  v_exp_f32 v41, v41
  v_exp_f32 v42, v42
  v_smfmac_f32_32x32x32_bf16 v[64:79], v[152:155], v[32:39], v223
  v_exp_f32 v43, v43
  v_exp_f32 v44, v44
  v_exp_f32 v45, v45
  v_exp_f32 v46, v46
  v_exp_f32 v47, v47
  v_exp_f32 v16, v16
  v_exp_f32 v17, v17
  v_exp_f32 v18, v18
  v_exp_f32 v19, v19
  v_exp_f32 v20, v20
  v_smfmac_f32_32x32x32_bf16 v[64:79], v[156:159], v[40:47], v223
  v_exp_f32 v21, v21
  v_exp_f32 v22, v22
  v_exp_f32 v23, v23
  v_mfma_f32_32x32x16_bf16 v[32:47], v[116:119], v[12:15], 0
  v_exp_f32 v24, v24
  v_exp_f32 v25, v25
  v_exp_f32 v26, v26
  v_smfmac_f32_32x32x32_bf16 v[80:95], v[160:163], v[16:23], v223
  v_exp_f32 v27, v27
  v_exp_f32 v28, v28
  v_exp_f32 v29, v29
  v_exp_f32 v30, v30
  v_exp_f32 v31, v31
  v_exp_f32 v32, v32
  v_exp_f32 v33, v33
  v_exp_f32 v34, v34
  v_exp_f32 v35, v35
  v_exp_f32 v36, v36
  v_smfmac_f32_32x32x32_bf16 v[80:95], v[164:167], v[24:31], v223
  v_exp_f32 v37, v37
  v_exp_f32 v38, v38
  v_exp_f32 v39, v39
  v_mfma_f32_32x32x16_bf16 v[16:31], v[120:123], v[12:15], 0
  v_cmp_le_f32 s[62:63], s51, v72
  v_cmp_ge_f32 s[64:65], s52, v72
  v_rcp_f32 v202, v72
  s_and_b64 s[62:63], s[62:63], s[64:65]
  s_cmp_eq_u64 s[62:63], -1
  s_cselect_b32 s70, 0, 1
  s_cbranch_scc0 KG_L9
  v_pk_mul_f32 v[64:65], v[64:65], v[202:203] op_sel_hi:[1,0]
  v_pk_mul_f32 v[66:67], v[66:67], v[202:203] op_sel_hi:[1,0]
  v_pk_mul_f32 v[68:69], v[68:69], v[202:203] op_sel_hi:[1,0]
  v_pk_mul_f32 v[70:71], v[70:71], v[202:203] op_sel_hi:[1,0]
  v_cvt_pk_bf16_f32 v196, v64, v65
  v_cvt_pk_bf16_f32 v197, v66, v67
  v_cvt_pk_bf16_f32 v198, v68, v69
  v_cvt_pk_bf16_f32 v199, v70, v71
  v_min_u32 v199, -2, v199
  s_cmp_eq_u32 s69, 1
  s_cbranch_scc0 KG_SG14
  buffer_store_dwordx4 v[196:199], v2, s[28:31], s58 offen offset:0 nt
KG_SH14:
KG_L9:
  v_exp_f32 v40, v40
  v_exp_f32 v41, v41
  v_exp_f32 v42, v42
  v_smfmac_f32_32x32x32_bf16 v[80:95], v[168:171], v[32:39], v223
  v_exp_f32 v43, v43
  v_exp_f32 v44, v44
  v_exp_f32 v45, v45
  v_exp_f32 v46, v46
  v_exp_f32 v47, v47
  v_exp_f32 v16, v16
  v_exp_f32 v17, v17
  v_exp_f32 v18, v18
  v_exp_f32 v19, v19
  v_exp_f32 v20, v20
  v_smfmac_f32_32x32x32_bf16 v[80:95], v[172:175], v[40:47], v223
  v_exp_f32 v21, v21
  v_exp_f32 v22, v22
  v_exp_f32 v23, v23
  v_mfma_f32_32x32x16_bf16 v[32:47], v[124:127], v[12:15], 0
  v_exp_f32 v24, v24
  v_exp_f32 v25, v25
  v_exp_f32 v26, v26
  v_smfmac_f32_32x32x32_bf16 v[80:95], v[176:179], v[16:23], v223
  v_exp_f32 v27, v27
  v_exp_f32 v28, v28
  v_exp_f32 v29, v29
  v_exp_f32 v30, v30
  v_exp_f32 v31, v31
  v_exp_f32 v32, v32
  v_exp_f32 v33, v33
  v_exp_f32 v34, v34
  v_exp_f32 v35, v35
  v_exp_f32 v36, v36
  v_smfmac_f32_32x32x32_bf16 v[80:95], v[180:183], v[24:31], v223
  s_cmp_lg_u32 s70, 0
  v_exp_f32 v37, v37
  v_exp_f32 v38, v38
  v_exp_f32 v39, v39
  v_mfma_f32_32x32x16_bf16 v[16:31], v[48:51], v[12:15], 0
  s_cbranch_scc1 KG_L12
  ds_write_b32 v7, v209 offset:144
KG_L12:
  v_exp_f32 v40, v40
  v_exp_f32 v41, v41
  v_exp_f32 v42, v42
  v_smfmac_f32_32x32x32_bf16 v[80:95], v[184:187], v[32:39], v223
  v_exp_f32 v43, v43
  v_exp_f32 v44, v44
  v_exp_f32 v45, v45
  v_exp_f32 v46, v46
  v_exp_f32 v47, v47
  v_exp_f32 v16, v16
  v_exp_f32 v17, v17
  v_exp_f32 v18, v18
  v_exp_f32 v19, v19
  v_exp_f32 v20, v20
  v_smfmac_f32_32x32x32_bf16 v[80:95], v[188:191], v[40:47], v223
  v_exp_f32 v21, v21
  v_exp_f32 v22, v22
  v_exp_f32 v23, v23
  v_mfma_f32_32x32x16_bf16 v[32:47], v[52:55], v[12:15], 0
  v_exp_f32 v24, v24
  v_exp_f32 v25, v25
  v_exp_f32 v26, v26
  v_smfmac_f32_32x32x32_bf16 v[80:95], v[224:227], v[16:23], v223
  v_exp_f32 v27, v27
  v_exp_f32 v28, v28
  v_exp_f32 v29, v29
  v_exp_f32 v30, v30
  v_exp_f32 v31, v31
  v_exp_f32 v32, v32
  v_exp_f32 v33, v33
  v_exp_f32 v34, v34
  v_exp_f32 v35, v35
  v_exp_f32 v36, v36
  v_smfmac_f32_32x32x32_bf16 v[80:95], v[228:231], v[24:31], v223
  v_exp_f32 v37, v37
  v_exp_f32 v38, v38
  v_exp_f32 v39, v39
  v_mfma_f32_32x32x16_bf16 v[16:31], v[56:59], v[12:15], 0
  v_exp_f32 v40, v40
  v_exp_f32 v41, v41
  v_exp_f32 v42, v42
  v_smfmac_f32_32x32x32_bf16 v[80:95], v[232:235], v[32:39], v223
  v_exp_f32 v43, v43
  v_exp_f32 v44, v44
  v_exp_f32 v45, v45
  v_exp_f32 v46, v46
  v_exp_f32 v47, v47
  v_exp_f32 v16, v16
  v_exp_f32 v17, v17
  v_exp_f32 v18, v18
  v_exp_f32 v19, v19
  v_exp_f32 v20, v20
  v_smfmac_f32_32x32x32_bf16 v[80:95], v[236:239], v[40:47], v223
  v_exp_f32 v21, v21
  v_exp_f32 v22, v22
  v_exp_f32 v23, v23
  v_mfma_f32_32x32x16_bf16 v[32:47], v[60:63], v[12:15], 0
  v_exp_f32 v24, v24
  v_exp_f32 v25, v25
  v_exp_f32 v26, v26
  v_smfmac_f32_32x32x32_bf16 v[80:95], v[240:243], v[16:23], v223
  v_exp_f32 v27, v27
  v_exp_f32 v28, v28
  v_exp_f32 v29, v29
  v_exp_f32 v30, v30
  v_exp_f32 v31, v31
  v_exp_f32 v32, v32
  v_exp_f32 v33, v33
  v_exp_f32 v34, v34
  v_exp_f32 v35, v35
  v_exp_f32 v36, v36
  v_smfmac_f32_32x32x32_bf16 v[80:95], v[244:247], v[24:31], v223
  v_exp_f32 v37, v37
  v_exp_f32 v38, v38
  v_exp_f32 v39, v39
  v_mfma_f32_32x32x16_bf16 v[16:31], v[96:99], v[12:15], 0
  v_exp_f32 v40, v40
  v_exp_f32 v41, v41
  v_exp_f32 v42, v42
  v_smfmac_f32_32x32x32_bf16 v[80:95], v[248:251], v[32:39], v223
  v_exp_f32 v43, v43
  v_exp_f32 v44, v44
  v_exp_f32 v45, v45
  v_exp_f32 v46, v46
  v_exp_f32 v47, v47
  v_exp_f32 v16, v16
  v_exp_f32 v17, v17
  v_exp_f32 v18, v18
  v_exp_f32 v19, v19
  v_exp_f32 v20, v20
  v_smfmac_f32_32x32x32_bf16 v[80:95], v[252:255], v[40:47], v223
  v_exp_f32 v21, v21
  v_exp_f32 v22, v22
  v_exp_f32 v23, v23
  v_mfma_f32_32x32x16_bf16 v[32:47], v[100:103], v[12:15], 0
  v_exp_f32 v24, v24
  v_exp_f32 v25, v25
  v_exp_f32 v26, v26
  v_smfmac_f32_32x32x32_bf16 v[80:95], v[128:131], v[16:23], v223
  v_exp_f32 v27, v27
  v_exp_f32 v28, v28
  v_exp_f32 v29, v29
  v_exp_f32 v30, v30
  v_exp_f32 v31, v31
  v_exp_f32 v32, v32
  v_exp_f32 v33, v33
  v_exp_f32 v34, v34
  v_exp_f32 v35, v35
  v_exp_f32 v36, v36
  v_smfmac_f32_32x32x32_bf16 v[80:95], v[132:135], v[24:31], v223
  v_exp_f32 v37, v37
  v_exp_f32 v38, v38
  v_exp_f32 v39, v39
  v_mfma_f32_32x32x16_bf16 v[16:31], v[104:107], v[12:15], 0
  v_exp_f32 v40, v40
  v_exp_f32 v41, v41
  v_exp_f32 v42, v42
  v_smfmac_f32_32x32x32_bf16 v[80:95], v[136:139], v[32:39], v223
  v_exp_f32 v43, v43
  v_exp_f32 v44, v44
  v_exp_f32 v45, v45
  v_exp_f32 v46, v46
  v_exp_f32 v47, v47
  v_exp_f32 v16, v16
  v_exp_f32 v17, v17
  v_exp_f32 v18, v18
  v_exp_f32 v19, v19
  v_exp_f32 v20, v20
  v_smfmac_f32_32x32x32_bf16 v[80:95], v[140:143], v[40:47], v223
  v_exp_f32 v21, v21
  v_exp_f32 v22, v22
  v_exp_f32 v23, v23
  v_mfma_f32_32x32x16_bf16 v[32:47], v[108:111], v[12:15], 0
  v_exp_f32 v24, v24
  v_exp_f32 v25, v25
  v_exp_f32 v26, v26
  v_smfmac_f32_32x32x32_bf16 v[80:95], v[144:147], v[16:23], v223
  v_exp_f32 v27, v27
  v_exp_f32 v28, v28
  v_exp_f32 v29, v29
  v_exp_f32 v30, v30
  v_exp_f32 v31, v31
  v_exp_f32 v32, v32
  v_exp_f32 v33, v33
  v_exp_f32 v34, v34
  v_exp_f32 v35, v35
  v_exp_f32 v36, v36
  v_smfmac_f32_32x32x32_bf16 v[80:95], v[148:151], v[24:31], v223
  v_exp_f32 v37, v37
  v_exp_f32 v38, v38
  v_exp_f32 v39, v39
  v_exp_f32 v40, v40
  v_exp_f32 v41, v41
  v_exp_f32 v42, v42
  v_smfmac_f32_32x32x32_bf16 v[80:95], v[152:155], v[32:39], v223
  v_exp_f32 v43, v43
  v_exp_f32 v44, v44
  v_exp_f32 v45, v45
  v_exp_f32 v46, v46
  v_exp_f32 v47, v47
  s_nop 2
  v_smfmac_f32_32x32x32_bf16 v[80:95], v[156:159], v[40:47], v223
  s_cmp_lg_u32 s70, 0
  s_cbranch_scc1 KG_SLOW
  s_cmp_eq_u32 s69, 1
  s_cbranch_scc0 KG_FN0
  s_nop 8
  v_rcp_f32 v202, v88
  v_subrev_u32 v196, s51, v88
  v_cmp_lt_u32 vcc, 0x1e000000, v196
  v_pk_mul_f32 v[80:81], v[80:81], v[202:203] op_sel_hi:[1,0]
  v_pk_mul_f32 v[82:83], v[82:83], v[202:203] op_sel_hi:[1,0]
  v_pk_mul_f32 v[84:85], v[84:85], v[202:203] op_sel_hi:[1,0]
  v_pk_mul_f32 v[86:87], v[86:87], v[202:203] op_sel_hi:[1,0]
  v_cvt_pk_bf16_f32 v199, v86, v87
  v_cvt_pk_bf16_f32 v196, v80, v81
  v_cvt_pk_bf16_f32 v197, v82, v83
  v_cvt_pk_bf16_f32 v198, v84, v85
  v_min_u32 v199, -2, v199
  s_cbranch_vccnz KG_SLOW
  buffer_store_dwordx4 v[196:199], v2, s[28:31], s58 offen offset:1024 nt
  ds_write_b32 v208, v220 offset:16
  s_endpgm
KG_FN0:
  s_nop 12
KG_FIN:
  v_cmp_le_f32 s[62:63], s51, v88
  v_cmp_ge_f32 s[64:65], s52, v88
  v_rcp_f32 v202, v88
  s_and_b64 s[62:63], s[62:63], s[64:65]
  s_cmp_eq_u64 s[62:63], -1
  s_cbranch_scc0 KG_SLOW
  s_cmp_lg_u32 s70, 0
  s_cbranch_scc1 KG_SLOW
KG_OUT:
  v_pk_mul_f32 v[80:81], v[80:81], v[202:203] op_sel_hi:[1,0]
  v_pk_mul_f32 v[82:83], v[82:83], v[202:203] op_sel_hi:[1,0]
  v_pk_mul_f32 v[84:85], v[84:85], v[202:203] op_sel_hi:[1,0]
  v_pk_mul_f32 v[86:87], v[86:87], v[202:203] op_sel_hi:[1,0]
  v_cvt_pk_bf16_f32 v196, v80, v81
  v_cvt_pk_bf16_f32 v197, v82, v83
  v_cvt_pk_bf16_f32 v198, v84, v85
  v_cvt_pk_bf16_f32 v199, v86, v87
  v_min_u32 v199, -2, v199
  s_cmp_eq_u32 s69, 1
  s_cbranch_scc0 KG_SG15
  buffer_store_dwordx4 v[196:199], v2, s[28:31], s58 offen offset:1024 nt
KG_SH15:
  ds_write_b32 v208, v220 offset:16
  s_endpgm
KG_SP1:
  ds_read_b32 v200, v7 offset:8
  s_waitcnt lgkmcnt(0)
  v_readfirstlane_b32 s59, v200
  s_cmp_ge_u32 s59, 1
  s_cbranch_scc1 KG_SR1
  s_sub_u32 s72, s72, 1
  s_cbranch_scc0 KG_SP1
  s_mov_b32 s72, 0
  s_branch KG_SR1
KG_SP2:
  ds_read_b32 v200, v7 offset:8
  s_waitcnt lgkmcnt(0)
  v_readfirstlane_b32 s59, v200
  s_cmp_ge_u32 s59, 2
  s_cbranch_scc1 KG_SR2
  s_sub_u32 s72, s72, 1
  s_cbranch_scc0 KG_SP2
  s_mov_b32 s72, 0
  s_branch KG_SR2
KG_SP3:
  ds_read_b32 v200, v7 offset:8
  s_waitcnt lgkmcnt(0)
  v_readfirstlane_b32 s59, v200
  s_cmp_ge_u32 s59, 3
  s_cbranch_scc1 KG_SR3
  s_sub_u32 s72, s72, 1
  s_cbranch_scc0 KG_SP3
  s_mov_b32 s72, 0
  s_branch KG_SR3
KG_SP4:
  ds_read_b32 v200, v7 offset:8
  s_waitcnt lgkmcnt(0)
  v_readfirstlane_b32 s59, v200
  s_cmp_ge_u32 s59, 4
  s_cbranch_scc1 KG_SR4
  s_sub_u32 s72, s72, 1
  s_cbranch_scc0 KG_SP4
  s_mov_b32 s72, 0
  s_branch KG_SR4
KG_SP5:
  ds_read_b32 v200, v7 offset:8
  s_waitcnt lgkmcnt(0)
  v_readfirstlane_b32 s59, v200
  s_cmp_ge_u32 s59, 5
  s_cbranch_scc1 KG_SR5
  s_sub_u32 s72, s72, 1
  s_cbranch_scc0 KG_SP5
  s_mov_b32 s72, 0
  s_branch KG_SR5
KG_SP6:
  ds_read_b32 v200, v7 offset:8
  s_waitcnt lgkmcnt(0)
  v_readfirstlane_b32 s59, v200
  s_cmp_ge_u32 s59, 6
  s_cbranch_scc1 KG_SR6
  s_sub_u32 s72, s72, 1
  s_cbranch_scc0 KG_SP6
  s_mov_b32 s72, 0
  s_branch KG_SR6
KG_SP7:
  ds_read_b32 v200, v7 offset:8
  s_waitcnt lgkmcnt(0)
  v_readfirstlane_b32 s59, v200
  s_cmp_ge_u32 s59, 7
  s_cbranch_scc1 KG_SR7
  s_sub_u32 s72, s72, 1
  s_cbranch_scc0 KG_SP7
  s_mov_b32 s72, 0
  s_branch KG_SR7
KG_SP8:
  ds_read_b32 v200, v7 offset:8
  s_waitcnt lgkmcnt(0)
  v_readfirstlane_b32 s59, v200
  s_cmp_ge_u32 s59, 8
  s_cbranch_scc1 KG_SR8
  s_sub_u32 s72, s72, 1
  s_cbranch_scc0 KG_SP8
  s_mov_b32 s72, 0
  s_branch KG_SR8
KG_SP9:
  ds_read_b32 v200, v7 offset:48
  s_waitcnt lgkmcnt(0)
  v_readfirstlane_b32 s56, v200
  s_cmp_ge_u32 s56, 1
  s_cbranch_scc1 KG_SR9
  s_sleep 1
  s_sub_u32 s72, s72, 1
  s_cbranch_scc0 KG_SP9
  s_mov_b32 s72, 0
  s_branch KG_SR9
KG_SP10:
  ds_read_b32 v200, v7 offset:48
  s_waitcnt lgkmcnt(0)
  v_readfirstlane_b32 s56, v200
  s_cmp_ge_u32 s56, 2
  s_cbranch_scc1 KG_SR10
  s_sleep 1
  s_sub_u32 s72, s72, 1
  s_cbranch_scc0 KG_SP10
  s_mov_b32 s72, 0
  s_branch KG_SR10
KG_SP11:
  ds_read_b32 v200, v7 offset:48
  s_waitcnt lgkmcnt(0)
  v_readfirstlane_b32 s56, v200
  s_cmp_ge_u32 s56, 3
  s_cbranch_scc1 KG_SR11
  s_sleep 1
  s_sub_u32 s72, s72, 1
  s_cbranch_scc0 KG_SP11
  s_mov_b32 s72, 0
  s_branch KG_SR11
KG_SP12:
  ds_read_b32 v200, v7 offset:48
  s_waitcnt lgkmcnt(0)
  v_readfirstlane_b32 s56, v200
  s_cmp_ge_u32 s56, 4
  s_cbranch_scc1 KG_SR12
  s_sleep 1
  s_sub_u32 s72, s72, 1
  s_cbranch_scc0 KG_SP12
  s_mov_b32 s72, 0
  s_branch KG_SR12
KG_SP13:
  ds_read_b32 v200, v7 offset:48
  s_waitcnt lgkmcnt(0)
  v_readfirstlane_b32 s56, v200
  s_cmp_ge_u32 s56, 8
  s_cbranch_scc1 KG_SR13
  s_sleep 1
  s_sub_u32 s72, s72, 1
  s_cbranch_scc0 KG_SP13
  s_mov_b32 s72, 0
  s_branch KG_SR13
KG_SLOW:
KG_LW16:
  ds_read_b32 v200, v7 offset:96
  s_waitcnt lgkmcnt(0)
  v_readfirstlane_b32 s53, v200
  s_cmp_ge_u32 s53, 127
  s_cbranch_scc1 KG_LD16
  s_sleep 1
  s_sub_u32 s72, s72, 1
  s_cbranch_scc0 KG_LW16
  s_mov_b32 s72, 0
KG_LD16:
  s_waitcnt vmcnt(0)
  v_mov_b32 v4, 0xff800000
  v_mov_b32 v5, 0xff800000
  s_mov_b32 s56, 2097152
  s_mov_b32 s55, 64
KG_MAXLOOP:
  buffer_load_dwordx4 v[96:99], v2, s[28:31], s56 offen offset:0
  s_add_u32 s56, s56, 2048
  s_waitcnt vmcnt(0)
  v_mfma_f32_32x32x16_bf16 v[16:31], v[96:99], v[8:11], 0
  v_mfma_f32_32x32x16_bf16 v[32:47], v[96:99], v[12:15], 0
  s_nop 12
  v_max3_f32 v4, v16, v17, v4
  v_max3_f32 v4, v18, v19, v4
  v_max3_f32 v4, v20, v21, v4
  v_max3_f32 v4, v22, v23, v4
  v_max3_f32 v4, v24, v25, v4
  v_max3_f32 v4, v26, v27, v4
  v_max3_f32 v4, v28, v29, v4
  v_max3_f32 v4, v30, v31, v4
  v_max3_f32 v5, v32, v33, v5
  v_max3_f32 v5, v34, v35, v5
  v_max3_f32 v5, v36, v37, v5
  v_max3_f32 v5, v38, v39, v5
  v_max3_f32 v5, v40, v41, v5
  v_max3_f32 v5, v42, v43, v5
  v_max3_f32 v5, v44, v45, v5
  v_max3_f32 v5, v46, v47, v5
  s_sub_u32 s55, s55, 1
  s_cmp_lg_u32 s55, 0
  s_cbranch_scc1 KG_MAXLOOP
  v_mov_b32 v196, v4
  v_mov_b32 v197, v5
  s_nop 1
  v_permlane32_swap_b32 v4, v196
  v_permlane32_swap_b32 v5, v197
  s_nop 1
  v_max_f32 v4, v4, v196
  v_max_f32 v5, v5, v197
  s_mov_b32 s56, 2097152
  buffer_load_dwordx4 v[96:99], v2, s[28:31], s56 offen offset:0
  buffer_load_dwordx4 v[100:103], v2, s[28:31], s56 offen offset:2048
  s_mov_b64 exec, s[60:61]
  buffer_load_dwordx4 v[128:131], v2, s[28:31], s56 offen offset:1024
  buffer_load_dwordx4 v[132:135], v2, s[28:31], s56 offen offset:1280
  buffer_load_dwordx4 v[136:139], v2, s[28:31], s56 offen offset:3072
  buffer_load_dwordx4 v[140:143], v2, s[28:31], s56 offen offset:3328
  s_mov_b64 exec, -1
  s_add_u32 s56, s56, 4096
  buffer_load_dwordx4 v[104:107], v2, s[28:31], s56 offen offset:0
  buffer_load_dwordx4 v[108:111], v2, s[28:31], s56 offen offset:2048
  s_mov_b64 exec, s[60:61]
  buffer_load_dwordx4 v[144:147], v2, s[28:31], s56 offen offset:1024
  buffer_load_dwordx4 v[148:151], v2, s[28:31], s56 offen offset:1280
  buffer_load_dwordx4 v[152:155], v2, s[28:31], s56 offen offset:3072
  buffer_load_dwordx4 v[156:159], v2, s[28:31], s56 offen offset:3328
  s_mov_b64 exec, -1
  s_add_u32 s56, s56, 4096
  buffer_load_dwordx4 v[112:115], v2, s[28:31], s56 offen offset:0
  buffer_load_dwordx4 v[116:119], v2, s[28:31], s56 offen offset:2048
  s_mov_b64 exec, s[60:61]
  buffer_load_dwordx4 v[160:163], v2, s[28:31], s56 offen offset:1024
  buffer_load_dwordx4 v[164:167], v2, s[28:31], s56 offen offset:1280
  buffer_load_dwordx4 v[168:171], v2, s[28:31], s56 offen offset:3072
  buffer_load_dwordx4 v[172:175], v2, s[28:31], s56 offen offset:3328
  s_mov_b64 exec, -1
  s_add_u32 s56, s56, 4096
  v_mov_b32 v64, 0
  v_mov_b32 v65, 0
  v_mov_b32 v66, 0
  v_mov_b32 v67, 0
  v_mov_b32 v68, 0
  v_mov_b32 v69, 0
  v_mov_b32 v70, 0
  v_mov_b32 v71, 0
  v_mov_b32 v72, 0
  v_mov_b32 v73, 0
  v_mov_b32 v74, 0
  v_mov_b32 v75, 0
  v_mov_b32 v76, 0
  v_mov_b32 v77, 0
  v_mov_b32 v78, 0
  v_mov_b32 v79, 0
  v_mov_b32 v80, 0
  v_mov_b32 v81, 0
  v_mov_b32 v82, 0
  v_mov_b32 v83, 0
  v_mov_b32 v84, 0
  v_mov_b32 v85, 0
  v_mov_b32 v86, 0
  v_mov_b32 v87, 0
  v_mov_b32 v88, 0
  v_mov_b32 v89, 0
  v_mov_b32 v90, 0
  v_mov_b32 v91, 0
  v_mov_b32 v92, 0
  v_mov_b32 v93, 0
  v_mov_b32 v94, 0
  v_mov_b32 v95, 0
  v_mov_b32 v40, 0
  v_mov_b32 v41, 0
  v_mov_b32 v42, 0
  v_mov_b32 v43, 0
  v_mov_b32 v44, 0
  v_mov_b32 v45, 0
  v_mov_b32 v46, 0
  v_mov_b32 v47, 0
  s_waitcnt vmcnt(12)
  v_mfma_f32_32x32x16_bf16 v[16:31], v[96:99], v[8:11], 0
  s_mov_b32 s55, 8
  s_nop 10
KG_LOOPB:
  v_sub_f32 v16, v16, v4
  v_exp_f32 v16, v16
  v_sub_f32 v17, v17, v4
  v_exp_f32 v17, v17
  v_smfmac_f32_32x32x32_bf16 v[80:95], v[188:191], v[40:47], v223
  v_sub_f32 v18, v18, v4
  v_exp_f32 v18, v18
  v_sub_f32 v19, v19, v4
  v_exp_f32 v19, v19
  v_sub_f32 v20, v20, v4
  v_exp_f32 v20, v20
  v_sub_f32 v21, v21, v4
  v_exp_f32 v21, v21
  v_mfma_f32_32x32x16_bf16 v[32:47], v[96:99], v[12:15], 0
  buffer_load_dwordx4 v[120:123], v2, s[28:31], s56 offen offset:0
  buffer_load_dwordx4 v[124:127], v2, s[28:31], s56 offen offset:2048
  s_mov_b64 exec, s[60:61]
  buffer_load_dwordx4 v[176:179], v2, s[28:31], s56 offen offset:1024
  buffer_load_dwordx4 v[180:183], v2, s[28:31], s56 offen offset:1280
  buffer_load_dwordx4 v[184:187], v2, s[28:31], s56 offen offset:3072
  buffer_load_dwordx4 v[188:191], v2, s[28:31], s56 offen offset:3328
  s_mov_b64 exec, -1
  s_add_u32 s56, s56, 4096
  v_sub_f32 v22, v22, v4
  v_exp_f32 v22, v22
  v_sub_f32 v23, v23, v4
  v_exp_f32 v23, v23
  v_sub_f32 v24, v24, v4
  v_exp_f32 v24, v24
  v_sub_f32 v25, v25, v4
  v_exp_f32 v25, v25
  v_smfmac_f32_32x32x32_bf16 v[64:79], v[128:131], v[16:23], v223
  v_sub_f32 v26, v26, v4
  v_exp_f32 v26, v26
  v_sub_f32 v27, v27, v4
  v_exp_f32 v27, v27
  v_sub_f32 v28, v28, v4
  v_exp_f32 v28, v28
  v_sub_f32 v29, v29, v4
  v_exp_f32 v29, v29
  v_sub_f32 v30, v30, v4
  v_exp_f32 v30, v30
  v_sub_f32 v31, v31, v4
  v_exp_f32 v31, v31
  v_sub_f32 v32, v32, v5
  v_exp_f32 v32, v32
  v_sub_f32 v33, v33, v5
  v_exp_f32 v33, v33
  v_smfmac_f32_32x32x32_bf16 v[64:79], v[132:135], v[24:31], v223
  v_sub_f32 v34, v34, v5
  v_exp_f32 v34, v34
  v_sub_f32 v35, v35, v5
  v_exp_f32 v35, v35
  v_sub_f32 v36, v36, v5
  v_exp_f32 v36, v36
  v_sub_f32 v37, v37, v5
  v_exp_f32 v37, v37
  v_mfma_f32_32x32x16_bf16 v[16:31], v[100:103], v[8:11], 0
  v_sub_f32 v38, v38, v5
  v_exp_f32 v38, v38
  v_sub_f32 v39, v39, v5
  v_exp_f32 v39, v39
  v_sub_f32 v40, v40, v5
  v_exp_f32 v40, v40
  v_sub_f32 v41, v41, v5
  v_exp_f32 v41, v41
  v_smfmac_f32_32x32x32_bf16 v[80:95], v[128:131], v[32:39], v223
  v_sub_f32 v42, v42, v5
  v_exp_f32 v42, v42
  v_sub_f32 v43, v43, v5
  v_exp_f32 v43, v43
  v_sub_f32 v44, v44, v5
  v_exp_f32 v44, v44
  v_sub_f32 v45, v45, v5
  v_exp_f32 v45, v45
  v_sub_f32 v46, v46, v5
  v_exp_f32 v46, v46
  v_sub_f32 v47, v47, v5
  v_exp_f32 v47, v47
  v_sub_f32 v16, v16, v4
  v_exp_f32 v16, v16
  v_sub_f32 v17, v17, v4
  v_exp_f32 v17, v17
  v_smfmac_f32_32x32x32_bf16 v[80:95], v[132:135], v[40:47], v223
  v_sub_f32 v18, v18, v4
  v_exp_f32 v18, v18
  v_sub_f32 v19, v19, v4
  v_exp_f32 v19, v19
  v_sub_f32 v20, v20, v4
  v_exp_f32 v20, v20
  v_sub_f32 v21, v21, v4
  v_exp_f32 v21, v21
  v_mfma_f32_32x32x16_bf16 v[32:47], v[100:103], v[12:15], 0
  v_sub_f32 v22, v22, v4
  v_exp_f32 v22, v22
  v_sub_f32 v23, v23, v4
  v_exp_f32 v23, v23
  v_sub_f32 v24, v24, v4
  v_exp_f32 v24, v24
  v_sub_f32 v25, v25, v4
  v_exp_f32 v25, v25
  v_smfmac_f32_32x32x32_bf16 v[64:79], v[136:139], v[16:23], v223
  v_sub_f32 v26, v26, v4
  v_exp_f32 v26, v26
  v_sub_f32 v27, v27, v4
  v_exp_f32 v27, v27
  v_sub_f32 v28, v28, v4
  v_exp_f32 v28, v28
  v_sub_f32 v29, v29, v4
  v_exp_f32 v29, v29
  v_sub_f32 v30, v30, v4
  v_exp_f32 v30, v30
  v_sub_f32 v31, v31, v4
  v_exp_f32 v31, v31
  v_sub_f32 v32, v32, v5
  v_exp_f32 v32, v32
  v_sub_f32 v33, v33, v5
  v_exp_f32 v33, v33
  v_smfmac_f32_32x32x32_bf16 v[64:79], v[140:143], v[24:31], v223
  v_sub_f32 v34, v34, v5
  v_exp_f32 v34, v34
  v_sub_f32 v35, v35, v5
  v_exp_f32 v35, v35
  v_sub_f32 v36, v36, v5
  v_exp_f32 v36, v36
  v_sub_f32 v37, v37, v5
  v_exp_f32 v37, v37
  s_waitcnt vmcnt(12)
  v_mfma_f32_32x32x16_bf16 v[16:31], v[104:107], v[8:11], 0
  v_sub_f32 v38, v38, v5
  v_exp_f32 v38, v38
  v_sub_f32 v39, v39, v5
  v_exp_f32 v39, v39
  v_sub_f32 v40, v40, v5
  v_exp_f32 v40, v40
  v_sub_f32 v41, v41, v5
  v_exp_f32 v41, v41
  v_smfmac_f32_32x32x32_bf16 v[80:95], v[136:139], v[32:39], v223
  v_sub_f32 v42, v42, v5
  v_exp_f32 v42, v42
  v_sub_f32 v43, v43, v5
  v_exp_f32 v43, v43
  v_sub_f32 v44, v44, v5
  v_exp_f32 v44, v44
  v_sub_f32 v45, v45, v5
  v_exp_f32 v45, v45
  v_sub_f32 v46, v46, v5
  v_exp_f32 v46, v46
  v_sub_f32 v47, v47, v5
  v_exp_f32 v47, v47
  v_sub_f32 v16, v16, v4
  v_exp_f32 v16, v16
  v_sub_f32 v17, v17, v4
  v_exp_f32 v17, v17
  v_smfmac_f32_32x32x32_bf16 v[80:95], v[140:143], v[40:47], v223
  v_sub_f32 v18, v18, v4
  v_exp_f32 v18, v18
  v_sub_f32 v19, v19, v4
  v_exp_f32 v19, v19
  v_sub_f32 v20, v20, v4
  v_exp_f32 v20, v20
  v_sub_f32 v21, v21, v4
  v_exp_f32 v21, v21
  v_mfma_f32_32x32x16_bf16 v[32:47], v[104:107], v[12:15], 0
  buffer_load_dwordx4 v[96:99], v2, s[28:31], s56 offen offset:0
  buffer_load_dwordx4 v[100:103], v2, s[28:31], s56 offen offset:2048
  s_mov_b64 exec, s[60:61]
  buffer_load_dwordx4 v[128:131], v2, s[28:31], s56 offen offset:1024
  buffer_load_dwordx4 v[132:135], v2, s[28:31], s56 offen offset:1280
  buffer_load_dwordx4 v[136:139], v2, s[28:31], s56 offen offset:3072
  buffer_load_dwordx4 v[140:143], v2, s[28:31], s56 offen offset:3328
  s_mov_b64 exec, -1
  s_add_u32 s56, s56, 4096
  v_sub_f32 v22, v22, v4
  v_exp_f32 v22, v22
  v_sub_f32 v23, v23, v4
  v_exp_f32 v23, v23
  v_sub_f32 v24, v24, v4
  v_exp_f32 v24, v24
  v_sub_f32 v25, v25, v4
  v_exp_f32 v25, v25
  v_smfmac_f32_32x32x32_bf16 v[64:79], v[144:147], v[16:23], v223
  v_sub_f32 v26, v26, v4
  v_exp_f32 v26, v26
  v_sub_f32 v27, v27, v4
  v_exp_f32 v27, v27
  v_sub_f32 v28, v28, v4
  v_exp_f32 v28, v28
  v_sub_f32 v29, v29, v4
  v_exp_f32 v29, v29
  v_sub_f32 v30, v30, v4
  v_exp_f32 v30, v30
  v_sub_f32 v31, v31, v4
  v_exp_f32 v31, v31
  v_sub_f32 v32, v32, v5
  v_exp_f32 v32, v32
  v_sub_f32 v33, v33, v5
  v_exp_f32 v33, v33
  v_smfmac_f32_32x32x32_bf16 v[64:79], v[148:151], v[24:31], v223
  v_sub_f32 v34, v34, v5
  v_exp_f32 v34, v34
  v_sub_f32 v35, v35, v5
  v_exp_f32 v35, v35
  v_sub_f32 v36, v36, v5
  v_exp_f32 v36, v36
  v_sub_f32 v37, v37, v5
  v_exp_f32 v37, v37
  v_mfma_f32_32x32x16_bf16 v[16:31], v[108:111], v[8:11], 0
  v_sub_f32 v38, v38, v5
  v_exp_f32 v38, v38
  v_sub_f32 v39, v39, v5
  v_exp_f32 v39, v39
  v_sub_f32 v40, v40, v5
  v_exp_f32 v40, v40
  v_sub_f32 v41, v41, v5
  v_exp_f32 v41, v41
  v_smfmac_f32_32x32x32_bf16 v[80:95], v[144:147], v[32:39], v223
  v_sub_f32 v42, v42, v5
  v_exp_f32 v42, v42
  v_sub_f32 v43, v43, v5
  v_exp_f32 v43, v43
  v_sub_f32 v44, v44, v5
  v_exp_f32 v44, v44
  v_sub_f32 v45, v45, v5
  v_exp_f32 v45, v45
  v_sub_f32 v46, v46, v5
  v_exp_f32 v46, v46
  v_sub_f32 v47, v47, v5
  v_exp_f32 v47, v47
  v_sub_f32 v16, v16, v4
  v_exp_f32 v16, v16
  v_sub_f32 v17, v17, v4
  v_exp_f32 v17, v17
  v_smfmac_f32_32x32x32_bf16 v[80:95], v[148:151], v[40:47], v223
  v_sub_f32 v18, v18, v4
  v_exp_f32 v18, v18
  v_sub_f32 v19, v19, v4
  v_exp_f32 v19, v19
  v_sub_f32 v20, v20, v4
  v_exp_f32 v20, v20
  v_sub_f32 v21, v21, v4
  v_exp_f32 v21, v21
  v_mfma_f32_32x32x16_bf16 v[32:47], v[108:111], v[12:15], 0
  v_sub_f32 v22, v22, v4
  v_exp_f32 v22, v22
  v_sub_f32 v23, v23, v4
  v_exp_f32 v23, v23
  v_sub_f32 v24, v24, v4
  v_exp_f32 v24, v24
  v_sub_f32 v25, v25, v4
  v_exp_f32 v25, v25
  v_smfmac_f32_32x32x32_bf16 v[64:79], v[152:155], v[16:23], v223
  v_sub_f32 v26, v26, v4
  v_exp_f32 v26, v26
  v_sub_f32 v27, v27, v4
  v_exp_f32 v27, v27
  v_sub_f32 v28, v28, v4
  v_exp_f32 v28, v28
  v_sub_f32 v29, v29, v4
  v_exp_f32 v29, v29
  v_sub_f32 v30, v30, v4
  v_exp_f32 v30, v30
  v_sub_f32 v31, v31, v4
  v_exp_f32 v31, v31
  v_sub_f32 v32, v32, v5
  v_exp_f32 v32, v32
  v_sub_f32 v33, v33, v5
  v_exp_f32 v33, v33
  v_smfmac_f32_32x32x32_bf16 v[64:79], v[156:159], v[24:31], v223
  v_sub_f32 v34, v34, v5
  v_exp_f32 v34, v34
  v_sub_f32 v35, v35, v5
  v_exp_f32 v35, v35
  v_sub_f32 v36, v36, v5
  v_exp_f32 v36, v36
  v_sub_f32 v37, v37, v5
  v_exp_f32 v37, v37
  s_waitcnt vmcnt(12)
  v_mfma_f32_32x32x16_bf16 v[16:31], v[112:115], v[8:11], 0
  v_sub_f32 v38, v38, v5
  v_exp_f32 v38, v38
  v_sub_f32 v39, v39, v5
  v_exp_f32 v39, v39
  v_sub_f32 v40, v40, v5
  v_exp_f32 v40, v40
  v_sub_f32 v41, v41, v5
  v_exp_f32 v41, v41
  v_smfmac_f32_32x32x32_bf16 v[80:95], v[152:155], v[32:39], v223
  v_sub_f32 v42, v42, v5
  v_exp_f32 v42, v42
  v_sub_f32 v43, v43, v5
  v_exp_f32 v43, v43
  v_sub_f32 v44, v44, v5
  v_exp_f32 v44, v44
  v_sub_f32 v45, v45, v5
  v_exp_f32 v45, v45
  v_sub_f32 v46, v46, v5
  v_exp_f32 v46, v46
  v_sub_f32 v47, v47, v5
  v_exp_f32 v47, v47
  v_sub_f32 v16, v16, v4
  v_exp_f32 v16, v16
  v_sub_f32 v17, v17, v4
  v_exp_f32 v17, v17
  v_smfmac_f32_32x32x32_bf16 v[80:95], v[156:159], v[40:47], v223
  v_sub_f32 v18, v18, v4
  v_exp_f32 v18, v18
  v_sub_f32 v19, v19, v4
  v_exp_f32 v19, v19
  v_sub_f32 v20, v20, v4
  v_exp_f32 v20, v20
  v_sub_f32 v21, v21, v4
  v_exp_f32 v21, v21
  v_mfma_f32_32x32x16_bf16 v[32:47], v[112:115], v[12:15], 0
  buffer_load_dwordx4 v[104:107], v2, s[28:31], s56 offen offset:0
  buffer_load_dwordx4 v[108:111], v2, s[28:31], s56 offen offset:2048
  s_mov_b64 exec, s[60:61]
  buffer_load_dwordx4 v[144:147], v2, s[28:31], s56 offen offset:1024
  buffer_load_dwordx4 v[148:151], v2, s[28:31], s56 offen offset:1280
  buffer_load_dwordx4 v[152:155], v2, s[28:31], s56 offen offset:3072
  buffer_load_dwordx4 v[156:159], v2, s[28:31], s56 offen offset:3328
  s_mov_b64 exec, -1
  s_add_u32 s56, s56, 4096
  v_sub_f32 v22, v22, v4
  v_exp_f32 v22, v22
  v_sub_f32 v23, v23, v4
  v_exp_f32 v23, v23
  v_sub_f32 v24, v24, v4
  v_exp_f32 v24, v24
  v_sub_f32 v25, v25, v4
  v_exp_f32 v25, v25
  v_smfmac_f32_32x32x32_bf16 v[64:79], v[160:163], v[16:23], v223
  v_sub_f32 v26, v26, v4
  v_exp_f32 v26, v26
  v_sub_f32 v27, v27, v4
  v_exp_f32 v27, v27
  v_sub_f32 v28, v28, v4
  v_exp_f32 v28, v28
  v_sub_f32 v29, v29, v4
  v_exp_f32 v29, v29
  v_sub_f32 v30, v30, v4
  v_exp_f32 v30, v30
  v_sub_f32 v31, v31, v4
  v_exp_f32 v31, v31
  v_sub_f32 v32, v32, v5
  v_exp_f32 v32, v32
  v_sub_f32 v33, v33, v5
  v_exp_f32 v33, v33
  v_smfmac_f32_32x32x32_bf16 v[64:79], v[164:167], v[24:31], v223
  v_sub_f32 v34, v34, v5
  v_exp_f32 v34, v34
  v_sub_f32 v35, v35, v5
  v_exp_f32 v35, v35
  v_sub_f32 v36, v36, v5
  v_exp_f32 v36, v36
  v_sub_f32 v37, v37, v5
  v_exp_f32 v37, v37
  v_mfma_f32_32x32x16_bf16 v[16:31], v[116:119], v[8:11], 0
  v_sub_f32 v38, v38, v5
  v_exp_f32 v38, v38
  v_sub_f32 v39, v39, v5
  v_exp_f32 v39, v39
  v_sub_f32 v40, v40, v5
  v_exp_f32 v40, v40
  v_sub_f32 v41, v41, v5
  v_exp_f32 v41, v41
  v_smfmac_f32_32x32x32_bf16 v[80:95], v[160:163], v[32:39], v223
  v_sub_f32 v42, v42, v5
  v_exp_f32 v42, v42
  v_sub_f32 v43, v43, v5
  v_exp_f32 v43, v43
  v_sub_f32 v44, v44, v5
  v_exp_f32 v44, v44
  v_sub_f32 v45, v45, v5
  v_exp_f32 v45, v45
  v_sub_f32 v46, v46, v5
  v_exp_f32 v46, v46
  v_sub_f32 v47, v47, v5
  v_exp_f32 v47, v47
  v_sub_f32 v16, v16, v4
  v_exp_f32 v16, v16
  v_sub_f32 v17, v17, v4
  v_exp_f32 v17, v17
  v_smfmac_f32_32x32x32_bf16 v[80:95], v[164:167], v[40:47], v223
  v_sub_f32 v18, v18, v4
  v_exp_f32 v18, v18
  v_sub_f32 v19, v19, v4
  v_exp_f32 v19, v19
  v_sub_f32 v20, v20, v4
  v_exp_f32 v20, v20
  v_sub_f32 v21, v21, v4
  v_exp_f32 v21, v21
  v_mfma_f32_32x32x16_bf16 v[32:47], v[116:119], v[12:15], 0
  v_sub_f32 v22, v22, v4
  v_exp_f32 v22, v22
  v_sub_f32 v23, v23, v4
  v_exp_f32 v23, v23
  v_sub_f32 v24, v24, v4
  v_exp_f32 v24, v24
  v_sub_f32 v25, v25, v4
  v_exp_f32 v25, v25
  v_smfmac_f32_32x32x32_bf16 v[64:79], v[168:171], v[16:23], v223
  v_sub_f32 v26, v26, v4
  v_exp_f32 v26, v26
  v_sub_f32 v27, v27, v4
  v_exp_f32 v27, v27
  v_sub_f32 v28, v28, v4
  v_exp_f32 v28, v28
  v_sub_f32 v29, v29, v4
  v_exp_f32 v29, v29
  v_sub_f32 v30, v30, v4
  v_exp_f32 v30, v30
  v_sub_f32 v31, v31, v4
  v_exp_f32 v31, v31
  v_sub_f32 v32, v32, v5
  v_exp_f32 v32, v32
  v_sub_f32 v33, v33, v5
  v_exp_f32 v33, v33
  v_smfmac_f32_32x32x32_bf16 v[64:79], v[172:175], v[24:31], v223
  v_sub_f32 v34, v34, v5
  v_exp_f32 v34, v34
  v_sub_f32 v35, v35, v5
  v_exp_f32 v35, v35
  v_sub_f32 v36, v36, v5
  v_exp_f32 v36, v36
  v_sub_f32 v37, v37, v5
  v_exp_f32 v37, v37
  s_waitcnt vmcnt(12)
  v_mfma_f32_32x32x16_bf16 v[16:31], v[120:123], v[8:11], 0
  v_sub_f32 v38, v38, v5
  v_exp_f32 v38, v38
  v_sub_f32 v39, v39, v5
  v_exp_f32 v39, v39
  v_sub_f32 v40, v40, v5
  v_exp_f32 v40, v40
  v_sub_f32 v41, v41, v5
  v_exp_f32 v41, v41
  v_smfmac_f32_32x32x32_bf16 v[80:95], v[168:171], v[32:39], v223
  v_sub_f32 v42, v42, v5
  v_exp_f32 v42, v42
  v_sub_f32 v43, v43, v5
  v_exp_f32 v43, v43
  v_sub_f32 v44, v44, v5
  v_exp_f32 v44, v44
  v_sub_f32 v45, v45, v5
  v_exp_f32 v45, v45
  v_sub_f32 v46, v46, v5
  v_exp_f32 v46, v46
  v_sub_f32 v47, v47, v5
  v_exp_f32 v47, v47
  v_sub_f32 v16, v16, v4
  v_exp_f32 v16, v16
  v_sub_f32 v17, v17, v4
  v_exp_f32 v17, v17
  v_smfmac_f32_32x32x32_bf16 v[80:95], v[172:175], v[40:47], v223
  v_sub_f32 v18, v18, v4
  v_exp_f32 v18, v18
  v_sub_f32 v19, v19, v4
  v_exp_f32 v19, v19
  v_sub_f32 v20, v20, v4
  v_exp_f32 v20, v20
  v_sub_f32 v21, v21, v4
  v_exp_f32 v21, v21
  v_mfma_f32_32x32x16_bf16 v[32:47], v[120:123], v[12:15], 0
  buffer_load_dwordx4 v[112:115], v2, s[28:31], s56 offen offset:0
  buffer_load_dwordx4 v[116:119], v2, s[28:31], s56 offen offset:2048
  s_mov_b64 exec, s[60:61]
  buffer_load_dwordx4 v[160:163], v2, s[28:31], s56 offen offset:1024
  buffer_load_dwordx4 v[164:167], v2, s[28:31], s56 offen offset:1280
  buffer_load_dwordx4 v[168:171], v2, s[28:31], s56 offen offset:3072
  buffer_load_dwordx4 v[172:175], v2, s[28:31], s56 offen offset:3328
  s_mov_b64 exec, -1
  s_add_u32 s56, s56, 4096
  v_sub_f32 v22, v22, v4
  v_exp_f32 v22, v22
  v_sub_f32 v23, v23, v4
  v_exp_f32 v23, v23
  v_sub_f32 v24, v24, v4
  v_exp_f32 v24, v24
  v_sub_f32 v25, v25, v4
  v_exp_f32 v25, v25
  v_smfmac_f32_32x32x32_bf16 v[64:79], v[176:179], v[16:23], v223
  v_sub_f32 v26, v26, v4
  v_exp_f32 v26, v26
  v_sub_f32 v27, v27, v4
  v_exp_f32 v27, v27
  v_sub_f32 v28, v28, v4
  v_exp_f32 v28, v28
  v_sub_f32 v29, v29, v4
  v_exp_f32 v29, v29
  v_sub_f32 v30, v30, v4
  v_exp_f32 v30, v30
  v_sub_f32 v31, v31, v4
  v_exp_f32 v31, v31
  v_sub_f32 v32, v32, v5
  v_exp_f32 v32, v32
  v_sub_f32 v33, v33, v5
  v_exp_f32 v33, v33
  v_smfmac_f32_32x32x32_bf16 v[64:79], v[180:183], v[24:31], v223
  v_sub_f32 v34, v34, v5
  v_exp_f32 v34, v34
  v_sub_f32 v35, v35, v5
  v_exp_f32 v35, v35
  v_sub_f32 v36, v36, v5
  v_exp_f32 v36, v36
  v_sub_f32 v37, v37, v5
  v_exp_f32 v37, v37
  v_mfma_f32_32x32x16_bf16 v[16:31], v[124:127], v[8:11], 0
  v_sub_f32 v38, v38, v5
  v_exp_f32 v38, v38
  v_sub_f32 v39, v39, v5
  v_exp_f32 v39, v39
  v_sub_f32 v40, v40, v5
  v_exp_f32 v40, v40
  v_sub_f32 v41, v41, v5
  v_exp_f32 v41, v41
  v_smfmac_f32_32x32x32_bf16 v[80:95], v[176:179], v[32:39], v223
  v_sub_f32 v42, v42, v5
  v_exp_f32 v42, v42
  v_sub_f32 v43, v43, v5
  v_exp_f32 v43, v43
  v_sub_f32 v44, v44, v5
  v_exp_f32 v44, v44
  v_sub_f32 v45, v45, v5
  v_exp_f32 v45, v45
  v_sub_f32 v46, v46, v5
  v_exp_f32 v46, v46
  v_sub_f32 v47, v47, v5
  v_exp_f32 v47, v47
  v_sub_f32 v16, v16, v4
  v_exp_f32 v16, v16
  v_sub_f32 v17, v17, v4
  v_exp_f32 v17, v17
  v_smfmac_f32_32x32x32_bf16 v[80:95], v[180:183], v[40:47], v223
  v_sub_f32 v18, v18, v4
  v_exp_f32 v18, v18
  v_sub_f32 v19, v19, v4
  v_exp_f32 v19, v19
  v_sub_f32 v20, v20, v4
  v_exp_f32 v20, v20
  v_sub_f32 v21, v21, v4
  v_exp_f32 v21, v21
  v_mfma_f32_32x32x16_bf16 v[32:47], v[124:127], v[12:15], 0
  v_sub_f32 v22, v22, v4
  v_exp_f32 v22, v22
  v_sub_f32 v23, v23, v4
  v_exp_f32 v23, v23
  v_sub_f32 v24, v24, v4
  v_exp_f32 v24, v24
  v_sub_f32 v25, v25, v4
  v_exp_f32 v25, v25
  v_smfmac_f32_32x32x32_bf16 v[64:79], v[184:187], v[16:23], v223
  v_sub_f32 v26, v26, v4
  v_exp_f32 v26, v26
  v_sub_f32 v27, v27, v4
  v_exp_f32 v27, v27
  v_sub_f32 v28, v28, v4
  v_exp_f32 v28, v28
  v_sub_f32 v29, v29, v4
  v_exp_f32 v29, v29
  v_sub_f32 v30, v30, v4
  v_exp_f32 v30, v30
  v_sub_f32 v31, v31, v4
  v_exp_f32 v31, v31
  v_sub_f32 v32, v32, v5
  v_exp_f32 v32, v32
  v_sub_f32 v33, v33, v5
  v_exp_f32 v33, v33
  v_smfmac_f32_32x32x32_bf16 v[64:79], v[188:191], v[24:31], v223
  v_sub_f32 v34, v34, v5
  v_exp_f32 v34, v34
  v_sub_f32 v35, v35, v5
  v_exp_f32 v35, v35
  v_sub_f32 v36, v36, v5
  v_exp_f32 v36, v36
  v_sub_f32 v37, v37, v5
  v_exp_f32 v37, v37
  s_waitcnt vmcnt(12)
  v_mfma_f32_32x32x16_bf16 v[16:31], v[96:99], v[8:11], 0
  v_sub_f32 v38, v38, v5
  v_exp_f32 v38, v38
  v_sub_f32 v39, v39, v5
  v_exp_f32 v39, v39
  v_sub_f32 v40, v40, v5
  v_exp_f32 v40, v40
  v_sub_f32 v41, v41, v5
  v_exp_f32 v41, v41
  v_smfmac_f32_32x32x32_bf16 v[80:95], v[184:187], v[32:39], v223
  v_sub_f32 v42, v42, v5
  v_exp_f32 v42, v42
  v_sub_f32 v43, v43, v5
  v_exp_f32 v43, v43
  v_sub_f32 v44, v44, v5
  v_exp_f32 v44, v44
  v_sub_f32 v45, v45, v5
  v_exp_f32 v45, v45
  v_sub_f32 v46, v46, v5
  v_exp_f32 v46, v46
  v_sub_f32 v47, v47, v5
  v_exp_f32 v47, v47
  s_sub_u32 s55, s55, 1
  s_cmp_lg_u32 s55, 0
  s_cbranch_scc1 KG_LOOPB
  v_smfmac_f32_32x32x32_bf16 v[80:95], v[188:191], v[40:47], v223
  s_nop 12
  v_rcp_f32 v202, v72
  s_nop 0
  v_pk_mul_f32 v[64:65], v[64:65], v[202:203] op_sel_hi:[1,0]
  v_pk_mul_f32 v[66:67], v[66:67], v[202:203] op_sel_hi:[1,0]
  v_pk_mul_f32 v[68:69], v[68:69], v[202:203] op_sel_hi:[1,0]
  v_pk_mul_f32 v[70:71], v[70:71], v[202:203] op_sel_hi:[1,0]
  v_cvt_pk_bf16_f32 v196, v64, v65
  v_cvt_pk_bf16_f32 v197, v66, v67
  v_cvt_pk_bf16_f32 v198, v68, v69
  v_cvt_pk_bf16_f32 v199, v70, v71
  v_min_u32 v199, -2, v199
  s_cmp_eq_u32 s69, 1
  s_cbranch_scc0 KG_SG17
  buffer_store_dwordx4 v[196:199], v2, s[28:31], s58 offen offset:0 nt
KG_SH17:
  ds_write_b32 v7, v209 offset:144
  v_rcp_f32 v202, v88
  s_nop 0
  s_branch KG_OUT
KG_SG14:
  buffer_store_dwordx4 v[196:199], v2, s[28:31], s58 offen offset:0 sc1
  s_branch KG_SH14
KG_SG15:
  buffer_store_dwordx4 v[196:199], v2, s[28:31], s58 offen offset:1024 sc1
  s_branch KG_SH15
KG_SG17:
  buffer_store_dwordx4 v[196:199], v2, s[28:31], s58 offen offset:0 sc1
  s_branch KG_SH17
KG_KV:
  s_lshl_b32 s67, s50, 5
  s_add_u32 s67, s67, s49
  s_mov_b32 s28, s14
  s_mov_b32 s29, s15
  s_mov_b32 s30, 11599872
  s_mov_b32 s31, 0x20000
  s_mov_b32 s57, s49
  v_bfe_u32 v9, v0, 2, 2
  v_and_b32 v10, 3, v0
  v_lshl_add_u32 v9, v2, 3, v9
  v_lshlrev_b32 v9, 5, v9
  v_lshl_add_u32 v9, v10, 3, v9
  v_add_u32 v5, 131328, v9
  s_lshl_b32 s53, s49, 12
  s_lshr_b32 s51, s58, 1
  s_lshl_b32 s51, s51, 11
  s_add_u32 s53, s53, s51
  s_and_b32 s51, s58, 1
  s_lshl_b32 s51, s51, 8
  s_add_u32 s53, s53, s51
  s_lshl_b32 s51, s59, 10
  s_add_u32 s53, s53, s51
  s_lshl_b32 s54, s53, 1
  s_add_u32 s53, s53, 2097152
  s_add_u32 s54, s54, 2621440
  s_add_u32 s55, s54, 0x40000
  s_lshl_b32 s56, s49, 3
  s_add_u32 s56, s56, s50
KG_LW18:
  ds_read_b32 v8, v7 offset:140
  s_waitcnt lgkmcnt(0)
  v_readfirstlane_b32 s51, v8
  s_cmp_ge_u32 s51, 1
  s_cbranch_scc1 KG_LD18
  s_sleep 1
  s_sub_u32 s72, s72, 1
  s_cbranch_scc0 KG_LW18
  s_mov_b32 s72, 0
KG_LD18:
  ds_read_b32 v8, v7 offset:100
  s_waitcnt lgkmcnt(0)
  v_readfirstlane_b32 s73, v8
  v_and_b32 v10, 1, v2
  v_lshrrev_b32 v11, 1, v2
  s_cmp_eq_u32 s59, 1
  s_cselect_b32 s51, 3, 9
  s_cselect_b32 s52, 9, 3
  v_lshlrev_b32 v12, s51, v10
  v_lshl_add_u32 v12, v1, 4, v12
  v_lshl_add_u32 v12, v11, s52, v12
  v_lshlrev_b32 v14, 1, v12
  v_mov_b32 v154, s73
  v_mov_b32 v155, s73
  v_mov_b32 v156, 1
  s_getreg_b32 s51, hwreg(HW_REG_XCC_ID, 0, 4)
  s_lshl_b32 s51, s51, 28
  s_xor_b32 s69, s73, s51
  s_mov_b32 s52, 1052289595
  v_lshrrev_b32 v10, 1, v1
  v_xor_b32 v10, v2, v10
  v_lshlrev_b32 v10, 4, v10
  v_lshl_add_u32 v10, v1, 7, v10
  s_lshl_b32 s51, s58, 11
  v_add_u32 v10, s51, v10
  v_xor_b32 v11, 64, v10
  v_mov_b32 v158, 8
  s_waitcnt vmcnt(17)
  ds_write_b32 v7, v158 offset:12
  ds_read_b128 v[16:19], v10 offset:0
  ds_read_b128 v[20:23], v11 offset:0
  ds_read_b128 v[24:27], v10 offset:8192
  ds_read_b128 v[28:31], v11 offset:8192
  ds_read_b128 v[32:35], v10 offset:16384
  ds_read_b128 v[36:39], v11 offset:16384
  ds_read_b128 v[40:43], v10 offset:24576
  ds_read_b128 v[44:47], v11 offset:24576
  ds_read_b128 v[48:51], v10 offset:32768
  ds_read_b128 v[52:55], v11 offset:32768
  ds_read_b128 v[56:59], v10 offset:40960
  ds_read_b128 v[60:63], v11 offset:40960
  ds_read_b128 v[64:67], v10 offset:49152
  ds_read_b128 v[68:71], v11 offset:49152
  ds_read_b128 v[72:75], v10 offset:57344
  ds_read_b128 v[76:79], v11 offset:57344
  s_waitcnt vmcnt(1) lgkmcnt(0)
  ds_read_b64_tr_b16 v[80:81], v5 offset:0
  ds_read_b64_tr_b16 v[82:83], v5 offset:128
  ds_read_b64_tr_b16 v[84:85], v5 offset:1024
  ds_read_b64_tr_b16 v[86:87], v5 offset:1152
  ds_read_b64_tr_b16 v[88:89], v5 offset:2048
  ds_read_b64_tr_b16 v[90:91], v5 offset:2176
  ds_read_b64_tr_b16 v[92:93], v5 offset:3072
  ds_read_b64_tr_b16 v[94:95], v5 offset:3200
  ds_read_b64_tr_b16 v[96:97], v5 offset:4096
  ds_read_b64_tr_b16 v[98:99], v5 offset:4224
  ds_read_b64_tr_b16 v[100:101], v5 offset:5120
  ds_read_b64_tr_b16 v[102:103], v5 offset:5248
  ds_read_b64_tr_b16 v[104:105], v5 offset:6144
  ds_read_b64_tr_b16 v[106:107], v5 offset:6272
  s_cmp_eq_u32 s59, 1
  s_cbranch_scc1 KG_KV1
  s_waitcnt lgkmcnt(12)
  v_mfma_f32_16x16x32_bf16 v[144:147], v[80:83], v[16:19], 0
  ds_read_b64_tr_b16 v[108:109], v5 offset:7168
  ds_read_b64_tr_b16 v[110:111], v5 offset:7296
  s_waitcnt lgkmcnt(12)
  v_mfma_f32_16x16x32_bf16 v[148:151], v[84:87], v[20:23], 0
  ds_read_b64_tr_b16 v[112:113], v5 offset:8192
  ds_read_b64_tr_b16 v[114:115], v5 offset:8320
  s_waitcnt lgkmcnt(12)
  v_mfma_f32_16x16x32_bf16 v[144:147], v[88:91], v[24:27], v[144:147]
  ds_read_b64_tr_b16 v[116:117], v5 offset:9216
  ds_read_b64_tr_b16 v[118:119], v5 offset:9344
  s_waitcnt lgkmcnt(12)
  v_mfma_f32_16x16x32_bf16 v[148:151], v[92:95], v[28:31], v[148:151]
  ds_read_b64_tr_b16 v[120:121], v5 offset:10240
  ds_read_b64_tr_b16 v[122:123], v5 offset:10368
  s_waitcnt lgkmcnt(12)
  v_mfma_f32_16x16x32_bf16 v[144:147], v[96:99], v[32:35], v[144:147]
  ds_read_b64_tr_b16 v[124:125], v5 offset:11264
  ds_read_b64_tr_b16 v[126:127], v5 offset:11392
  s_waitcnt lgkmcnt(12)
  v_mfma_f32_16x16x32_bf16 v[148:151], v[100:103], v[36:39], v[148:151]
  ds_read_b64_tr_b16 v[128:129], v5 offset:12288
  ds_read_b64_tr_b16 v[130:131], v5 offset:12416
  s_waitcnt lgkmcnt(12)
  v_mfma_f32_16x16x32_bf16 v[144:147], v[104:107], v[40:43], v[144:147]
  ds_read_b64_tr_b16 v[132:133], v5 offset:13312
  ds_read_b64_tr_b16 v[134:135], v5 offset:13440
  s_waitcnt lgkmcnt(12)
  v_mfma_f32_16x16x32_bf16 v[148:151], v[108:111], v[44:47], v[148:151]
  ds_read_b64_tr_b16 v[136:137], v5 offset:14336
  ds_read_b64_tr_b16 v[138:139], v5 offset:14464
  s_waitcnt lgkmcnt(12)
  v_mfma_f32_16x16x32_bf16 v[144:147], v[112:115], v[48:51], v[144:147]
  ds_read_b64_tr_b16 v[140:141], v5 offset:15360
  ds_read_b64_tr_b16 v[142:143], v5 offset:15488
  s_waitcnt lgkmcnt(12)
  v_mfma_f32_16x16x32_bf16 v[148:151], v[116:119], v[52:55], v[148:151]
  s_waitcnt lgkmcnt(10)
  v_mfma_f32_16x16x32_bf16 v[144:147], v[120:123], v[56:59], v[144:147]
  s_waitcnt lgkmcnt(8)
  v_mfma_f32_16x16x32_bf16 v[148:151], v[124:127], v[60:63], v[148:151]
  s_waitcnt lgkmcnt(6)
  v_mfma_f32_16x16x32_bf16 v[144:147], v[128:131], v[64:67], v[144:147]
  s_waitcnt lgkmcnt(4)
  v_mfma_f32_16x16x32_bf16 v[148:151], v[132:135], v[68:71], v[148:151]
  s_waitcnt lgkmcnt(2)
  v_mfma_f32_16x16x32_bf16 v[144:147], v[136:139], v[72:75], v[144:147]
  s_waitcnt lgkmcnt(0)
  v_mfma_f32_16x16x32_bf16 v[148:151], v[140:143], v[76:79], v[148:151]
  ds_write_b32 v7, v156 offset:152
  s_nop 7
  v_add_f32 v144, v144, v148
  v_add_f32 v145, v145, v149
  v_add_f32 v146, v146, v150
  v_add_f32 v147, v147, v151
  v_mul_f32 v144, s52, v144
  v_mul_f32 v145, s52, v145
  v_mul_f32 v146, s52, v146
  v_mul_f32 v147, s52, v147
  v_cvt_pk_bf16_f32 v152, v144, v145
  v_cvt_pk_bf16_f32 v153, v146, v147
  buffer_store_dwordx4 v[152:155], v14, s[28:31], s54 offen
  buffer_store_dwordx2 v[152:153], v12, s[28:31], s53 offen sc1
  buffer_store_dwordx4 v[152:155], v14, s[28:31], s55 offen sc1
  s_waitcnt vmcnt(0)
  s_lshr_b32 s51, s56, 2
  s_lshl_b32 s51, s51, 7
  s_and_b32 s52, s56, 3
  s_lshl_b32 s52, s52, 2
  s_add_u32 s51, s51, s52
  s_add_u32 s51, s51, 2375680
  v_mov_b32 v8, 0
  v_mov_b32 v9, s69
  s_mov_b64 exec, 1
  buffer_store_dword v9, v8, s[28:31], s51 offen sc1
  s_mov_b64 exec, -1
  v_lshlrev_b32 v10, 4, v2
  v_add_u32 v10, 147712, v10
  ds_read_b128 v[80:83], v10 offset:0
  ds_read_b128 v[84:87], v10 offset:64
  ds_read_b128 v[88:91], v10 offset:128
  ds_read_b128 v[92:95], v10 offset:192
  ds_read_b128 v[96:99], v10 offset:256
  ds_read_b128 v[100:103], v10 offset:320
  ds_read_b128 v[104:107], v10 offset:384
  ds_read_b128 v[108:111], v10 offset:448
  s_waitcnt lgkmcnt(7)
  v_mfma_f32_16x16x32_bf16 v[144:147], v[80:83], v[16:19], 0
  s_waitcnt lgkmcnt(6)
  v_mfma_f32_16x16x32_bf16 v[144:147], v[84:87], v[20:23], v[144:147]
  s_waitcnt lgkmcnt(5)
  v_mfma_f32_16x16x32_bf16 v[144:147], v[88:91], v[24:27], v[144:147]
  s_waitcnt lgkmcnt(4)
  v_mfma_f32_16x16x32_bf16 v[144:147], v[92:95], v[28:31], v[144:147]
  s_waitcnt lgkmcnt(3)
  v_mfma_f32_16x16x32_bf16 v[144:147], v[96:99], v[32:35], v[144:147]
  s_waitcnt lgkmcnt(2)
  v_mfma_f32_16x16x32_bf16 v[144:147], v[100:103], v[36:39], v[144:147]
  s_waitcnt lgkmcnt(1)
  v_mfma_f32_16x16x32_bf16 v[144:147], v[104:107], v[40:43], v[144:147]
  s_waitcnt lgkmcnt(0)
  v_mfma_f32_16x16x32_bf16 v[144:147], v[108:111], v[44:47], v[144:147]
  ds_read_b128 v[112:115], v10 offset:512
  ds_read_b128 v[116:119], v10 offset:576
  ds_read_b128 v[120:123], v10 offset:640
  ds_read_b128 v[124:127], v10 offset:704
  ds_read_b128 v[128:131], v10 offset:768
  ds_read_b128 v[132:135], v10 offset:832
  ds_read_b128 v[136:139], v10 offset:896
  ds_read_b128 v[140:143], v10 offset:960
  s_waitcnt lgkmcnt(7)
  v_mfma_f32_16x16x32_bf16 v[144:147], v[112:115], v[48:51], v[144:147]
  s_waitcnt lgkmcnt(6)
  v_mfma_f32_16x16x32_bf16 v[144:147], v[116:119], v[52:55], v[144:147]
  s_waitcnt lgkmcnt(5)
  v_mfma_f32_16x16x32_bf16 v[144:147], v[120:123], v[56:59], v[144:147]
  s_waitcnt lgkmcnt(4)
  v_mfma_f32_16x16x32_bf16 v[144:147], v[124:127], v[60:63], v[144:147]
  s_waitcnt lgkmcnt(3)
  v_mfma_f32_16x16x32_bf16 v[144:147], v[128:131], v[64:67], v[144:147]
  s_waitcnt lgkmcnt(2)
  v_mfma_f32_16x16x32_bf16 v[144:147], v[132:135], v[68:71], v[144:147]
  s_waitcnt lgkmcnt(1)
  v_mfma_f32_16x16x32_bf16 v[144:147], v[136:139], v[72:75], v[144:147]
  s_waitcnt lgkmcnt(0)
  v_mfma_f32_16x16x32_bf16 v[144:147], v[140:143], v[76:79], v[144:147]
  s_lshl_b32 s51, s57, 8
  s_lshl_b32 s52, s58, 6
  s_add_u32 s51, s51, s52
  s_add_u32 s52, s51, 2293760
  v_lshlrev_b32 v10, 2, v1
  s_nop 6
  v_cvt_pk_bf16_f32 v11, v144, v144
  v_lshlrev_b32 v11, 16, v11
  s_mov_b32 s51, 3216550459
  v_mul_f32 v11, s51, v11
  v_exp_f32 v11, v11
  s_nop 0
  v_add_f32 v11, 1.0, v11
  v_rcp_f32 v11, v11
  s_nop 0
  v_cvt_pk_bf16_f32 v11, v11, v11
  v_lshlrev_b32 v11, 16, v11
  s_mov_b64 exec, 0xffff
  buffer_store_dword v11, v10, s[28:31], s52 offen sc1
  s_mov_b64 exec, -1
  s_branch KG_KP
KG_KV1:
  s_waitcnt lgkmcnt(12)
  v_mfma_f32_16x16x32_bf16 v[144:147], v[16:19], v[80:83], 0
  ds_read_b64_tr_b16 v[108:109], v5 offset:7168
  ds_read_b64_tr_b16 v[110:111], v5 offset:7296
  s_waitcnt lgkmcnt(12)
  v_mfma_f32_16x16x32_bf16 v[148:151], v[20:23], v[84:87], 0
  ds_read_b64_tr_b16 v[112:113], v5 offset:8192
  ds_read_b64_tr_b16 v[114:115], v5 offset:8320
  s_waitcnt lgkmcnt(12)
  v_mfma_f32_16x16x32_bf16 v[144:147], v[24:27], v[88:91], v[144:147]
  ds_read_b64_tr_b16 v[116:117], v5 offset:9216
  ds_read_b64_tr_b16 v[118:119], v5 offset:9344
  s_waitcnt lgkmcnt(12)
  v_mfma_f32_16x16x32_bf16 v[148:151], v[28:31], v[92:95], v[148:151]
  ds_read_b64_tr_b16 v[120:121], v5 offset:10240
  ds_read_b64_tr_b16 v[122:123], v5 offset:10368
  s_waitcnt lgkmcnt(12)
  v_mfma_f32_16x16x32_bf16 v[144:147], v[32:35], v[96:99], v[144:147]
  ds_read_b64_tr_b16 v[124:125], v5 offset:11264
  ds_read_b64_tr_b16 v[126:127], v5 offset:11392
  s_waitcnt lgkmcnt(12)
  v_mfma_f32_16x16x32_bf16 v[148:151], v[36:39], v[100:103], v[148:151]
  ds_read_b64_tr_b16 v[128:129], v5 offset:12288
  ds_read_b64_tr_b16 v[130:131], v5 offset:12416
  s_waitcnt lgkmcnt(12)
  v_mfma_f32_16x16x32_bf16 v[144:147], v[40:43], v[104:107], v[144:147]
  ds_read_b64_tr_b16 v[132:133], v5 offset:13312
  ds_read_b64_tr_b16 v[134:135], v5 offset:13440
  s_waitcnt lgkmcnt(12)
  v_mfma_f32_16x16x32_bf16 v[148:151], v[44:47], v[108:111], v[148:151]
  ds_read_b64_tr_b16 v[136:137], v5 offset:14336
  ds_read_b64_tr_b16 v[138:139], v5 offset:14464
  s_waitcnt lgkmcnt(12)
  v_mfma_f32_16x16x32_bf16 v[144:147], v[48:51], v[112:115], v[144:147]
  ds_read_b64_tr_b16 v[140:141], v5 offset:15360
  ds_read_b64_tr_b16 v[142:143], v5 offset:15488
  s_waitcnt lgkmcnt(12)
  v_mfma_f32_16x16x32_bf16 v[148:151], v[52:55], v[116:119], v[148:151]
  s_waitcnt lgkmcnt(10)
  v_mfma_f32_16x16x32_bf16 v[144:147], v[56:59], v[120:123], v[144:147]
  s_waitcnt lgkmcnt(8)
  v_mfma_f32_16x16x32_bf16 v[148:151], v[60:63], v[124:127], v[148:151]
  s_waitcnt lgkmcnt(6)
  v_mfma_f32_16x16x32_bf16 v[144:147], v[64:67], v[128:131], v[144:147]
  s_waitcnt lgkmcnt(4)
  v_mfma_f32_16x16x32_bf16 v[148:151], v[68:71], v[132:135], v[148:151]
  s_waitcnt lgkmcnt(2)
  v_mfma_f32_16x16x32_bf16 v[144:147], v[72:75], v[136:139], v[144:147]
  s_waitcnt lgkmcnt(0)
  v_mfma_f32_16x16x32_bf16 v[148:151], v[76:79], v[140:143], v[148:151]
  ds_write_b32 v7, v156 offset:152
  s_nop 7
  v_add_f32 v144, v144, v148
  v_add_f32 v145, v145, v149
  v_add_f32 v146, v146, v150
  v_add_f32 v147, v147, v151
  v_cvt_pk_bf16_f32 v152, v144, v145
  v_cvt_pk_bf16_f32 v153, v146, v147
  buffer_store_dwordx4 v[152:155], v14, s[28:31], s54 offen
  buffer_store_dwordx2 v[152:153], v12, s[28:31], s53 offen sc1
  buffer_store_dwordx4 v[152:155], v14, s[28:31], s55 offen sc1
  s_waitcnt vmcnt(0)
  s_lshr_b32 s51, s56, 2
  s_lshl_b32 s51, s51, 7
  s_and_b32 s52, s56, 3
  s_lshl_b32 s52, s52, 2
  s_add_u32 s51, s51, s52
  s_add_u32 s51, s51, 2375680
  v_mov_b32 v8, 0
  v_mov_b32 v9, s69
  s_mov_b64 exec, 1
  buffer_store_dword v9, v8, s[28:31], s51 offen sc1
  s_mov_b64 exec, -1
  s_branch KG_KP
KG_TAG:
  s_lshl_b32 s67, s50, 5
  s_add_u32 s67, s67, s49
  s_mov_b32 s28, s14
  s_mov_b32 s29, s15
  s_mov_b32 s30, 11599872
  s_mov_b32 s31, 0x20000
  s_waitcnt vmcnt(0)
  v_readfirstlane_b32 s73, v11
  s_mul_i32 s73, s73, 2654435761
  s_add_u32 s73, s73, 2135587861
  v_mov_b32 v9, 1
  v_mov_b32 v11, s73
  ds_write_b32 v7, v11 offset:100
  ds_write_b32 v7, v9 offset:140
  s_and_b32 s51, s2, 7
  s_lshl_b32 s59, s51, 15
  s_add_u32 s59, s59, 2621440
  s_movk_i32 s58, 0x1ff
  v_lshlrev_b32 v4, 3, v0
  v_add_u32 v4, 131328, v4
KG_LW19:
  ds_read_b32 v12, v7 offset:4
  s_waitcnt lgkmcnt(0)
  v_readfirstlane_b32 s51, v12
  s_cmp_ge_u32 s51, 2
  s_cbranch_scc1 KG_LD19
  s_sleep 2
  s_sub_u32 s72, s72, 1
  s_cbranch_scc0 KG_LW19
  s_mov_b32 s72, 0
KG_LD19:
KG_LW20:
  ds_read_b32 v12, v7 offset:152
  s_waitcnt lgkmcnt(0)
  v_readfirstlane_b32 s51, v12
  s_cmp_ge_u32 s51, 1
  s_cbranch_scc1 KG_LD20
  s_sleep 1
  s_sub_u32 s72, s72, 1
  s_cbranch_scc0 KG_LW20
  s_mov_b32 s72, 0
KG_LD20:
  v_mov_b32 v14, 0
  s_add_u32 s51, s59, 0
  buffer_load_dwordx4 v[16:19], v3, s[28:31], s51 offen offset:0 sc1
  buffer_load_dwordx4 v[20:23], v3, s[28:31], s51 offen offset:1024 sc1
  buffer_load_dwordx4 v[24:27], v3, s[28:31], s51 offen offset:2048 sc1
  buffer_load_dwordx4 v[28:31], v3, s[28:31], s51 offen offset:3072 sc1
  s_add_u32 s51, s59, 4096
  buffer_load_dwordx4 v[32:35], v3, s[28:31], s51 offen offset:0 sc1
  buffer_load_dwordx4 v[36:39], v3, s[28:31], s51 offen offset:1024 sc1
  buffer_load_dwordx4 v[40:43], v3, s[28:31], s51 offen offset:2048 sc1
  buffer_load_dwordx4 v[44:47], v3, s[28:31], s51 offen offset:3072 sc1
  s_add_u32 s51, s59, 8192
  buffer_load_dwordx4 v[48:51], v3, s[28:31], s51 offen offset:0 sc1
  buffer_load_dwordx4 v[52:55], v3, s[28:31], s51 offen offset:1024 sc1
  buffer_load_dwordx4 v[56:59], v3, s[28:31], s51 offen offset:2048 sc1
  buffer_load_dwordx4 v[60:63], v3, s[28:31], s51 offen offset:3072 sc1
  s_waitcnt vmcnt(8)
  v_cmpx_eq_u32 vcc, s73, v18
  v_cmpx_eq_u32 vcc, s73, v22
  v_cmpx_eq_u32 vcc, s73, v26
  v_cmpx_eq_u32 vcc, s73, v30
  s_cmp_eq_u64 exec, -1
  s_mov_b64 exec, -1
  s_cbranch_scc0 KG_GF0_0
  ds_write_b64 v4, v[16:17] offset:0
  ds_write_b64 v4, v[20:21] offset:512
  ds_write_b64 v4, v[24:25] offset:1024
  ds_write_b64 v4, v[28:29] offset:1536
  v_add_u32 v14, 1, v14
  s_bitset0_b32 s58, 0
  v_add_u32 v4, 0x800, v4
  ds_write_b32 v7, v14 offset:8
KG_GF0_0:
  s_waitcnt vmcnt(4)
  v_cmpx_eq_u32 vcc, s73, v34
  v_cmpx_eq_u32 vcc, s73, v38
  v_cmpx_eq_u32 vcc, s73, v42
  v_cmpx_eq_u32 vcc, s73, v46
  s_cmp_eq_u64 exec, -1
  s_mov_b64 exec, -1
  s_cbranch_scc0 KG_GF0_1
  ds_write_b64 v4, v[32:33] offset:0
  ds_write_b64 v4, v[36:37] offset:512
  ds_write_b64 v4, v[40:41] offset:1024
  ds_write_b64 v4, v[44:45] offset:1536
  v_add_u32 v14, 1, v14
  s_bitset0_b32 s58, 1
  v_add_u32 v4, 0x800, v4
  ds_write_b32 v7, v14 offset:8
KG_GF0_1:
  s_waitcnt vmcnt(0)
  v_cmpx_eq_u32 vcc, s73, v50
  v_cmpx_eq_u32 vcc, s73, v54
  v_cmpx_eq_u32 vcc, s73, v58
  v_cmpx_eq_u32 vcc, s73, v62
  s_cmp_eq_u64 exec, -1
  s_mov_b64 exec, -1
  s_cbranch_scc0 KG_GF0_2
  ds_write_b64 v4, v[48:49] offset:0
  ds_write_b64 v4, v[52:53] offset:512
  ds_write_b64 v4, v[56:57] offset:1024
  ds_write_b64 v4, v[60:61] offset:1536
  v_add_u32 v14, 1, v14
  s_bitset0_b32 s58, 2
  v_add_u32 v4, 0x800, v4
  ds_write_b32 v7, v14 offset:8
KG_GF0_2:
  s_movk_i32 s57, 7
  s_mov_b32 s55, 262144
KG_GR:
  s_sub_u32 s55, s55, 1
  s_cbranch_scc1 KG_GE
  s_cmp_eq_u32 s58, 0x100
  s_cbranch_scc1 KG_GE
  s_cmp_eq_u32 s57, 0xff
  s_cbranch_scc1 KG_GA
  ds_read_b64 v[12:13], v7 offset:0
  s_waitcnt lgkmcnt(0)
  v_min_u32 v12, v12, v13
  s_nop 0
  v_readfirstlane_b32 s51, v12
  s_cmp_lt_u32 s51, 6
  s_cbranch_scc1 KG_GA
  s_movk_i32 s57, 0xff
  s_add_u32 s51, s59, 12288
  buffer_load_dwordx4 v[64:67], v3, s[28:31], s51 offen offset:0 sc1
  buffer_load_dwordx4 v[68:71], v3, s[28:31], s51 offen offset:1024 sc1
  buffer_load_dwordx4 v[72:75], v3, s[28:31], s51 offen offset:2048 sc1
  buffer_load_dwordx4 v[76:79], v3, s[28:31], s51 offen offset:3072 sc1
  s_add_u32 s51, s59, 16384
  buffer_load_dwordx4 v[80:83], v3, s[28:31], s51 offen offset:0 sc1
  buffer_load_dwordx4 v[84:87], v3, s[28:31], s51 offen offset:1024 sc1
  buffer_load_dwordx4 v[88:91], v3, s[28:31], s51 offen offset:2048 sc1
  buffer_load_dwordx4 v[92:95], v3, s[28:31], s51 offen offset:3072 sc1
  s_add_u32 s51, s59, 20480
  buffer_load_dwordx4 v[96:99], v3, s[28:31], s51 offen offset:0 sc1
  buffer_load_dwordx4 v[100:103], v3, s[28:31], s51 offen offset:1024 sc1
  buffer_load_dwordx4 v[104:107], v3, s[28:31], s51 offen offset:2048 sc1
  buffer_load_dwordx4 v[108:111], v3, s[28:31], s51 offen offset:3072 sc1
  s_add_u32 s51, s59, 24576
  buffer_load_dwordx4 v[112:115], v3, s[28:31], s51 offen offset:0 sc1
  buffer_load_dwordx4 v[116:119], v3, s[28:31], s51 offen offset:1024 sc1
  buffer_load_dwordx4 v[120:123], v3, s[28:31], s51 offen offset:2048 sc1
  buffer_load_dwordx4 v[124:127], v3, s[28:31], s51 offen offset:3072 sc1
  s_add_u32 s51, s59, 28672
  buffer_load_dwordx4 v[128:131], v3, s[28:31], s51 offen offset:0 sc1
  buffer_load_dwordx4 v[132:135], v3, s[28:31], s51 offen offset:1024 sc1
  buffer_load_dwordx4 v[136:139], v3, s[28:31], s51 offen offset:2048 sc1
  buffer_load_dwordx4 v[140:143], v3, s[28:31], s51 offen offset:3072 sc1
  ds_write_b32 v7, v9 offset:156
  s_waitcnt vmcnt(16)
  v_cmpx_eq_u32 vcc, s73, v66
  v_cmpx_eq_u32 vcc, s73, v70
  v_cmpx_eq_u32 vcc, s73, v74
  v_cmpx_eq_u32 vcc, s73, v78
  s_cmp_eq_u64 exec, -1
  s_mov_b64 exec, -1
  s_cbranch_scc0 KG_GF0_3
  ds_write_b64 v4, v[64:65] offset:0
  ds_write_b64 v4, v[68:69] offset:512
  ds_write_b64 v4, v[72:73] offset:1024
  ds_write_b64 v4, v[76:77] offset:1536
  v_add_u32 v14, 1, v14
  s_bitset0_b32 s58, 3
  v_add_u32 v4, 0x800, v4
  ds_write_b32 v7, v14 offset:8
KG_GF0_3:
  s_waitcnt vmcnt(12)
  v_cmpx_eq_u32 vcc, s73, v82
  v_cmpx_eq_u32 vcc, s73, v86
  v_cmpx_eq_u32 vcc, s73, v90
  v_cmpx_eq_u32 vcc, s73, v94
  s_cmp_eq_u64 exec, -1
  s_mov_b64 exec, -1
  s_cbranch_scc0 KG_GF0_4
  ds_write_b64 v4, v[80:81] offset:0
  ds_write_b64 v4, v[84:85] offset:512
  ds_write_b64 v4, v[88:89] offset:1024
  ds_write_b64 v4, v[92:93] offset:1536
  v_add_u32 v14, 1, v14
  s_bitset0_b32 s58, 4
  v_add_u32 v4, 0x800, v4
  ds_write_b32 v7, v14 offset:8
KG_GF0_4:
  s_waitcnt vmcnt(8)
  v_cmpx_eq_u32 vcc, s73, v98
  v_cmpx_eq_u32 vcc, s73, v102
  v_cmpx_eq_u32 vcc, s73, v106
  v_cmpx_eq_u32 vcc, s73, v110
  s_cmp_eq_u64 exec, -1
  s_mov_b64 exec, -1
  s_cbranch_scc0 KG_GF0_5
  ds_write_b64 v4, v[96:97] offset:0
  ds_write_b64 v4, v[100:101] offset:512
  ds_write_b64 v4, v[104:105] offset:1024
  ds_write_b64 v4, v[108:109] offset:1536
  v_add_u32 v14, 1, v14
  s_bitset0_b32 s58, 5
  v_add_u32 v4, 0x800, v4
  ds_write_b32 v7, v14 offset:8
KG_GF0_5:
  s_waitcnt vmcnt(4)
  v_cmpx_eq_u32 vcc, s73, v114
  v_cmpx_eq_u32 vcc, s73, v118
  v_cmpx_eq_u32 vcc, s73, v122
  v_cmpx_eq_u32 vcc, s73, v126
  s_cmp_eq_u64 exec, -1
  s_mov_b64 exec, -1
  s_cbranch_scc0 KG_GF0_6
  ds_write_b64 v4, v[112:113] offset:0
  ds_write_b64 v4, v[116:117] offset:512
  ds_write_b64 v4, v[120:121] offset:1024
  ds_write_b64 v4, v[124:125] offset:1536
  v_add_u32 v14, 1, v14
  s_bitset0_b32 s58, 6
  v_add_u32 v4, 0x800, v4
  ds_write_b32 v7, v14 offset:8
KG_GF0_6:
  s_waitcnt vmcnt(0)
  v_cmpx_eq_u32 vcc, s73, v130
  v_cmpx_eq_u32 vcc, s73, v134
  v_cmpx_eq_u32 vcc, s73, v138
  v_cmpx_eq_u32 vcc, s73, v142
  s_cmp_eq_u64 exec, -1
  s_mov_b64 exec, -1
  s_cbranch_scc0 KG_GF0_7
  ds_write_b64 v4, v[128:129] offset:0
  ds_write_b64 v4, v[132:133] offset:512
  ds_write_b64 v4, v[136:137] offset:1024
  ds_write_b64 v4, v[140:141] offset:1536
  v_add_u32 v14, 1, v14
  s_bitset0_b32 s58, 7
  v_add_u32 v4, 0x800, v4
  ds_write_b32 v7, v14 offset:8
KG_GF0_7:
  s_branch KG_GR
KG_GA:
  s_and_b32 s53, s58, s57
  s_cbranch_scc1 KG_GB
  s_sleep 1
  s_branch KG_GR
KG_GB:
  s_bitset0_b32 s59, 18
  s_and_b32 s51, s55, 3
  s_cbranch_scc1 KG_GC
  s_bitset1_b32 s59, 18
KG_GC:
  s_bitcmp1_b32 s53, 0
  s_cbranch_scc0 KG_GL0
  s_add_u32 s51, s59, 0
  buffer_load_dwordx4 v[16:19], v3, s[28:31], s51 offen offset:0 sc1
  buffer_load_dwordx4 v[20:23], v3, s[28:31], s51 offen offset:1024 sc1
  buffer_load_dwordx4 v[24:27], v3, s[28:31], s51 offen offset:2048 sc1
  buffer_load_dwordx4 v[28:31], v3, s[28:31], s51 offen offset:3072 sc1
KG_GL0:
  s_bitcmp1_b32 s53, 1
  s_cbranch_scc0 KG_GL1
  s_add_u32 s51, s59, 4096
  buffer_load_dwordx4 v[32:35], v3, s[28:31], s51 offen offset:0 sc1
  buffer_load_dwordx4 v[36:39], v3, s[28:31], s51 offen offset:1024 sc1
  buffer_load_dwordx4 v[40:43], v3, s[28:31], s51 offen offset:2048 sc1
  buffer_load_dwordx4 v[44:47], v3, s[28:31], s51 offen offset:3072 sc1
KG_GL1:
  s_bitcmp1_b32 s53, 2
  s_cbranch_scc0 KG_GL2
  s_add_u32 s51, s59, 8192
  buffer_load_dwordx4 v[48:51], v3, s[28:31], s51 offen offset:0 sc1
  buffer_load_dwordx4 v[52:55], v3, s[28:31], s51 offen offset:1024 sc1
  buffer_load_dwordx4 v[56:59], v3, s[28:31], s51 offen offset:2048 sc1
  buffer_load_dwordx4 v[60:63], v3, s[28:31], s51 offen offset:3072 sc1
KG_GL2:
  s_bitcmp1_b32 s53, 3
  s_cbranch_scc0 KG_GL3
  s_add_u32 s51, s59, 12288
  buffer_load_dwordx4 v[64:67], v3, s[28:31], s51 offen offset:0 sc1
  buffer_load_dwordx4 v[68:71], v3, s[28:31], s51 offen offset:1024 sc1
  buffer_load_dwordx4 v[72:75], v3, s[28:31], s51 offen offset:2048 sc1
  buffer_load_dwordx4 v[76:79], v3, s[28:31], s51 offen offset:3072 sc1
KG_GL3:
  s_bitcmp1_b32 s53, 4
  s_cbranch_scc0 KG_GL4
  s_add_u32 s51, s59, 16384
  buffer_load_dwordx4 v[80:83], v3, s[28:31], s51 offen offset:0 sc1
  buffer_load_dwordx4 v[84:87], v3, s[28:31], s51 offen offset:1024 sc1
  buffer_load_dwordx4 v[88:91], v3, s[28:31], s51 offen offset:2048 sc1
  buffer_load_dwordx4 v[92:95], v3, s[28:31], s51 offen offset:3072 sc1
KG_GL4:
  s_bitcmp1_b32 s53, 5
  s_cbranch_scc0 KG_GL5
  s_add_u32 s51, s59, 20480
  buffer_load_dwordx4 v[96:99], v3, s[28:31], s51 offen offset:0 sc1
  buffer_load_dwordx4 v[100:103], v3, s[28:31], s51 offen offset:1024 sc1
  buffer_load_dwordx4 v[104:107], v3, s[28:31], s51 offen offset:2048 sc1
  buffer_load_dwordx4 v[108:111], v3, s[28:31], s51 offen offset:3072 sc1
KG_GL5:
  s_bitcmp1_b32 s53, 6
  s_cbranch_scc0 KG_GL6
  s_add_u32 s51, s59, 24576
  buffer_load_dwordx4 v[112:115], v3, s[28:31], s51 offen offset:0 sc1
  buffer_load_dwordx4 v[116:119], v3, s[28:31], s51 offen offset:1024 sc1
  buffer_load_dwordx4 v[120:123], v3, s[28:31], s51 offen offset:2048 sc1
  buffer_load_dwordx4 v[124:127], v3, s[28:31], s51 offen offset:3072 sc1
KG_GL6:
  s_bitcmp1_b32 s53, 7
  s_cbranch_scc0 KG_GL7
  s_add_u32 s51, s59, 28672
  buffer_load_dwordx4 v[128:131], v3, s[28:31], s51 offen offset:0 sc1
  buffer_load_dwordx4 v[132:135], v3, s[28:31], s51 offen offset:1024 sc1
  buffer_load_dwordx4 v[136:139], v3, s[28:31], s51 offen offset:2048 sc1
  buffer_load_dwordx4 v[140:143], v3, s[28:31], s51 offen offset:3072 sc1
KG_GL7:
  s_waitcnt vmcnt(0)
  s_bitcmp1_b32 s53, 0
  s_cbranch_scc0 KG_GF1_0
  v_cmpx_eq_u32 vcc, s73, v18
  v_cmpx_eq_u32 vcc, s73, v22
  v_cmpx_eq_u32 vcc, s73, v26
  v_cmpx_eq_u32 vcc, s73, v30
  s_cmp_eq_u64 exec, -1
  s_mov_b64 exec, -1
  s_cbranch_scc0 KG_GF1_0
  ds_write_b64 v4, v[16:17] offset:0
  ds_write_b64 v4, v[20:21] offset:512
  ds_write_b64 v4, v[24:25] offset:1024
  ds_write_b64 v4, v[28:29] offset:1536
  v_add_u32 v14, 1, v14
  s_bitset0_b32 s58, 0
  v_add_u32 v4, 0x800, v4
  ds_write_b32 v7, v14 offset:8
KG_GF1_0:
  s_bitcmp1_b32 s53, 1
  s_cbranch_scc0 KG_GF1_1
  v_cmpx_eq_u32 vcc, s73, v34
  v_cmpx_eq_u32 vcc, s73, v38
  v_cmpx_eq_u32 vcc, s73, v42
  v_cmpx_eq_u32 vcc, s73, v46
  s_cmp_eq_u64 exec, -1
  s_mov_b64 exec, -1
  s_cbranch_scc0 KG_GF1_1
  ds_write_b64 v4, v[32:33] offset:0
  ds_write_b64 v4, v[36:37] offset:512
  ds_write_b64 v4, v[40:41] offset:1024
  ds_write_b64 v4, v[44:45] offset:1536
  v_add_u32 v14, 1, v14
  s_bitset0_b32 s58, 1
  v_add_u32 v4, 0x800, v4
  ds_write_b32 v7, v14 offset:8
KG_GF1_1:
  s_bitcmp1_b32 s53, 2
  s_cbranch_scc0 KG_GF1_2
  v_cmpx_eq_u32 vcc, s73, v50
  v_cmpx_eq_u32 vcc, s73, v54
  v_cmpx_eq_u32 vcc, s73, v58
  v_cmpx_eq_u32 vcc, s73, v62
  s_cmp_eq_u64 exec, -1
  s_mov_b64 exec, -1
  s_cbranch_scc0 KG_GF1_2
  ds_write_b64 v4, v[48:49] offset:0
  ds_write_b64 v4, v[52:53] offset:512
  ds_write_b64 v4, v[56:57] offset:1024
  ds_write_b64 v4, v[60:61] offset:1536
  v_add_u32 v14, 1, v14
  s_bitset0_b32 s58, 2
  v_add_u32 v4, 0x800, v4
  ds_write_b32 v7, v14 offset:8
KG_GF1_2:
  s_bitcmp1_b32 s53, 3
  s_cbranch_scc0 KG_GF1_3
  v_cmpx_eq_u32 vcc, s73, v66
  v_cmpx_eq_u32 vcc, s73, v70
  v_cmpx_eq_u32 vcc, s73, v74
  v_cmpx_eq_u32 vcc, s73, v78
  s_cmp_eq_u64 exec, -1
  s_mov_b64 exec, -1
  s_cbranch_scc0 KG_GF1_3
  ds_write_b64 v4, v[64:65] offset:0
  ds_write_b64 v4, v[68:69] offset:512
  ds_write_b64 v4, v[72:73] offset:1024
  ds_write_b64 v4, v[76:77] offset:1536
  v_add_u32 v14, 1, v14
  s_bitset0_b32 s58, 3
  v_add_u32 v4, 0x800, v4
  ds_write_b32 v7, v14 offset:8
KG_GF1_3:
  s_bitcmp1_b32 s53, 4
  s_cbranch_scc0 KG_GF1_4
  v_cmpx_eq_u32 vcc, s73, v82
  v_cmpx_eq_u32 vcc, s73, v86
  v_cmpx_eq_u32 vcc, s73, v90
  v_cmpx_eq_u32 vcc, s73, v94
  s_cmp_eq_u64 exec, -1
  s_mov_b64 exec, -1
  s_cbranch_scc0 KG_GF1_4
  ds_write_b64 v4, v[80:81] offset:0
  ds_write_b64 v4, v[84:85] offset:512
  ds_write_b64 v4, v[88:89] offset:1024
  ds_write_b64 v4, v[92:93] offset:1536
  v_add_u32 v14, 1, v14
  s_bitset0_b32 s58, 4
  v_add_u32 v4, 0x800, v4
  ds_write_b32 v7, v14 offset:8
KG_GF1_4:
  s_bitcmp1_b32 s53, 5
  s_cbranch_scc0 KG_GF1_5
  v_cmpx_eq_u32 vcc, s73, v98
  v_cmpx_eq_u32 vcc, s73, v102
  v_cmpx_eq_u32 vcc, s73, v106
  v_cmpx_eq_u32 vcc, s73, v110
  s_cmp_eq_u64 exec, -1
  s_mov_b64 exec, -1
  s_cbranch_scc0 KG_GF1_5
  ds_write_b64 v4, v[96:97] offset:0
  ds_write_b64 v4, v[100:101] offset:512
  ds_write_b64 v4, v[104:105] offset:1024
  ds_write_b64 v4, v[108:109] offset:1536
  v_add_u32 v14, 1, v14
  s_bitset0_b32 s58, 5
  v_add_u32 v4, 0x800, v4
  ds_write_b32 v7, v14 offset:8
KG_GF1_5:
  s_bitcmp1_b32 s53, 6
  s_cbranch_scc0 KG_GF1_6
  v_cmpx_eq_u32 vcc, s73, v114
  v_cmpx_eq_u32 vcc, s73, v118
  v_cmpx_eq_u32 vcc, s73, v122
  v_cmpx_eq_u32 vcc, s73, v126
  s_cmp_eq_u64 exec, -1
  s_mov_b64 exec, -1
  s_cbranch_scc0 KG_GF1_6
  ds_write_b64 v4, v[112:113] offset:0
  ds_write_b64 v4, v[116:117] offset:512
  ds_write_b64 v4, v[120:121] offset:1024
  ds_write_b64 v4, v[124:125] offset:1536
  v_add_u32 v14, 1, v14
  s_bitset0_b32 s58, 6
  v_add_u32 v4, 0x800, v4
  ds_write_b32 v7, v14 offset:8
KG_GF1_6:
  s_bitcmp1_b32 s53, 7
  s_cbranch_scc0 KG_GF1_7
  v_cmpx_eq_u32 vcc, s73, v130
  v_cmpx_eq_u32 vcc, s73, v134
  v_cmpx_eq_u32 vcc, s73, v138
  v_cmpx_eq_u32 vcc, s73, v142
  s_cmp_eq_u64 exec, -1
  s_mov_b64 exec, -1
  s_cbranch_scc0 KG_GF1_7
  ds_write_b64 v4, v[128:129] offset:0
  ds_write_b64 v4, v[132:133] offset:512
  ds_write_b64 v4, v[136:137] offset:1024
  ds_write_b64 v4, v[140:141] offset:1536
  v_add_u32 v14, 1, v14
  s_bitset0_b32 s58, 7
  v_add_u32 v4, 0x800, v4
  ds_write_b32 v7, v14 offset:8
KG_GF1_7:
  s_branch KG_GR
KG_GE:
  s_branch KG_WT
KG_KP:
  v_mov_b32 v12, -1
  v_mov_b32 v13, -1
  v_mov_b32 v14, -1
  v_mov_b32 v15, -1
  s_lshl_b32 s52, s49, 16
  s_lshl_b32 s53, s50, 12
  s_add_u32 s52, s52, s53
  s_add_u32 s52, s52, 5242880
  s_add_u32 s53, s52, 32768
  buffer_store_dwordx4 v[12:15], v3, s[28:31], s52 offen offset:0 sc1
  buffer_store_dwordx4 v[12:15], v3, s[28:31], s52 offen offset:1024 sc1
  buffer_store_dwordx4 v[12:15], v3, s[28:31], s52 offen offset:2048 sc1
  buffer_store_dwordx4 v[12:15], v3, s[28:31], s52 offen offset:3072 sc1
  buffer_store_dwordx4 v[12:15], v3, s[28:31], s53 offen offset:0 sc1
  buffer_store_dwordx4 v[12:15], v3, s[28:31], s53 offen offset:1024 sc1
  buffer_store_dwordx4 v[12:15], v3, s[28:31], s53 offen offset:2048 sc1
  buffer_store_dwordx4 v[12:15], v3, s[28:31], s53 offen offset:3072 sc1
  s_and_b32 s51, s2, 7
  s_lshl_b32 s51, s51, 3
  s_mov_b64 s[60:61], 0xff
  s_lshl_b64 s[60:61], s[60:61], s51
  s_mov_b32 s58, 0
  s_mov_b32 s71, 0
  s_mov_b32 s59, 0
  s_mov_b32 s57, 65536
KG_LW21:
  ds_read_b32 v8, v7 offset:4
  s_waitcnt lgkmcnt(0)
  v_readfirstlane_b32 s51, v8
  s_cmp_ge_u32 s51, 8
  s_cbranch_scc1 KG_LD21
  s_sleep 2
  s_sub_u32 s72, s72, 1
  s_cbranch_scc0 KG_LW21
  s_mov_b32 s72, 0
KG_LD21:
KG_LW22:
  ds_read_b32 v8, v7 offset:0
  s_waitcnt lgkmcnt(0)
  v_readfirstlane_b32 s51, v8
  s_cmp_ge_u32 s51, 8
  s_cbranch_scc1 KG_LD22
  s_sleep 2
  s_sub_u32 s72, s72, 1
  s_cbranch_scc0 KG_LW22
  s_mov_b32 s72, 0
KG_LD22:
  s_mov_b32 s52, 2375680
  s_mov_b32 s55, 262144
  v_lshlrev_b32 v8, 7, v0
  s_mov_b64 exec, -1
KG_GPKV:
  buffer_load_dwordx4 v[12:15], v8, s[28:31], s52 offen sc1
  ds_write_b32 v7, v156 offset:104
  s_waitcnt vmcnt(0)
  v_xor_b32 v12, s69, v12
  v_xor_b32 v13, s69, v13
  v_xor_b32 v14, s69, v14
  v_xor_b32 v15, s69, v15
  v_or3_b32 v12, v12, v13, v14
  v_or_b32 v12, v12, v15
  v_lshlrev_b32 v13, 4, v12
  v_cmp_ne_u32 vcc, 0, v13
  s_sub_u32 s55, s55, 1
  s_cbranch_scc1 KG_GDKV
  s_and_b64 s[62:63], exec, vcc
  s_or_b64 s[64:65], s[62:63], s[60:61]
  s_mov_b64 exec, -1
  s_and_b32 s51, s64, 0xff
  s_cselect_b32 s51, 0, 0xff
  s_cselect_b32 s53, 0, 1
  s_or_b32 s60, s60, s51
  s_or_b32 s59, s59, s53
  s_and_b32 s51, s64, 0xff00
  s_cselect_b32 s51, 0, 0xff00
  s_cselect_b32 s53, 0, 2
  s_or_b32 s60, s60, s51
  s_or_b32 s59, s59, s53
  s_and_b32 s51, s64, 0xff0000
  s_cselect_b32 s51, 0, 0xff0000
  s_cselect_b32 s53, 0, 4
  s_or_b32 s60, s60, s51
  s_or_b32 s59, s59, s53
  s_and_b32 s51, s64, 0xff000000
  s_cselect_b32 s51, 0, 0xff000000
  s_cselect_b32 s53, 0, 8
  s_or_b32 s60, s60, s51
  s_or_b32 s59, s59, s53
  s_and_b32 s51, s65, 0xff
  s_cselect_b32 s51, 0, 0xff
  s_cselect_b32 s53, 0, 16
  s_or_b32 s61, s61, s51
  s_or_b32 s59, s59, s53
  s_and_b32 s51, s65, 0xff00
  s_cselect_b32 s51, 0, 0xff00
  s_cselect_b32 s53, 0, 32
  s_or_b32 s61, s61, s51
  s_or_b32 s59, s59, s53
  s_and_b32 s51, s65, 0xff0000
  s_cselect_b32 s51, 0, 0xff0000
  s_cselect_b32 s53, 0, 64
  s_or_b32 s61, s61, s51
  s_or_b32 s59, s59, s53
  s_and_b32 s51, s65, 0xff000000
  s_cselect_b32 s51, 0, 0xff000000
  s_cselect_b32 s53, 0, 128
  s_or_b32 s61, s61, s51
  s_or_b32 s59, s59, s53
  s_cbranch_scc0 KG_QE
  s_cmp_lg_u32 s58, 0
  s_cbranch_scc1 KG_QL
KG_PW23:
  ds_read_b128 v[16:19], v7 offset:32
  s_waitcnt lgkmcnt(0)
  v_min3_u32 v16, v16, v17, v18
  v_min_u32 v16, v16, v19
  s_nop 0
  v_readfirstlane_b32 s51, v16
  s_cmp_ge_u32 s51, 1
  s_cbranch_scc1 KG_PD23
  s_sleep 1
  s_sub_u32 s72, s72, 1
  s_cbranch_scc0 KG_PW23
  s_mov_b32 s72, 0
KG_PD23:
KG_QL:
  s_ff1_i32_b32 s51, s59
  s_bitset0_b32 s59, s51
  s_cmp_ge_u32 s58, 4
  s_cbranch_scc1 KG_QQ
  v_mov_b32 v9, s58
  s_add_u32 s58, s58, 1
  s_lshl_b32 s51, s51, 14
  s_add_u32 s51, s51, 2097152
  s_mov_b32 m0, s57
  s_add_u32 s57, s57, 4096
  buffer_load_dwordx4 v3, s[28:31], s51 offen offset:0 lds
  buffer_load_dwordx4 v3, s[28:31], s51 offen offset:1024 lds
  buffer_load_dwordx4 v3, s[28:31], s51 offen offset:2048 lds
  buffer_load_dwordx4 v3, s[28:31], s51 offen offset:3072 lds
  s_add_u32 s51, s51, 4096
  s_mov_b32 m0, s57
  s_add_u32 s57, s57, 4096
  buffer_load_dwordx4 v3, s[28:31], s51 offen offset:0 lds
  buffer_load_dwordx4 v3, s[28:31], s51 offen offset:1024 lds
  buffer_load_dwordx4 v3, s[28:31], s51 offen offset:2048 lds
  buffer_load_dwordx4 v3, s[28:31], s51 offen offset:3072 lds
  s_add_u32 s51, s51, 4096
  s_mov_b32 m0, s57
  s_add_u32 s57, s57, 4096
  buffer_load_dwordx4 v3, s[28:31], s51 offen offset:0 lds
  buffer_load_dwordx4 v3, s[28:31], s51 offen offset:1024 lds
  buffer_load_dwordx4 v3, s[28:31], s51 offen offset:2048 lds
  buffer_load_dwordx4 v3, s[28:31], s51 offen offset:3072 lds
  s_add_u32 s51, s51, 4096
  s_mov_b32 m0, s57
  s_add_u32 s57, s57, 4096
  buffer_load_dwordx4 v3, s[28:31], s51 offen offset:0 lds
  buffer_load_dwordx4 v3, s[28:31], s51 offen offset:1024 lds
  buffer_load_dwordx4 v3, s[28:31], s51 offen offset:2048 lds
  buffer_load_dwordx4 v3, s[28:31], s51 offen offset:3072 lds
  s_add_u32 s51, s51, 4096
  s_waitcnt vmcnt(16)
  ds_write_b32 v7, v9 offset:48
  s_branch KG_QN
KG_QQ:
  s_lshl_b32 s71, s71, 3
  s_or_b32 s71, s71, s51
KG_QN:
  s_cmp_lg_u32 s59, 0
  s_cbranch_scc1 KG_QL
  v_mov_b32 v9, s58
  s_waitcnt vmcnt(0)
  ds_write_b32 v7, v9 offset:48
KG_QE:
  s_and_b64 exec, s[62:63], s[62:63]
  s_cbranch_scc0 KG_GDKV
  s_sleep 4
  s_branch KG_GPKV
KG_GDKV:
  s_mov_b64 exec, -1
  s_lshl_b32 s51, s49, 1
  s_add_u32 s52, s51, 1
  v_readlane_b32 s51, v12, s51
  v_readlane_b32 s52, v12, s52
  s_lshl_b32 s53, s71, 8
  s_bitset1_b32 s53, 7
  s_or_b32 s51, s51, s52
  s_cmp_eq_u32 s51, 0
  s_cselect_b32 s51, 1, 2
  s_cmp_lg_u32 s51, 1
  s_cbranch_scc1 KG_DPE
  v_mov_b32 v12, -1
  v_mov_b32 v13, -1
  v_mov_b32 v14, -1
  v_mov_b32 v15, -1
  s_lshl_b32 s52, s49, 16
  s_lshl_b32 s54, s50, 12
  s_add_u32 s52, s52, s54
  s_add_u32 s52, s52, 5242880
  s_add_u32 s54, s52, 32768
  buffer_store_dwordx4 v[12:15], v3, s[28:31], s52 offen offset:0
  buffer_store_dwordx4 v[12:15], v3, s[28:31], s52 offen offset:1024
  buffer_store_dwordx4 v[12:15], v3, s[28:31], s52 offen offset:2048
  buffer_store_dwordx4 v[12:15], v3, s[28:31], s52 offen offset:3072
  buffer_store_dwordx4 v[12:15], v3, s[28:31], s54 offen offset:0
  buffer_store_dwordx4 v[12:15], v3, s[28:31], s54 offen offset:1024
  buffer_store_dwordx4 v[12:15], v3, s[28:31], s54 offen offset:2048
  buffer_store_dwordx4 v[12:15], v3, s[28:31], s54 offen offset:3072
  s_waitcnt vmcnt(0)
KG_DPE:
  v_mov_b32 v12, s51
  v_mov_b32 v9, s53
  ds_write_b32 v7, v12 offset:56
  ds_write_b32 v7, v9 offset:96
  s_cmp_lg_u32 s2, 0
  s_cbranch_scc1 KG_H3
  s_mov_b32 s54, 2359296
  v_mov_b32 v10, 0
  v_mov_b32 v11, s73
  s_mov_b64 exec, 1
  buffer_store_dword v11, v10, s[28:31], s54 offen sc1
  s_mov_b64 exec, -1
  s_branch KG_H3
KG_WT:
KG_LW24:
  ds_read_b32 v8, v7 offset:8
  s_waitcnt lgkmcnt(0)
  v_readfirstlane_b32 s51, v8
  s_cmp_ge_u32 s51, 8
  s_cbranch_scc1 KG_LD24
  s_sleep 2
  s_sub_u32 s72, s72, 1
  s_cbranch_scc0 KG_LW24
  s_mov_b32 s72, 0
KG_LD24:
  s_lshr_b32 s58, s49, 3
  s_bfe_u32 s59, s49, 0x20001
  s_and_b32 s57, s49, 1
  s_cmp_eq_u32 s57, 1
  s_cselect_b64 s[62:63], s[18:19], s[16:17]
  s_mov_b32 s32, s62
  s_mov_b32 s33, s63
  s_mov_b32 s34, 1052672
  s_mov_b32 s35, 0x20000
  s_lshl_b32 s54, s58, 4
  s_lshl_b32 s52, s59, 8
  s_add_u32 s52, s52, s54
  v_add_u32 v10, s52, v1
  v_mul_u32_u24 v10, 514, v10
  v_lshl_add_u32 v10, v2, 4, v10
  s_lshl_b32 s52, s50, 5
  s_sub_u32 s51, 450, s52
  s_mov_b32 exec_hi, 0
  v_add_u32 v10, s52, v10
  s_not_b64 exec, exec
  v_add_u32 v10, s51, v10
  s_mov_b64 exec, -1
  v_and_b32 v12, 2, v10
  v_and_b32 v10, -4, v10
  s_mov_b32 s51, 0
  buffer_load_dwordx4 v[16:19], v10, s[32:35], s51 offen
  buffer_load_dword v96, v10, s[32:35], s51 offen offset:16
  s_mov_b32 s51, 32896
  buffer_load_dwordx4 v[20:23], v10, s[32:35], s51 offen
  buffer_load_dword v97, v10, s[32:35], s51 offen offset:16
  s_mov_b32 s51, 65792
  buffer_load_dwordx4 v[24:27], v10, s[32:35], s51 offen
  buffer_load_dword v98, v10, s[32:35], s51 offen offset:16
  s_mov_b32 s51, 98688
  buffer_load_dwordx4 v[28:31], v10, s[32:35], s51 offen
  buffer_load_dword v99, v10, s[32:35], s51 offen offset:16
  s_mov_b32 s51, 526336
  buffer_load_dwordx4 v[32:35], v10, s[32:35], s51 offen
  buffer_load_dword v100, v10, s[32:35], s51 offen offset:16
  s_mov_b32 s51, 559232
  buffer_load_dwordx4 v[36:39], v10, s[32:35], s51 offen
  buffer_load_dword v101, v10, s[32:35], s51 offen offset:16
  s_mov_b32 s51, 592128
  buffer_load_dwordx4 v[40:43], v10, s[32:35], s51 offen
  buffer_load_dword v102, v10, s[32:35], s51 offen offset:16
  s_mov_b32 s51, 625024
  buffer_load_dwordx4 v[44:47], v10, s[32:35], s51 offen
  buffer_load_dword v103, v10, s[32:35], s51 offen offset:16
  s_or_b32 s56, s50, s59
  s_cmp_lg_u32 s56, 0
  s_cbranch_scc1 KG_WT1
  v_lshl_add_u32 v11, v2, 8, v1
  v_add_u32 v11, s54, v11
  v_mul_u32_u24 v11, 514, v11
  s_mov_b32 s51, 0
  buffer_load_ushort v80, v11, s[32:35], s51 offen offset:256
  s_mov_b32 s51, 32896
  buffer_load_ushort v81, v11, s[32:35], s51 offen offset:256
  s_mov_b32 s51, 65792
  buffer_load_ushort v82, v11, s[32:35], s51 offen offset:256
  s_mov_b32 s51, 98688
  buffer_load_ushort v83, v11, s[32:35], s51 offen offset:256
  s_mov_b32 s51, 526336
  buffer_load_ushort v84, v11, s[32:35], s51 offen offset:256
  s_mov_b32 s51, 559232
  buffer_load_ushort v85, v11, s[32:35], s51 offen offset:256
  s_mov_b32 s51, 592128
  buffer_load_ushort v86, v11, s[32:35], s51 offen offset:256
  s_mov_b32 s51, 625024
  buffer_load_ushort v87, v11, s[32:35], s51 offen offset:256
KG_WT1:
  s_mov_b32 s62, 0x05040100
  s_mov_b32 s63, 0x07060302
  v_lshlrev_b32 v10, 16, v2
  v_lshl_add_u32 v10, v1, 4, v10
  s_lshl_b32 s52, s50, 18
  s_lshl_b32 s53, s58, 11
  s_lshl_b32 s51, s57, 10
  s_add_u32 s53, s53, s51
  s_add_u32 s53, s53, 9437184
  s_add_u32 s52, s52, s53
  s_lshl_b32 s51, s59, 8
  s_add_u32 s52, s52, s51
  s_waitcnt vmcnt(0)
  v_alignbyte_b32 v16, v17, v16, v12
  v_alignbyte_b32 v17, v18, v17, v12
  v_alignbyte_b32 v18, v19, v18, v12
  v_alignbyte_b32 v19, v96, v19, v12
  v_alignbyte_b32 v20, v21, v20, v12
  v_alignbyte_b32 v21, v22, v21, v12
  v_alignbyte_b32 v22, v23, v22, v12
  v_alignbyte_b32 v23, v97, v23, v12
  v_alignbyte_b32 v24, v25, v24, v12
  v_alignbyte_b32 v25, v26, v25, v12
  v_alignbyte_b32 v26, v27, v26, v12
  v_alignbyte_b32 v27, v98, v27, v12
  v_alignbyte_b32 v28, v29, v28, v12
  v_alignbyte_b32 v29, v30, v29, v12
  v_alignbyte_b32 v30, v31, v30, v12
  v_alignbyte_b32 v31, v99, v31, v12
  v_alignbyte_b32 v32, v33, v32, v12
  v_alignbyte_b32 v33, v34, v33, v12
  v_alignbyte_b32 v34, v35, v34, v12
  v_alignbyte_b32 v35, v100, v35, v12
  v_alignbyte_b32 v36, v37, v36, v12
  v_alignbyte_b32 v37, v38, v37, v12
  v_alignbyte_b32 v38, v39, v38, v12
  v_alignbyte_b32 v39, v101, v39, v12
  v_alignbyte_b32 v40, v41, v40, v12
  v_alignbyte_b32 v41, v42, v41, v12
  v_alignbyte_b32 v42, v43, v42, v12
  v_alignbyte_b32 v43, v102, v43, v12
  v_alignbyte_b32 v44, v45, v44, v12
  v_alignbyte_b32 v45, v46, v45, v12
  v_alignbyte_b32 v46, v47, v46, v12
  v_alignbyte_b32 v47, v103, v47, v12
  v_perm_b32 v48, v20, v16, s62
  v_perm_b32 v49, v28, v24, s62
  v_perm_b32 v50, v36, v32, s62
  v_perm_b32 v51, v44, v40, s62
  v_perm_b32 v52, v20, v16, s63
  v_perm_b32 v53, v28, v24, s63
  v_perm_b32 v54, v36, v32, s63
  v_perm_b32 v55, v44, v40, s63
  v_perm_b32 v56, v21, v17, s62
  v_perm_b32 v57, v29, v25, s62
  v_perm_b32 v58, v37, v33, s62
  v_perm_b32 v59, v45, v41, s62
  v_perm_b32 v60, v21, v17, s63
  v_perm_b32 v61, v29, v25, s63
  v_perm_b32 v62, v37, v33, s63
  v_perm_b32 v63, v45, v41, s63
  v_perm_b32 v64, v22, v18, s62
  v_perm_b32 v65, v30, v26, s62
  v_perm_b32 v66, v38, v34, s62
  v_perm_b32 v67, v46, v42, s62
  v_perm_b32 v68, v22, v18, s63
  v_perm_b32 v69, v30, v26, s63
  v_perm_b32 v70, v38, v34, s63
  v_perm_b32 v71, v46, v42, s63
  v_perm_b32 v72, v23, v19, s62
  v_perm_b32 v73, v31, v27, s62
  v_perm_b32 v74, v39, v35, s62
  v_perm_b32 v75, v47, v43, s62
  v_perm_b32 v76, v23, v19, s63
  v_perm_b32 v77, v31, v27, s63
  v_perm_b32 v78, v39, v35, s63
  v_perm_b32 v79, v47, v43, s63
  s_add_u32 s51, s52, 0
  buffer_store_dwordx4 v[48:51], v10, s[28:31], s51 offen sc1
  s_add_u32 s51, s52, 8192
  buffer_store_dwordx4 v[52:55], v10, s[28:31], s51 offen sc1
  s_add_u32 s51, s52, 16384
  buffer_store_dwordx4 v[56:59], v10, s[28:31], s51 offen sc1
  s_add_u32 s51, s52, 24576
  buffer_store_dwordx4 v[60:63], v10, s[28:31], s51 offen sc1
  s_add_u32 s51, s52, 32768
  buffer_store_dwordx4 v[64:67], v10, s[28:31], s51 offen sc1
  s_add_u32 s51, s52, 40960
  buffer_store_dwordx4 v[68:71], v10, s[28:31], s51 offen sc1
  s_add_u32 s51, s52, 49152
  buffer_store_dwordx4 v[72:75], v10, s[28:31], s51 offen sc1
  s_add_u32 s51, s52, 57344
  buffer_store_dwordx4 v[76:79], v10, s[28:31], s51 offen sc1
  s_cmp_lg_u32 s56, 0
  s_cbranch_scc1 KG_J1
  v_lshl_or_b32 v88, v81, 16, v80
  v_lshl_or_b32 v89, v83, 16, v82
  v_lshl_or_b32 v90, v85, 16, v84
  v_lshl_or_b32 v91, v87, 16, v86
  s_add_u32 s51, s53, 2097152
  buffer_store_dwordx4 v[88:91], v3, s[28:31], s51 offen sc1
  s_branch KG_J1
KG_H2B:
  s_lshl_b32 s67, s50, 5
  s_add_u32 s67, s67, s49
  s_mov_b32 s28, s14
  s_mov_b32 s29, s15
  s_mov_b32 s30, 11599872
  s_mov_b32 s31, 0x20000
  s_getpc_b64 s[36:37]
  s_add_u32 s36, s36, TAB_F@rel32@lo+4
  s_addc_u32 s37, s37, TAB_F@rel32@hi+12
  s_mov_b32 s38, 262144
  s_mov_b32 s39, 0x20000
  s_getpc_b64 s[40:41]
  s_add_u32 s40, s40, TAB_K2@rel32@lo+4
  s_addc_u32 s41, s41, TAB_K2@rel32@hi+12
  s_mov_b32 s42, 83968
  s_mov_b32 s43, 0x20000
  s_mul_i32 s64, s68, 5120
  s_add_u32 s64, s64, 63488
  s_add_u32 s65, s64, 4096
  s_lshr_b32 s69, s68, 1
  s_and_b32 s70, s68, 1
  s_lshl_b32 s53, s50, 15
  s_lshl_b32 s51, s70, 10
  s_add_u32 s53, s53, s51
KG_LW25:
  ds_read_b32 v8, v7 offset:104
  s_waitcnt lgkmcnt(0)
  v_readfirstlane_b32 s51, v8
  s_cmp_ge_u32 s51, 1
  s_cbranch_scc1 KG_LD25
  s_sleep 1
  s_sub_u32 s72, s72, 1
  s_cbranch_scc0 KG_LW25
  s_mov_b32 s72, 0
KG_LD25:
  s_lshr_b32 s56, s2, 6
  s_lshl_b32 s56, s56, 13
  s_add_u32 s54, s53, s56
  buffer_load_dwordx4 v[88:91], v3, s[36:39], s54 offen offset:0
  buffer_load_dwordx4 v[92:95], v3, s[36:39], s54 offen offset:2048
  s_add_u32 s54, s54, 4096
  buffer_load_dwordx4 v[96:99], v3, s[36:39], s54 offen offset:0
  buffer_load_dwordx4 v[100:103], v3, s[36:39], s54 offen offset:2048
  s_add_u32 s56, s56, 0x2000
  s_bitset0_b32 s56, 15
  s_add_u32 s54, s53, s56
  buffer_load_dwordx4 v[104:107], v3, s[36:39], s54 offen offset:0
  buffer_load_dwordx4 v[108:111], v3, s[36:39], s54 offen offset:2048
  s_add_u32 s54, s54, 4096
  buffer_load_dwordx4 v[112:115], v3, s[36:39], s54 offen offset:0
  buffer_load_dwordx4 v[116:119], v3, s[36:39], s54 offen offset:2048
  s_add_u32 s56, s56, 0x2000
  s_bitset0_b32 s56, 15
  s_add_u32 s54, s53, s56
  buffer_load_dwordx4 v[120:123], v3, s[36:39], s54 offen offset:0
  buffer_load_dwordx4 v[124:127], v3, s[36:39], s54 offen offset:2048
  s_add_u32 s54, s54, 4096
  buffer_load_dwordx4 v[128:131], v3, s[36:39], s54 offen offset:0
  buffer_load_dwordx4 v[132:135], v3, s[36:39], s54 offen offset:2048
  s_add_u32 s56, s56, 0x2000
  s_bitset0_b32 s56, 15
  s_add_u32 s54, s53, s56
  buffer_load_dwordx4 v[136:139], v3, s[36:39], s54 offen offset:0
  buffer_load_dwordx4 v[140:143], v3, s[36:39], s54 offen offset:2048
  s_add_u32 s54, s54, 4096
  buffer_load_dwordx4 v[144:147], v3, s[36:39], s54 offen offset:0
  buffer_load_dwordx4 v[148:151], v3, s[36:39], s54 offen offset:2048
KG_LW26:
  ds_read_b32 v8, v7 offset:140
  s_waitcnt lgkmcnt(0)
  v_readfirstlane_b32 s51, v8
  s_cmp_ge_u32 s51, 1
  s_cbranch_scc1 KG_LD26
  s_sleep 1
  s_sub_u32 s72, s72, 1
  s_cbranch_scc0 KG_LW26
  s_mov_b32 s72, 0
KG_LD26:
  ds_read_b32 v8, v7 offset:100
  s_waitcnt lgkmcnt(0)
  v_readfirstlane_b32 s73, v8
KG_LW27:
  ds_read_b32 v12, v7 offset:0
  s_waitcnt lgkmcnt(0)
  v_readfirstlane_b32 s51, v12
  s_cmp_ge_u32 s51, 8
  s_cbranch_scc1 KG_LD27
  s_sleep 2
  s_sub_u32 s72, s72, 1
  s_cbranch_scc0 KG_LW27
  s_mov_b32 s72, 0
KG_LD27:
  s_setprio 0
  ds_read_b128 v[152:155], v248 offset:0
  ds_read_b128 v[168:171], v248 offset:4096
  ds_read_b128 v[156:159], v249 offset:0
  ds_read_b128 v[172:175], v249 offset:4096
  ds_read_b128 v[160:163], v250 offset:0
  ds_read_b128 v[176:179], v250 offset:4096
  ds_read_b128 v[164:167], v251 offset:0
  ds_read_b128 v[180:183], v251 offset:4096
  ds_read_b128 v[184:187], v248 offset:8192
  ds_read_b128 v[200:203], v248 offset:12288
  ds_read_b128 v[188:191], v249 offset:8192
  ds_read_b128 v[204:207], v249 offset:12288
  ds_read_b128 v[192:195], v250 offset:8192
  ds_read_b128 v[208:211], v250 offset:12288
  ds_read_b128 v[196:199], v251 offset:8192
  ds_read_b128 v[212:215], v251 offset:12288
  s_waitcnt vmcnt(15) lgkmcnt(12)
  v_smfmac_f32_32x32x32_bf16 v[216:231], v[88:91], v[152:159], v252
  v_smfmac_f32_32x32x32_bf16 v[232:247], v[88:91], v[168:175], v252
  s_mul_i32 s51, s69, 12288
  buffer_load_dwordx4 v[16:19], v3, s[40:43], s51 offen offset:0
  buffer_load_dwordx4 v[20:23], v3, s[40:43], s51 offen offset:1024
  s_waitcnt vmcnt(16) lgkmcnt(8)
  v_smfmac_f32_32x32x32_bf16 v[216:231], v[92:95], v[160:167], v252
  v_smfmac_f32_32x32x32_bf16 v[232:247], v[92:95], v[176:183], v252
  buffer_load_dwordx4 v[24:27], v3, s[40:43], s51 offen offset:2048
  buffer_load_dwordx4 v[28:31], v3, s[40:43], s51 offen offset:3072
  ds_read_b128 v[152:155], v248 offset:16384
  ds_read_b128 v[168:171], v248 offset:20480
  ds_read_b128 v[156:159], v249 offset:16384
  ds_read_b128 v[172:175], v249 offset:20480
  ds_read_b128 v[160:163], v250 offset:16384
  ds_read_b128 v[176:179], v250 offset:20480
  ds_read_b128 v[164:167], v251 offset:16384
  ds_read_b128 v[180:183], v251 offset:20480
  s_waitcnt vmcnt(17) lgkmcnt(12)
  v_smfmac_f32_32x32x32_bf16 v[216:231], v[96:99], v[184:191], v252
  v_smfmac_f32_32x32x32_bf16 v[232:247], v[96:99], v[200:207], v252
  s_add_u32 s51, s51, 4096
  buffer_load_dwordx4 v[32:35], v3, s[40:43], s51 offen offset:0
  buffer_load_dwordx4 v[36:39], v3, s[40:43], s51 offen offset:1024
  s_waitcnt vmcnt(18) lgkmcnt(8)
  v_smfmac_f32_32x32x32_bf16 v[216:231], v[100:103], v[192:199], v252
  v_smfmac_f32_32x32x32_bf16 v[232:247], v[100:103], v[208:215], v252
  buffer_load_dwordx4 v[40:43], v3, s[40:43], s51 offen offset:2048
  buffer_load_dwordx4 v[44:47], v3, s[40:43], s51 offen offset:3072
  ds_read_b128 v[184:187], v248 offset:24576
  ds_read_b128 v[200:203], v248 offset:28672
  ds_read_b128 v[188:191], v249 offset:24576
  ds_read_b128 v[204:207], v249 offset:28672
  ds_read_b128 v[192:195], v250 offset:24576
  ds_read_b128 v[208:211], v250 offset:28672
  ds_read_b128 v[196:199], v251 offset:24576
  ds_read_b128 v[212:215], v251 offset:28672
  s_waitcnt vmcnt(19) lgkmcnt(12)
  v_smfmac_f32_32x32x32_bf16 v[216:231], v[104:107], v[152:159], v252
  v_smfmac_f32_32x32x32_bf16 v[232:247], v[104:107], v[168:175], v252
  s_add_u32 s51, s51, 4096
  buffer_load_dwordx4 v[48:51], v3, s[40:43], s51 offen offset:0
  buffer_load_dwordx4 v[52:55], v3, s[40:43], s51 offen offset:1024
  s_waitcnt vmcnt(20) lgkmcnt(8)
  v_smfmac_f32_32x32x32_bf16 v[216:231], v[108:111], v[160:167], v252
  v_smfmac_f32_32x32x32_bf16 v[232:247], v[108:111], v[176:183], v252
  buffer_load_dwordx4 v[56:59], v3, s[40:43], s51 offen offset:2048
  buffer_load_dwordx4 v[60:63], v3, s[40:43], s51 offen offset:3072
  ds_read_b128 v[152:155], v248 offset:32768
  ds_read_b128 v[168:171], v248 offset:36864
  ds_read_b128 v[156:159], v249 offset:32768
  ds_read_b128 v[172:175], v249 offset:36864
  ds_read_b128 v[160:163], v250 offset:32768
  ds_read_b128 v[176:179], v250 offset:36864
  ds_read_b128 v[164:167], v251 offset:32768
  ds_read_b128 v[180:183], v251 offset:36864
  s_waitcnt vmcnt(21) lgkmcnt(12)
  v_smfmac_f32_32x32x32_bf16 v[216:231], v[112:115], v[184:191], v252
  v_smfmac_f32_32x32x32_bf16 v[232:247], v[112:115], v[200:207], v252
  s_mov_b32 s51, 24576
  buffer_load_dwordx4 v[64:67], v3, s[40:43], s51 offen offset:0
  buffer_load_dwordx4 v[68:71], v3, s[40:43], s51 offen offset:1024
  s_waitcnt vmcnt(22) lgkmcnt(8)
  v_smfmac_f32_32x32x32_bf16 v[216:231], v[116:119], v[192:199], v252
  v_smfmac_f32_32x32x32_bf16 v[232:247], v[116:119], v[208:215], v252
  buffer_load_dwordx4 v[72:75], v3, s[40:43], s51 offen offset:2048
  buffer_load_dwordx4 v[76:79], v3, s[40:43], s51 offen offset:3072
  ds_read_b128 v[184:187], v248 offset:40960
  ds_read_b128 v[200:203], v248 offset:45056
  ds_read_b128 v[188:191], v249 offset:40960
  ds_read_b128 v[204:207], v249 offset:45056
  ds_read_b128 v[192:195], v250 offset:40960
  ds_read_b128 v[208:211], v250 offset:45056
  ds_read_b128 v[196:199], v251 offset:40960
  ds_read_b128 v[212:215], v251 offset:45056
  s_waitcnt vmcnt(23) lgkmcnt(12)
  v_smfmac_f32_32x32x32_bf16 v[216:231], v[120:123], v[152:159], v252
  v_smfmac_f32_32x32x32_bf16 v[232:247], v[120:123], v[168:175], v252
  s_mov_b32 s51, 28672
  buffer_load_dwordx4 v[80:83], v3, s[40:43], s51 offen offset:0
  buffer_load_dwordx4 v[84:87], v3, s[40:43], s51 offen offset:1024
  s_waitcnt vmcnt(24) lgkmcnt(8)
  v_smfmac_f32_32x32x32_bf16 v[216:231], v[124:127], v[160:167], v252
  v_smfmac_f32_32x32x32_bf16 v[232:247], v[124:127], v[176:183], v252
  s_lshl_b32 s51, s68, 12
  s_add_u32 s51, s51, 30720
  buffer_load_dwordx4 v[104:107], v3, s[40:43], s51 offen offset:0
  buffer_load_dwordx4 v[108:111], v3, s[40:43], s51 offen offset:1024
  ds_read_b128 v[152:155], v248 offset:49152
  ds_read_b128 v[168:171], v248 offset:53248
  ds_read_b128 v[156:159], v249 offset:49152
  ds_read_b128 v[172:175], v249 offset:53248
  ds_read_b128 v[160:163], v250 offset:49152
  ds_read_b128 v[176:179], v250 offset:53248
  ds_read_b128 v[164:167], v251 offset:49152
  ds_read_b128 v[180:183], v251 offset:53248
  s_waitcnt vmcnt(25) lgkmcnt(12)
  v_smfmac_f32_32x32x32_bf16 v[216:231], v[128:131], v[184:191], v252
  v_smfmac_f32_32x32x32_bf16 v[232:247], v[128:131], v[200:207], v252
  buffer_load_dwordx4 v[112:115], v3, s[40:43], s51 offen offset:2048
  buffer_load_dwordx4 v[116:119], v3, s[40:43], s51 offen offset:3072
  s_waitcnt vmcnt(26) lgkmcnt(8)
  v_smfmac_f32_32x32x32_bf16 v[216:231], v[132:135], v[192:199], v252
  v_smfmac_f32_32x32x32_bf16 v[232:247], v[132:135], v[208:215], v252
  buffer_load_dwordx3 v[4:6], v3, s[40:43], s64 offen offset:2048
  buffer_load_dwordx4 v[128:131], v3, s[40:43], s64 offen offset:0
  ds_read_b128 v[184:187], v248 offset:57344
  ds_read_b128 v[200:203], v248 offset:61440
  ds_read_b128 v[188:191], v249 offset:57344
  ds_read_b128 v[204:207], v249 offset:61440
  ds_read_b128 v[192:195], v250 offset:57344
  ds_read_b128 v[208:211], v250 offset:61440
  ds_read_b128 v[196:199], v251 offset:57344
  ds_read_b128 v[212:215], v251 offset:61440
  s_waitcnt vmcnt(27) lgkmcnt(12)
  v_smfmac_f32_32x32x32_bf16 v[216:231], v[136:139], v[152:159], v252
  v_smfmac_f32_32x32x32_bf16 v[232:247], v[136:139], v[168:175], v252
  buffer_load_dword v132, v3, s[40:43], s64 offen offset:1024
  buffer_load_dword v1, v3, s[40:43], s64 offen offset:1028
  s_waitcnt vmcnt(28) lgkmcnt(8)
  v_smfmac_f32_32x32x32_bf16 v[216:231], v[140:143], v[160:167], v252
  v_smfmac_f32_32x32x32_bf16 v[232:247], v[140:143], v[176:183], v252
  buffer_load_dword v2, v3, s[40:43], s64 offen offset:1032
  s_waitcnt vmcnt(28) lgkmcnt(4)
  v_smfmac_f32_32x32x32_bf16 v[216:231], v[144:147], v[184:191], v252
  v_smfmac_f32_32x32x32_bf16 v[232:247], v[144:147], v[200:207], v252
  s_waitcnt vmcnt(27) lgkmcnt(0)
  v_smfmac_f32_32x32x32_bf16 v[216:231], v[148:151], v[192:199], v252
  v_smfmac_f32_32x32x32_bf16 v[232:247], v[148:151], v[208:215], v252
  s_setprio 2
  v_mov_b32 v8, 1
  s_mov_b64 exec, 1
  ds_add_u32 v7, v8 offset:52
  s_mov_b64 exec, -1
  s_lshl_b32 s51, s50, 18
  s_lshl_b32 s52, s49, 7
  s_add_u32 s51, s51, s52
  s_add_u32 s51, s51, 3145728
  s_lshl_b32 s52, s70, 16
  s_add_u32 s53, s51, s52
  s_sub_u32 s54, s51, s52
  s_add_u32 s54, s54, 196608
  v_xor_b32 v248, 57344, v255
  s_or_b32 s51, s50, s70
  s_nop 7
  v_pk_add_f32 v[152:153], v[216:217], v[224:225]
  v_pk_add_f32 v[160:161], v[216:217], v[224:225] neg_lo:[0,1] neg_hi:[1,0]
  v_pk_add_f32 v[154:155], v[218:219], v[226:227]
  v_pk_add_f32 v[162:163], v[218:219], v[226:227] neg_lo:[0,1] neg_hi:[1,0]
  v_pk_add_f32 v[156:157], v[220:221], v[228:229]
  v_pk_add_f32 v[164:165], v[220:221], v[228:229] neg_lo:[0,1] neg_hi:[1,0]
  v_pk_add_f32 v[158:159], v[222:223], v[230:231]
  v_pk_add_f32 v[166:167], v[222:223], v[230:231] neg_lo:[0,1] neg_hi:[1,0]
  v_pk_add_f32 v[168:169], v[232:233], v[240:241]
  v_pk_add_f32 v[176:177], v[232:233], v[240:241] neg_lo:[0,1] neg_hi:[1,0]
  v_pk_add_f32 v[170:171], v[234:235], v[242:243]
  v_pk_add_f32 v[178:179], v[234:235], v[242:243] neg_lo:[0,1] neg_hi:[1,0]
  v_pk_add_f32 v[172:173], v[236:237], v[244:245]
  v_pk_add_f32 v[180:181], v[236:237], v[244:245] neg_lo:[0,1] neg_hi:[1,0]
  v_pk_add_f32 v[174:175], v[238:239], v[246:247]
  v_pk_add_f32 v[182:183], v[238:239], v[246:247] neg_lo:[0,1] neg_hi:[1,0]
  s_cbranch_scc1 KG_H2S
  s_mov_b32 exec_hi, 0
  v_swap_b32 v153, v160
  v_swap_b32 v169, v176
  s_mov_b32 exec_hi, -1
KG_H2S:
  v_cvt_pk_bf16_f32 v184, v152, v153
  v_cvt_pk_bf16_f32 v185, v154, v155
  v_cvt_pk_bf16_f32 v186, v156, v157
  v_cvt_pk_bf16_f32 v187, v158, v159
  ds_write_b128 v253, v[184:187] offset:0
  v_cvt_pk_bf16_f32 v188, v160, v161
  v_cvt_pk_bf16_f32 v189, v162, v163
  v_cvt_pk_bf16_f32 v190, v164, v165
  v_cvt_pk_bf16_f32 v191, v166, v167
  ds_write_b128 v253, v[188:191] offset:32
  v_cvt_pk_bf16_f32 v192, v168, v169
  v_cvt_pk_bf16_f32 v193, v170, v171
  v_cvt_pk_bf16_f32 v194, v172, v173
  v_cvt_pk_bf16_f32 v195, v174, v175
  ds_write_b128 v253, v[192:195] offset:2560
  v_cvt_pk_bf16_f32 v196, v176, v177
  v_cvt_pk_bf16_f32 v197, v178, v179
  v_cvt_pk_bf16_f32 v198, v180, v181
  v_cvt_pk_bf16_f32 v199, v182, v183
  ds_write_b128 v253, v[196:199] offset:2592
  s_waitcnt lgkmcnt(0)
  ds_read_b64_tr_b16 v[152:153], v254 offset:0
  ds_read_b64_tr_b16 v[154:155], v254 offset:320
  ds_read_b64_tr_b16 v[156:157], v254 offset:2560
  ds_read_b64_tr_b16 v[158:159], v254 offset:2880
  ds_read_b64_tr_b16 v[160:161], v254 offset:32
  ds_read_b64_tr_b16 v[162:163], v254 offset:352
  ds_read_b64_tr_b16 v[164:165], v254 offset:2592
  ds_read_b64_tr_b16 v[166:167], v254 offset:2912
  s_waitcnt lgkmcnt(6)
  buffer_store_dwordx4 v[152:155], v255, s[28:31], s53 offen offset:0 sc1
  s_waitcnt lgkmcnt(4)
  buffer_store_dwordx4 v[156:159], v255, s[28:31], s53 offen offset:64 sc1
  s_waitcnt lgkmcnt(2)
  buffer_store_dwordx4 v[160:163], v248, s[28:31], s54 offen offset:0 sc1
  s_waitcnt lgkmcnt(0)
  buffer_store_dwordx4 v[164:167], v248, s[28:31], s54 offen offset:64 sc1
  v_mov_b32 v8, 1
  s_waitcnt vmcnt(0)
  s_mov_b64 exec, 1
  ds_add_rtn_u32 v9, v7, v8 offset:108
  s_mov_b64 exec, -1
  s_waitcnt lgkmcnt(0)
  v_readfirstlane_b32 s51, v9
  s_cmp_lg_u32 s51, 2
  s_cbranch_scc1 KG_JN28
  s_lshr_b32 s51, s67, 2
  s_lshl_b32 s51, s51, 7
  s_and_b32 s52, s67, 3
  s_lshl_b32 s52, s52, 2
  s_add_u32 s51, s51, s52
  s_add_u32 s51, s51, 2392064
  v_mov_b32 v8, 0
  v_mov_b32 v9, s73
  s_mov_b64 exec, 1
  buffer_store_dword v9, v8, s[28:31], s51 offen sc1
  s_mov_b64 exec, -1
KG_JN28:
  s_getpc_b64 s[32:33]
  s_add_u32 s32, s32, TAB_FINV@rel32@lo+4
  s_addc_u32 s33, s33, TAB_FINV@rel32@hi+12
  s_mov_b32 s34, 262144
  s_mov_b32 s35, 0x20000
  s_cmp_eq_u32 s68, 3
  s_cselect_b64 s[32:33], s[12:13], s[32:33]
  s_cselect_b32 s34, 524288, s34
  s_lshr_b32 s51, s2, 3
  s_lshl_b32 s51, s51, 13
  s_add_u32 s52, s51, 262144
  v_lshlrev_b32 v10, 7, v0
KG_LW29:
  ds_read_b32 v8, v7 offset:96
  s_waitcnt lgkmcnt(0)
  v_readfirstlane_b32 s71, v8
  s_cmp_ge_u32 s71, 127
  s_cbranch_scc1 KG_LD29
  s_sleep 2
  s_sub_u32 s72, s72, 1
  s_cbranch_scc0 KG_LW29
  s_mov_b32 s72, 0
KG_LD29:
KG_LW30:
  ds_read_b32 v8, v7 offset:52
  s_waitcnt lgkmcnt(0)
  v_readfirstlane_b32 s53, v8
  s_cmp_ge_u32 s53, 2
  s_cbranch_scc1 KG_LD30
  s_sleep 2
  s_sub_u32 s72, s72, 1
  s_cbranch_scc0 KG_LW30
  s_mov_b32 s72, 0
KG_LD30:
  s_lshl_b32 s57, s70, 13
  s_add_u32 s54, s57, 2097152
  s_bfe_u32 s53, s71, 0x3000e
  s_lshl_b32 s53, s53, 14
  s_add_u32 s53, s53, s54
  s_add_u32 m0, s57, 0
  s_nop 0
  buffer_load_dwordx4 v3, s[28:31], s53 offen offset:0 lds
  buffer_load_dwordx4 v3, s[28:31], s53 offen offset:1024 lds
  buffer_load_dwordx4 v3, s[28:31], s53 offen offset:2048 lds
  buffer_load_dwordx4 v3, s[28:31], s53 offen offset:3072 lds
  s_add_u32 m0, s57, 4096
  s_add_u32 s53, s53, 4096
  buffer_load_dwordx4 v3, s[28:31], s53 offen offset:0 lds
  buffer_load_dwordx4 v3, s[28:31], s53 offen offset:1024 lds
  buffer_load_dwordx4 v3, s[28:31], s53 offen offset:2048 lds
  buffer_load_dwordx4 v3, s[28:31], s53 offen offset:3072 lds
  s_bfe_u32 s53, s71, 0x3000b
  s_lshl_b32 s53, s53, 14
  s_add_u32 s53, s53, s54
  s_add_u32 m0, s57, 16384
  s_nop 0
  buffer_load_dwordx4 v3, s[28:31], s53 offen offset:0 lds
  buffer_load_dwordx4 v3, s[28:31], s53 offen offset:1024 lds
  buffer_load_dwordx4 v3, s[28:31], s53 offen offset:2048 lds
  buffer_load_dwordx4 v3, s[28:31], s53 offen offset:3072 lds
  s_add_u32 m0, s57, 20480
  s_add_u32 s53, s53, 4096
  buffer_load_dwordx4 v3, s[28:31], s53 offen offset:0 lds
  buffer_load_dwordx4 v3, s[28:31], s53 offen offset:1024 lds
  buffer_load_dwordx4 v3, s[28:31], s53 offen offset:2048 lds
  buffer_load_dwordx4 v3, s[28:31], s53 offen offset:3072 lds
  s_bfe_u32 s53, s71, 0x30008
  s_lshl_b32 s53, s53, 14
  s_add_u32 s53, s53, s54
  s_add_u32 m0, s57, 32768
  s_nop 0
  buffer_load_dwordx4 v3, s[28:31], s53 offen offset:0 lds
  buffer_load_dwordx4 v3, s[28:31], s53 offen offset:1024 lds
  buffer_load_dwordx4 v3, s[28:31], s53 offen offset:2048 lds
  buffer_load_dwordx4 v3, s[28:31], s53 offen offset:3072 lds
  s_add_u32 m0, s57, 36864
  s_add_u32 s53, s53, 4096
  buffer_load_dwordx4 v3, s[28:31], s53 offen offset:0 lds
  buffer_load_dwordx4 v3, s[28:31], s53 offen offset:1024 lds
  buffer_load_dwordx4 v3, s[28:31], s53 offen offset:2048 lds
  buffer_load_dwordx4 v3, s[28:31], s53 offen offset:3072 lds
  buffer_load_dword v134, v10, s[32:35], s51 offen
  buffer_load_dword v135, v10, s[32:35], s52 offen
  v_mov_b32 v9, 2
  s_waitcnt vmcnt(2)
  s_mov_b64 exec, 1
  ds_add_u32 v7, v9 offset:48
  s_mov_b64 exec, -1
  s_branch KG_H3B
KG_J1:
  v_mov_b32 v8, 1
  s_waitcnt vmcnt(0)
  s_mov_b64 exec, 1
  ds_add_rtn_u32 v9, v7, v8 offset:108
  s_mov_b64 exec, -1
  s_waitcnt lgkmcnt(0)
  v_readfirstlane_b32 s51, v9
  s_cmp_lg_u32 s51, 2
  s_cbranch_scc1 KG_JN31
  s_lshr_b32 s51, s67, 2
  s_lshl_b32 s51, s51, 7
  s_and_b32 s52, s67, 3
  s_lshl_b32 s52, s52, 2
  s_add_u32 s51, s51, s52
  s_add_u32 s51, s51, 2392064
  v_mov_b32 v8, 0
  v_mov_b32 v9, s73
  s_mov_b64 exec, 1
  buffer_store_dword v9, v8, s[28:31], s51 offen sc1
  s_mov_b64 exec, -1
KG_JN31:
KG_H3:
  s_getpc_b64 s[40:41]
  s_add_u32 s40, s40, TAB_K2@rel32@lo+4
  s_addc_u32 s41, s41, TAB_K2@rel32@hi+12
  s_mov_b32 s42, 83968
  s_mov_b32 s43, 0x20000
  s_mul_i32 s64, s68, 5120
  s_add_u32 s64, s64, 63488
  s_add_u32 s65, s64, 4096
  s_lshr_b32 s69, s68, 1
  s_and_b32 s70, s68, 1
  buffer_load_dwordx3 v[4:6], v3, s[40:43], s64 offen offset:2048
  s_waitcnt vmcnt(15)
  buffer_load_dwordx4 v[128:131], v3, s[40:43], s64 offen offset:0
  s_waitcnt vmcnt(15)
  buffer_load_dword v132, v3, s[40:43], s64 offen offset:1024
  s_waitcnt vmcnt(15)
  buffer_load_dword v1, v3, s[40:43], s64 offen offset:1028
  s_waitcnt vmcnt(15)
  buffer_load_dword v2, v3, s[40:43], s64 offen offset:1032
  s_waitcnt vmcnt(15)
  s_mul_i32 s51, s69, 12288
  buffer_load_dwordx4 v[16:19], v3, s[40:43], s51 offen offset:0
  s_waitcnt vmcnt(15)
  buffer_load_dwordx4 v[20:23], v3, s[40:43], s51 offen offset:1024
  s_waitcnt vmcnt(15)
  buffer_load_dwordx4 v[24:27], v3, s[40:43], s51 offen offset:2048
  s_waitcnt vmcnt(15)
  buffer_load_dwordx4 v[28:31], v3, s[40:43], s51 offen offset:3072
  s_waitcnt vmcnt(15)
  s_add_u32 s51, s51, 4096
  buffer_load_dwordx4 v[32:35], v3, s[40:43], s51 offen offset:0
  s_waitcnt vmcnt(15)
  buffer_load_dwordx4 v[36:39], v3, s[40:43], s51 offen offset:1024
  s_waitcnt vmcnt(15)
  buffer_load_dwordx4 v[40:43], v3, s[40:43], s51 offen offset:2048
  s_waitcnt vmcnt(15)
  buffer_load_dwordx4 v[44:47], v3, s[40:43], s51 offen offset:3072
  s_waitcnt vmcnt(15)
  s_add_u32 s51, s51, 4096
  buffer_load_dwordx4 v[48:51], v3, s[40:43], s51 offen offset:0
  s_waitcnt vmcnt(15)
  buffer_load_dwordx4 v[52:55], v3, s[40:43], s51 offen offset:1024
  s_waitcnt vmcnt(15)
  buffer_load_dwordx4 v[56:59], v3, s[40:43], s51 offen offset:2048
  s_waitcnt vmcnt(15)
  buffer_load_dwordx4 v[60:63], v3, s[40:43], s51 offen offset:3072
  s_waitcnt vmcnt(15)
  s_lshl_b32 s51, s68, 12
  s_add_u32 s51, s51, 30720
  buffer_load_dwordx4 v[104:107], v3, s[40:43], s51 offen offset:0
  s_waitcnt vmcnt(15)
  buffer_load_dwordx4 v[108:111], v3, s[40:43], s51 offen offset:1024
  s_waitcnt vmcnt(15)
  buffer_load_dwordx4 v[112:115], v3, s[40:43], s51 offen offset:2048
  s_waitcnt vmcnt(15)
  buffer_load_dwordx4 v[116:119], v3, s[40:43], s51 offen offset:3072
  s_waitcnt vmcnt(15)
  s_mov_b32 s51, 24576
  buffer_load_dwordx4 v[64:67], v3, s[40:43], s51 offen offset:0
  s_waitcnt vmcnt(15)
  buffer_load_dwordx4 v[68:71], v3, s[40:43], s51 offen offset:1024
  s_waitcnt vmcnt(15)
  buffer_load_dwordx4 v[72:75], v3, s[40:43], s51 offen offset:2048
  s_waitcnt vmcnt(15)
  buffer_load_dwordx4 v[76:79], v3, s[40:43], s51 offen offset:3072
  s_waitcnt vmcnt(15)
  s_mov_b32 s51, 28672
  buffer_load_dwordx4 v[80:83], v3, s[40:43], s51 offen offset:0
  s_waitcnt vmcnt(15)
  buffer_load_dwordx4 v[84:87], v3, s[40:43], s51 offen offset:1024
  s_waitcnt vmcnt(15)
KG_H3B:
  buffer_load_dwordx4 v[248:251], v3, s[40:43], s64 offen offset:3072
  buffer_load_dwordx4 v[252:255], v3, s[40:43], s65 offen offset:0
  s_cmp_eq_u32 s67, 0
  s_cbranch_scc1 KG_SPA
KG_SPAR:
KG_PCE:
  s_cmp_lg_u32 s68, 0
  s_cbranch_scc1 KG_S1W
  s_lshl_b32 s52, s50, 10
  s_add_u32 s52, s52, 2392064
  s_mov_b32 s55, 262144
  v_lshlrev_b32 v8, 7, v0
  s_mov_b64 exec, 255
KG_GPS1:
  buffer_load_dwordx4 v[12:15], v8, s[28:31], s52 offen sc1
  s_waitcnt vmcnt(0)
  v_xor_b32 v12, s73, v12
  v_xor_b32 v13, s73, v13
  v_xor_b32 v14, s73, v14
  v_xor_b32 v15, s73, v15
  v_or3_b32 v12, v12, v13, v14
  v_or_b32 v12, v12, v15
  v_cmp_ne_u32 vcc, 0, v12
  s_sub_u32 s55, s55, 1
  s_cbranch_scc1 KG_GDS1
  s_and_b64 exec, exec, vcc
  s_cbranch_scc0 KG_GDS1
  s_sleep 2
  s_branch KG_GPS1
KG_GDS1:
  s_mov_b64 exec, -1
  ds_write_b32 v7, v4 offset:112
KG_S1W:
KG_PW32:
  ds_read_b32 v12, v5
  s_waitcnt lgkmcnt(0)
  v_cmp_gt_u32 vcc, 3, v12
  s_cbranch_vccz KG_PD32
  s_sleep 2
  s_sub_u32 s72, s72, 1
  s_cbranch_scc0 KG_PW32
  s_mov_b32 s72, 0
KG_PD32:
KG_LW33:
  ds_read_b32 v8, v7 offset:112
  s_waitcnt lgkmcnt(0)
  v_readfirstlane_b32 s51, v8
  s_cmp_ge_u32 s51, 1
  s_cbranch_scc1 KG_LD33
  s_sleep 2
  s_sub_u32 s72, s72, 1
  s_cbranch_scc0 KG_LW33
  s_mov_b32 s72, 0
KG_LD33:
  s_lshl_b32 s51, s67, 13
  s_lshl_b32 s52, s70, 11
  s_add_u32 s51, s51, s52
  s_add_u32 s51, s51, 3145728
  s_add_u32 s52, s51, 4096
  buffer_load_dwordx4 v[88:91], v128, s[28:31], s51 offen offset:0 sc1
  buffer_load_dwordx4 v[92:95], v128, s[28:31], s51 offen offset:64 sc1
  buffer_load_dwordx4 v[96:99], v128, s[28:31], s52 offen offset:0 sc1
  buffer_load_dwordx4 v[100:103], v128, s[28:31], s52 offen offset:64 sc1
  s_lshl_b32 s51, s67, 13
  s_cmp_eq_u32 s67, 31
  s_cselect_b32 s51, 2097152, s51
  s_lshl_b32 s52, s68, 11
  s_add_u32 s52, s52, 9437184
  s_add_u32 s51, s51, s52
  s_cmp_lg_u32 s67, 0
  s_cbranch_scc1 KG_NXX
  s_add_u32 s52, s52, 253952
  buffer_load_dwordx4 v[172:175], v3, s[28:31], s52 offen offset:0 sc1
  buffer_load_dwordx4 v[180:183], v3, s[28:31], s52 offen offset:1024 sc1
KG_NXX:
  buffer_load_dwordx4 v[140:143], v3, s[28:31], s51 offen offset:0 sc1
  buffer_load_dwordx4 v[148:151], v3, s[28:31], s51 offen offset:1024 sc1
  s_getpc_b64 s[36:37]
  s_add_u32 s36, s36, TAB_FINV@rel32@lo+4
  s_addc_u32 s37, s37, TAB_FINV@rel32@hi+12
  s_mov_b32 s38, 262144
  s_mov_b32 s39, 0x20000
  s_lshl_b32 s56, s50, 15
  s_lshl_b32 s51, s69, 10
  s_add_u32 s56, s56, s51
  s_add_u32 s57, s56, 0
  buffer_load_dwordx4 v[192:195], v3, s[36:39], s57 offen offset:0
  buffer_load_dwordx4 v[196:199], v3, s[36:39], s57 offen offset:2048
  s_add_u32 s57, s56, 4096
  buffer_load_dwordx4 v[200:203], v3, s[36:39], s57 offen offset:0
  buffer_load_dwordx4 v[204:207], v3, s[36:39], s57 offen offset:2048
  s_add_u32 s57, s56, 8192
  buffer_load_dwordx4 v[208:211], v3, s[36:39], s57 offen offset:0
  buffer_load_dwordx4 v[212:215], v3, s[36:39], s57 offen offset:2048
  s_add_u32 s57, s56, 12288
  buffer_load_dwordx4 v[216:219], v3, s[36:39], s57 offen offset:0
  buffer_load_dwordx4 v[220:223], v3, s[36:39], s57 offen offset:2048
  s_add_u32 s57, s56, 16384
  buffer_load_dwordx4 v[224:227], v3, s[36:39], s57 offen offset:0
  buffer_load_dwordx4 v[228:231], v3, s[36:39], s57 offen offset:2048
  s_add_u32 s57, s56, 20480
  buffer_load_dwordx4 v[232:235], v3, s[36:39], s57 offen offset:0
  buffer_load_dwordx4 v[236:239], v3, s[36:39], s57 offen offset:2048
  s_add_u32 s57, s56, 24576
  buffer_load_dwordx4 v[240:243], v3, s[36:39], s57 offen offset:0
  buffer_load_dwordx4 v[244:247], v3, s[36:39], s57 offen offset:2048
  s_setprio 0
  s_waitcnt vmcnt(16)
  v_mfma_f32_16x16x32_bf16 v[152:155], v[88:91], v[16:19], 0
  v_mfma_f32_16x16x32_bf16 v[156:159], v[96:99], v[16:19], 0
  v_mfma_f32_16x16x32_bf16 v[160:163], v[88:91], v[40:43], 0
  v_mfma_f32_16x16x32_bf16 v[164:167], v[96:99], v[40:43], 0
  v_mfma_f32_16x16x32_bf16 v[152:155], v[96:99], v[24:27], v[152:155]
  v_mfma_f32_16x16x32_bf16 v[156:159], v[88:91], v[20:23], v[156:159]
  v_mfma_f32_16x16x32_bf16 v[160:163], v[96:99], v[48:51], v[160:163]
  v_mfma_f32_16x16x32_bf16 v[164:167], v[88:91], v[44:47], v[164:167]
  v_mfma_f32_16x16x32_bf16 v[152:155], v[92:95], v[28:31], v[152:155]
  v_mfma_f32_16x16x32_bf16 v[156:159], v[100:103], v[28:31], v[156:159]
  v_mfma_f32_16x16x32_bf16 v[160:163], v[92:95], v[52:55], v[160:163]
  v_mfma_f32_16x16x32_bf16 v[164:167], v[100:103], v[52:55], v[164:167]
  v_mfma_f32_16x16x32_bf16 v[152:155], v[100:103], v[36:39], v[152:155]
  v_mfma_f32_16x16x32_bf16 v[156:159], v[92:95], v[32:35], v[156:159]
  v_mfma_f32_16x16x32_bf16 v[160:163], v[100:103], v[60:63], v[160:163]
  v_mfma_f32_16x16x32_bf16 v[164:167], v[92:95], v[56:59], v[164:167]
  s_setprio 2
  s_cmp_eq_u32 s67, 0
  s_cbranch_scc1 KG_SPB
KG_SPBR:
  s_nop 7
  s_nop 4
  v_pk_mul_f32 v[8:9], v[152:153], v[104:105]
  v_pk_mul_f32 v[10:11], v[152:153], v[108:109]
  v_pk_fma_f32 v[152:153], v[156:157], v[108:109], v[8:9] neg_lo:[1,0,0] neg_hi:[1,0,0]
  v_pk_fma_f32 v[156:157], v[156:157], v[104:105], v[10:11]
  v_pk_mul_f32 v[8:9], v[154:155], v[106:107]
  v_pk_mul_f32 v[10:11], v[154:155], v[110:111]
  v_pk_fma_f32 v[154:155], v[158:159], v[110:111], v[8:9] neg_lo:[1,0,0] neg_hi:[1,0,0]
  v_pk_fma_f32 v[158:159], v[158:159], v[106:107], v[10:11]
  v_pk_mul_f32 v[8:9], v[160:161], v[112:113]
  v_pk_mul_f32 v[10:11], v[160:161], v[116:117]
  v_pk_fma_f32 v[160:161], v[164:165], v[116:117], v[8:9] neg_lo:[1,0,0] neg_hi:[1,0,0]
  v_pk_fma_f32 v[164:165], v[164:165], v[112:113], v[10:11]
  v_pk_mul_f32 v[8:9], v[162:163], v[114:115]
  v_pk_mul_f32 v[10:11], v[162:163], v[118:119]
  v_pk_fma_f32 v[162:163], v[166:167], v[118:119], v[8:9] neg_lo:[1,0,0] neg_hi:[1,0,0]
  v_pk_fma_f32 v[166:167], v[166:167], v[114:115], v[10:11]
  v_cvt_pk_bf16_f32 v88, v152, v153
  v_cvt_pk_bf16_f32 v89, v154, v155
  v_cvt_pk_bf16_f32 v90, v156, v157
  v_cvt_pk_bf16_f32 v91, v158, v159
  v_cvt_pk_bf16_f32 v92, v160, v161
  v_cvt_pk_bf16_f32 v93, v162, v163
  v_cvt_pk_bf16_f32 v94, v164, v165
  v_cvt_pk_bf16_f32 v95, v166, v167
  ds_write_b64 v129, v[88:89] offset:0
  ds_write_b64 v129, v[90:91] offset:5120
  ds_write_b64 v129, v[92:93] offset:1280
  ds_write_b64 v129, v[94:95] offset:6400
  s_lshl_b32 s51, s68, 12
  s_add_u32 s51, s51, 47104
  buffer_load_dwordx4 v[104:107], v3, s[40:43], s51 offen offset:0
  buffer_load_dwordx4 v[108:111], v3, s[40:43], s51 offen offset:1024
  buffer_load_dwordx4 v[112:115], v3, s[40:43], s51 offen offset:2048
  buffer_load_dwordx4 v[116:119], v3, s[40:43], s51 offen offset:3072
  s_waitcnt lgkmcnt(0)
  s_mov_b64 exec, 1
  ds_add_u32 v7, v4 offset:116
  s_mov_b64 exec, -1
KG_LW34:
  ds_read_b32 v8, v7 offset:116
  s_waitcnt lgkmcnt(0)
  v_readfirstlane_b32 s51, v8
  s_cmp_ge_u32 s51, 4
  s_cbranch_scc1 KG_LD34
  s_sleep 2
  s_sub_u32 s72, s72, 1
  s_cbranch_scc0 KG_LW34
  s_mov_b32 s72, 0
KG_LD34:
  ds_read_b128 v[88:91], v130
  ds_read_b128 v[92:95], v130 offset:5120
  s_setprio 0
  s_waitcnt vmcnt(18) lgkmcnt(0)
  v_mfma_f32_16x16x32_bf16 v[152:155], v[64:67], v[88:91], 0
  v_mfma_f32_16x16x32_bf16 v[156:159], v[64:67], v[92:95], 0
  v_mfma_f32_16x16x32_bf16 v[160:163], v[76:79], v[88:91], 0
  v_mfma_f32_16x16x32_bf16 v[164:167], v[76:79], v[92:95], 0
  v_mfma_f32_16x16x32_bf16 v[152:155], v[72:75], v[92:95], v[152:155]
  v_mfma_f32_16x16x32_bf16 v[156:159], v[68:71], v[88:91], v[156:159]
  v_mfma_f32_16x16x32_bf16 v[160:163], v[84:87], v[92:95], v[160:163]
  v_mfma_f32_16x16x32_bf16 v[164:167], v[80:83], v[88:91], v[164:167]
  s_setprio 2
  v_lshlrev_b32 v136, 16, v140
  v_and_b32 v137, 0xffff0000, v140
  v_lshlrev_b32 v138, 16, v141
  v_and_b32 v139, 0xffff0000, v141
  v_lshlrev_b32 v140, 16, v142
  v_and_b32 v141, 0xffff0000, v142
  v_lshlrev_b32 v142, 16, v143
  v_and_b32 v143, 0xffff0000, v143
  v_lshlrev_b32 v144, 16, v148
  v_and_b32 v145, 0xffff0000, v148
  v_lshlrev_b32 v146, 16, v149
  v_and_b32 v147, 0xffff0000, v149
  v_lshlrev_b32 v148, 16, v150
  v_and_b32 v149, 0xffff0000, v150
  v_lshlrev_b32 v150, 16, v151
  v_and_b32 v151, 0xffff0000, v151
  s_cmp_eq_u32 s67, 0
  s_cbranch_scc1 KG_SPECIAL
  v_pk_mul_f32 v[8:9], v[152:153], v[136:137]
  v_pk_mul_f32 v[10:11], v[152:153], v[144:145]
  v_pk_fma_f32 v[152:153], v[156:157], v[144:145], v[8:9] neg_lo:[1,0,0] neg_hi:[1,0,0]
  v_pk_fma_f32 v[156:157], v[156:157], v[136:137], v[10:11]
  v_pk_mul_f32 v[8:9], v[154:155], v[138:139]
  v_pk_mul_f32 v[10:11], v[154:155], v[146:147]
  v_pk_fma_f32 v[154:155], v[158:159], v[146:147], v[8:9] neg_lo:[1,0,0] neg_hi:[1,0,0]
  v_pk_fma_f32 v[158:159], v[158:159], v[138:139], v[10:11]
  v_pk_mul_f32 v[8:9], v[160:161], v[140:141]
  v_pk_mul_f32 v[10:11], v[160:161], v[148:149]
  v_pk_fma_f32 v[160:161], v[164:165], v[148:149], v[8:9] neg_lo:[1,0,0] neg_hi:[1,0,0]
  v_pk_fma_f32 v[164:165], v[164:165], v[140:141], v[10:11]
  v_pk_mul_f32 v[8:9], v[162:163], v[142:143]
  v_pk_mul_f32 v[10:11], v[162:163], v[150:151]
  v_pk_fma_f32 v[162:163], v[166:167], v[150:151], v[8:9] neg_lo:[1,0,0] neg_hi:[1,0,0]
  v_pk_fma_f32 v[166:167], v[166:167], v[142:143], v[10:11]
KG_STEP3:
  v_cvt_pk_bf16_f32 v88, v152, v153
  v_cvt_pk_bf16_f32 v89, v154, v155
  v_cvt_pk_bf16_f32 v92, v156, v157
  v_cvt_pk_bf16_f32 v93, v158, v159
  v_cvt_pk_bf16_f32 v90, v160, v161
  v_cvt_pk_bf16_f32 v91, v162, v163
  v_cvt_pk_bf16_f32 v94, v164, v165
  v_cvt_pk_bf16_f32 v95, v166, v167
  s_setprio 0
  s_nop 1
  v_mfma_f32_16x16x32_bf16 v[152:155], v[88:91], v[64:67], 0
  v_mfma_f32_16x16x32_bf16 v[156:159], v[92:95], v[64:67], 0
  v_mfma_f32_16x16x32_bf16 v[160:163], v[88:91], v[76:79], 0
  v_mfma_f32_16x16x32_bf16 v[164:167], v[92:95], v[76:79], 0
  v_mfma_f32_16x16x32_bf16 v[152:155], v[92:95], v[68:71], v[152:155]
  v_mfma_f32_16x16x32_bf16 v[156:159], v[88:91], v[72:75], v[156:159]
  v_mfma_f32_16x16x32_bf16 v[160:163], v[92:95], v[80:83], v[160:163]
  v_mfma_f32_16x16x32_bf16 v[164:167], v[88:91], v[84:87], v[164:167]
  s_setprio 2
  s_nop 7
  s_waitcnt vmcnt(0)
  s_nop 4
  v_pk_mul_f32 v[8:9], v[152:153], v[104:105]
  v_pk_mul_f32 v[10:11], v[152:153], v[108:109]
  v_pk_fma_f32 v[152:153], v[156:157], v[108:109], v[8:9] neg_lo:[1,0,0] neg_hi:[1,0,0]
  v_pk_fma_f32 v[156:157], v[156:157], v[104:105], v[10:11]
  v_pk_mul_f32 v[8:9], v[154:155], v[106:107]
  v_pk_mul_f32 v[10:11], v[154:155], v[110:111]
  v_pk_fma_f32 v[154:155], v[158:159], v[110:111], v[8:9] neg_lo:[1,0,0] neg_hi:[1,0,0]
  v_pk_fma_f32 v[158:159], v[158:159], v[106:107], v[10:11]
  v_pk_mul_f32 v[8:9], v[160:161], v[112:113]
  v_pk_mul_f32 v[10:11], v[160:161], v[116:117]
  v_pk_fma_f32 v[160:161], v[164:165], v[116:117], v[8:9] neg_lo:[1,0,0] neg_hi:[1,0,0]
  v_pk_fma_f32 v[164:165], v[164:165], v[112:113], v[10:11]
  v_pk_mul_f32 v[8:9], v[162:163], v[114:115]
  v_pk_mul_f32 v[10:11], v[162:163], v[118:119]
  v_pk_fma_f32 v[162:163], v[166:167], v[118:119], v[8:9] neg_lo:[1,0,0] neg_hi:[1,0,0]
  v_pk_fma_f32 v[166:167], v[166:167], v[114:115], v[10:11]
  v_cvt_pk_bf16_f32 v88, v152, v153
  v_cvt_pk_bf16_f32 v89, v154, v155
  v_cvt_pk_bf16_f32 v90, v156, v157
  v_cvt_pk_bf16_f32 v91, v158, v159
  v_cvt_pk_bf16_f32 v92, v160, v161
  v_cvt_pk_bf16_f32 v93, v162, v163
  v_cvt_pk_bf16_f32 v94, v164, v165
  v_cvt_pk_bf16_f32 v95, v166, v167
  ds_write_b64 v131, v[88:89] offset:0
  ds_write_b64 v131, v[90:91] offset:4608
  ds_write_b64 v131, v[92:93] offset:2304
  ds_write_b64 v131, v[94:95] offset:6912
  s_waitcnt lgkmcnt(0)
  s_mov_b64 exec, 1
  ds_add_u32 v7, v4 offset:120
  s_mov_b64 exec, -1
KG_LW35:
  ds_read_b32 v8, v7 offset:120
  s_waitcnt lgkmcnt(0)
  v_readfirstlane_b32 s51, v8
  s_cmp_ge_u32 s51, 4
  s_cbranch_scc1 KG_LD35
  s_sleep 2
  s_sub_u32 s72, s72, 1
  s_cbranch_scc0 KG_LW35
  s_mov_b32 s72, 0
KG_LD35:
  ds_read_b128 v[88:91], v132 offset:0
  ds_read_b128 v[92:95], v132 offset:64
  ds_read_b128 v[96:99], v132 offset:4608
  ds_read_b128 v[100:103], v132 offset:4672
  s_setprio 0
  s_waitcnt lgkmcnt(0)
  v_mfma_f32_16x16x32_bf16 v[152:155], v[16:19], v[88:91], 0
  v_mfma_f32_16x16x32_bf16 v[156:159], v[16:19], v[96:99], 0
  v_mfma_f32_16x16x32_bf16 v[160:163], v[40:43], v[88:91], 0
  v_mfma_f32_16x16x32_bf16 v[164:167], v[40:43], v[96:99], 0
  v_mfma_f32_16x16x32_bf16 v[152:155], v[20:23], v[96:99], v[152:155]
  v_mfma_f32_16x16x32_bf16 v[156:159], v[24:27], v[88:91], v[156:159]
  v_mfma_f32_16x16x32_bf16 v[160:163], v[44:47], v[96:99], v[160:163]
  v_mfma_f32_16x16x32_bf16 v[164:167], v[48:51], v[88:91], v[164:167]
  v_mfma_f32_16x16x32_bf16 v[152:155], v[28:31], v[92:95], v[152:155]
  v_mfma_f32_16x16x32_bf16 v[156:159], v[28:31], v[100:103], v[156:159]
  v_mfma_f32_16x16x32_bf16 v[160:163], v[52:55], v[92:95], v[160:163]
  v_mfma_f32_16x16x32_bf16 v[164:167], v[52:55], v[100:103], v[164:167]
  v_mfma_f32_16x16x32_bf16 v[152:155], v[32:35], v[100:103], v[152:155]
  v_mfma_f32_16x16x32_bf16 v[156:159], v[36:39], v[92:95], v[156:159]
  v_mfma_f32_16x16x32_bf16 v[160:163], v[56:59], v[100:103], v[160:163]
  v_mfma_f32_16x16x32_bf16 v[164:167], v[60:63], v[92:95], v[164:167]
  s_setprio 2
  s_nop 1
  s_lshl_b32 s51, s67, 13
  s_lshl_b32 s52, s70, 11
  s_add_u32 s51, s51, s52
  s_lshl_b32 s52, s69, 6
  s_add_u32 s51, s51, s52
  s_add_u32 s51, s51, 7340032
  s_add_u32 s52, s51, 4096
  v_cvt_pk_bf16_f32 v88, v152, v153
  v_cvt_pk_bf16_f32 v89, v154, v155
  v_cvt_pk_bf16_f32 v90, v160, v161
  v_cvt_pk_bf16_f32 v91, v162, v163
  v_cvt_pk_bf16_f32 v92, v156, v157
  v_cvt_pk_bf16_f32 v93, v158, v159
  v_cvt_pk_bf16_f32 v94, v164, v165
  v_cvt_pk_bf16_f32 v95, v166, v167
  buffer_store_dwordx4 v[88:91], v128, s[28:31], s51 offen sc1
  buffer_store_dwordx4 v[92:95], v128, s[28:31], s52 offen sc1
  s_waitcnt vmcnt(0)
  s_mov_b64 exec, 1
  ds_add_rtn_u32 v9, v7, v4 offset:128
  s_mov_b64 exec, -1
  s_waitcnt lgkmcnt(0)
  v_readfirstlane_b32 s51, v9
  s_cmp_lg_u32 s51, 3
  s_cbranch_scc1 KG_JN36
  s_lshr_b32 s51, s67, 2
  s_lshl_b32 s51, s51, 7
  s_and_b32 s52, s67, 3
  s_lshl_b32 s52, s52, 2
  s_add_u32 s51, s51, s52
  s_add_u32 s51, s51, 2408448
  v_mov_b32 v8, 0
  v_mov_b32 v9, s73
  s_mov_b64 exec, 1
  buffer_store_dword v9, v8, s[28:31], s51 offen sc1
  s_mov_b64 exec, -1
KG_JN36:
  s_lshr_b32 s3, s68, 1
  s_and_b32 s66, s68, 1
  s_mov_b32 s32, s12
  s_mov_b32 s33, s13
  s_mov_b32 s34, 524288
  s_mov_b32 s35, 0x20000
  s_lshl_b32 s54, s68, 14
  s_lshl_b32 s53, s68, 17
  s_lshl_b32 s51, s50, 6
  s_add_u32 s53, s53, s51
KG_PW37:
  ds_read_b32 v12, v5
  s_waitcnt lgkmcnt(0)
  v_cmp_gt_u32 vcc, 6, v12
  s_cbranch_vccz KG_PD37
  s_sleep 2
  s_sub_u32 s72, s72, 1
  s_cbranch_scc0 KG_PW37
  s_mov_b32 s72, 0
KG_PD37:
  s_add_u32 m0, s54, 65536
  s_add_u32 s51, s53, 0
  buffer_load_dwordx4 v253, s[32:35], s51 offen lds
  s_add_u32 m0, s54, 66560
  s_add_u32 s51, s53, 8192
  buffer_load_dwordx4 v253, s[32:35], s51 offen lds
  s_add_u32 m0, s54, 67584
  s_add_u32 s51, s53, 16384
  buffer_load_dwordx4 v253, s[32:35], s51 offen lds
  s_add_u32 m0, s54, 68608
  s_add_u32 s51, s53, 24576
  buffer_load_dwordx4 v253, s[32:35], s51 offen lds
  s_add_u32 m0, s54, 69632
  s_add_u32 s51, s53, 32768
  buffer_load_dwordx4 v253, s[32:35], s51 offen lds
  s_add_u32 m0, s54, 70656
  s_add_u32 s51, s53, 40960
  buffer_load_dwordx4 v253, s[32:35], s51 offen lds
  s_add_u32 m0, s54, 71680
  s_add_u32 s51, s53, 49152
  buffer_load_dwordx4 v253, s[32:35], s51 offen lds
  s_add_u32 m0, s54, 72704
  s_add_u32 s51, s53, 57344
  buffer_load_dwordx4 v253, s[32:35], s51 offen lds
  s_add_u32 m0, s54, 73728
  s_add_u32 s51, s53, 65536
  buffer_load_dwordx4 v253, s[32:35], s51 offen lds
  s_add_u32 m0, s54, 74752
  s_add_u32 s51, s53, 73728
  buffer_load_dwordx4 v253, s[32:35], s51 offen lds
  s_add_u32 m0, s54, 75776
  s_add_u32 s51, s53, 81920
  buffer_load_dwordx4 v253, s[32:35], s51 offen lds
  s_add_u32 m0, s54, 76800
  s_add_u32 s51, s53, 90112
  buffer_load_dwordx4 v253, s[32:35], s51 offen lds
  s_add_u32 m0, s54, 77824
  s_add_u32 s51, s53, 98304
  buffer_load_dwordx4 v253, s[32:35], s51 offen lds
  s_add_u32 m0, s54, 78848
  s_add_u32 s51, s53, 106496
  buffer_load_dwordx4 v253, s[32:35], s51 offen lds
  s_add_u32 m0, s54, 79872
  s_add_u32 s51, s53, 114688
  buffer_load_dwordx4 v253, s[32:35], s51 offen lds
  s_add_u32 m0, s54, 80896
  s_add_u32 s51, s53, 122880
  buffer_load_dwordx4 v253, s[32:35], s51 offen lds
  s_mov_b32 s44, s22
  s_mov_b32 s45, s23
  s_mov_b32 s46, 2097152
  s_mov_b32 s47, 0x20000
  s_lshl_b32 s51, s66, 20
  s_lshl_b32 s52, s49, 10
  s_add_u32 s51, s51, s52
  s_lshl_b32 s52, s50, 6
  s_add_u32 s51, s51, s52
  s_lshl_b32 s52, s3, 9
  s_add_u32 s69, s51, s52
  s_waitcnt vmcnt(0)
  s_waitcnt lgkmcnt(0)
  s_mov_b64 exec, 1
  ds_add_u32 v7, v4 offset:148
  s_mov_b64 exec, -1
KG_LW38:
  ds_read_b32 v8, v7 offset:148
  s_waitcnt lgkmcnt(0)
  v_readfirstlane_b32 s51, v8
  s_cmp_ge_u32 s51, 4
  s_cbranch_scc1 KG_LD38
  s_sleep 2
  s_sub_u32 s72, s72, 1
  s_cbranch_scc0 KG_LW38
  s_mov_b32 s72, 0
KG_LD38:
  ds_read_b64_tr_b16 v[64:65], v1 offset:0
  ds_read_b64_tr_b16 v[66:67], v1 offset:1024
  ds_read_b64_tr_b16 v[68:69], v2 offset:0
  ds_read_b64_tr_b16 v[70:71], v2 offset:1024
  ds_read_b64_tr_b16 v[72:73], v1 offset:4096
  ds_read_b64_tr_b16 v[74:75], v1 offset:5120
  ds_read_b64_tr_b16 v[76:77], v2 offset:4096
  ds_read_b64_tr_b16 v[78:79], v2 offset:5120
  ds_read_b64_tr_b16 v[80:81], v1 offset:8192
  ds_read_b64_tr_b16 v[82:83], v1 offset:9216
  ds_read_b64_tr_b16 v[84:85], v2 offset:8192
  ds_read_b64_tr_b16 v[86:87], v2 offset:9216
  ds_read_b64_tr_b16 v[88:89], v1 offset:12288
  ds_read_b64_tr_b16 v[90:91], v1 offset:13312
  ds_read_b64_tr_b16 v[92:93], v2 offset:12288
  ds_read_b64_tr_b16 v[94:95], v2 offset:13312
  ds_read_b64_tr_b16 v[96:97], v1 offset:16384
  ds_read_b64_tr_b16 v[98:99], v1 offset:17408
  ds_read_b64_tr_b16 v[100:101], v2 offset:16384
  ds_read_b64_tr_b16 v[102:103], v2 offset:17408
  ds_read_b64_tr_b16 v[104:105], v1 offset:20480
  ds_read_b64_tr_b16 v[106:107], v1 offset:21504
  ds_read_b64_tr_b16 v[108:109], v2 offset:20480
  ds_read_b64_tr_b16 v[110:111], v2 offset:21504
  ds_read_b64_tr_b16 v[112:113], v1 offset:24576
  ds_read_b64_tr_b16 v[114:115], v1 offset:25600
  ds_read_b64_tr_b16 v[116:117], v2 offset:24576
  ds_read_b64_tr_b16 v[118:119], v2 offset:25600
  ds_read_b64_tr_b16 v[120:121], v1 offset:28672
  ds_read_b64_tr_b16 v[122:123], v1 offset:29696
  ds_read_b64_tr_b16 v[124:125], v2 offset:28672
  ds_read_b64_tr_b16 v[126:127], v2 offset:29696
  ds_read_b64_tr_b16 v[128:129], v1 offset:2048
  ds_read_b64_tr_b16 v[130:131], v1 offset:3072
  ds_read_b64_tr_b16 v[132:133], v2 offset:2048
  ds_read_b64_tr_b16 v[134:135], v2 offset:3072
  ds_read_b64_tr_b16 v[136:137], v1 offset:6144
  ds_read_b64_tr_b16 v[138:139], v1 offset:7168
  ds_read_b64_tr_b16 v[140:141], v2 offset:6144
  ds_read_b64_tr_b16 v[142:143], v2 offset:7168
  ds_read_b64_tr_b16 v[144:145], v1 offset:10240
  ds_read_b64_tr_b16 v[146:147], v1 offset:11264
  ds_read_b64_tr_b16 v[148:149], v2 offset:10240
  ds_read_b64_tr_b16 v[150:151], v2 offset:11264
  ds_read_b64_tr_b16 v[152:153], v1 offset:14336
  ds_read_b64_tr_b16 v[154:155], v1 offset:15360
  ds_read_b64_tr_b16 v[156:157], v2 offset:14336
  ds_read_b64_tr_b16 v[158:159], v2 offset:15360
  ds_read_b64_tr_b16 v[160:161], v1 offset:18432
  ds_read_b64_tr_b16 v[162:163], v1 offset:19456
  ds_read_b64_tr_b16 v[164:165], v2 offset:18432
  ds_read_b64_tr_b16 v[166:167], v2 offset:19456
  ds_read_b64_tr_b16 v[168:169], v1 offset:22528
  ds_read_b64_tr_b16 v[170:171], v1 offset:23552
  ds_read_b64_tr_b16 v[172:173], v2 offset:22528
  ds_read_b64_tr_b16 v[174:175], v2 offset:23552
  ds_read_b64_tr_b16 v[176:177], v1 offset:26624
  ds_read_b64_tr_b16 v[178:179], v1 offset:27648
  ds_read_b64_tr_b16 v[180:181], v2 offset:26624
  ds_read_b64_tr_b16 v[182:183], v2 offset:27648
  ds_read_b64_tr_b16 v[184:185], v1 offset:30720
  ds_read_b64_tr_b16 v[186:187], v1 offset:31744
  ds_read_b64_tr_b16 v[188:189], v2 offset:30720
  ds_read_b64_tr_b16 v[190:191], v2 offset:31744
  v_xor_b32 v6, 0x2000, v249
  s_waitcnt lgkmcnt(0)
  s_mov_b64 exec, 1
  ds_add_u32 v7, v4 offset:168
  s_mov_b64 exec, -1
  v_xor_b32 v1, 0x100, v250
  v_lshrrev_b32 v10, 2, v0
  v_and_b32 v11, 3, v0
  v_lshlrev_b32 v10, 7, v10
  v_lshl_add_u32 v10, v11, 2, v10
  s_lshl_b32 s52, s68, 11
  s_add_u32 s52, s52, 2408448
  buffer_load_dword v12, v10, s[28:31], s52 offen sc1
  s_lshl_b32 s53, s68, 19
  s_lshl_b32 s51, s49, 7
  s_add_u32 s53, s53, s51
  s_add_u32 s53, s53, 7340032
  s_add_u32 s54, s54, 65536
  s_mov_b32 s58, 0xffff
  s_mov_b32 s55, 262144
KG_LW39:
  ds_read_b32 v8, v7 offset:168
  s_waitcnt lgkmcnt(0)
  v_readfirstlane_b32 s51, v8
  s_cmp_ge_u32 s51, 4
  s_cbranch_scc1 KG_LD39
  s_sleep 2
  s_sub_u32 s72, s72, 1
  s_cbranch_scc0 KG_LW39
  s_mov_b32 s72, 0
KG_LD39:
  s_branch KG_YC
KG_YP:
  s_sleep 2
  buffer_load_dword v12, v10, s[28:31], s52 offen sc1
KG_YC:
  s_waitcnt vmcnt(0)
  v_cmp_ne_u32 vcc, s73, v12
  s_sub_u32 s55, s55, 1
  s_cbranch_scc1 KG_YD
  s_quadmask_b64 s[62:63], vcc
  s_andn2_b32 s59, s58, s62
  s_cbranch_scc0 KG_YP
  s_and_b32 s58, s58, s62
KG_YL:
  s_ff1_i32_b32 s51, s59
  s_bitset0_b32 s59, s51
  s_lshl_b32 s64, s51, 10
  s_add_u32 m0, s64, s54
  s_lshl_b32 s51, s51, 15
  s_add_u32 s51, s51, s53
  buffer_load_dwordx4 v248, s[28:31], s51 offen sc1 lds
  s_cmp_lg_u32 s59, 0
  s_cbranch_scc1 KG_YL
  s_cmp_lg_u32 s58, 0
  s_cbranch_scc1 KG_YP
KG_YD:
  s_waitcnt vmcnt(0)
  s_waitcnt lgkmcnt(0)
  s_mov_b64 exec, 1
  ds_add_u32 v7, v4 offset:136
  s_mov_b64 exec, -1
KG_LW40:
  ds_read_b32 v8, v7 offset:136
  s_waitcnt lgkmcnt(0)
  v_readfirstlane_b32 s51, v8
  s_cmp_ge_u32 s51, 4
  s_cbranch_scc1 KG_LD40
  s_sleep 2
  s_sub_u32 s72, s72, 1
  s_cbranch_scc0 KG_LW40
  s_mov_b32 s72, 0
KG_LD40:
  s_lshl_b32 s51, s49, 8
  s_lshl_b32 s52, s66, 7
  s_add_u32 s51, s51, s52
  s_add_u32 s51, s51, 2293760
  buffer_load_dword v248, v252, s[28:31], s51 offen sc1
  s_setprio 0
  ds_read_b64_tr_b16 v[32:33], v250 offset:0
  ds_read_b64_tr_b16 v[34:35], v250 offset:1024
  ds_read_b64_tr_b16 v[36:37], v1 offset:4096
  ds_read_b64_tr_b16 v[38:39], v1 offset:5120
  ds_read_b64_tr_b16 v[40:41], v250 offset:8192
  ds_read_b64_tr_b16 v[42:43], v250 offset:9216
  ds_read_b64_tr_b16 v[44:45], v1 offset:12288
  ds_read_b64_tr_b16 v[46:47], v1 offset:13312
  ds_read_b64_tr_b16 v[48:49], v250 offset:16384
  ds_read_b64_tr_b16 v[50:51], v250 offset:17408
  ds_read_b64_tr_b16 v[52:53], v1 offset:20480
  ds_read_b64_tr_b16 v[54:55], v1 offset:21504
  s_waitcnt lgkmcnt(10)
  v_mfma_f32_32x32x16_bf16 v[16:31], v[192:195], v[32:35], 0
  s_add_u32 s57, s56, 28672
  buffer_load_dwordx4 v[192:195], v3, s[36:39], s57 offen offset:0
  ds_read_b64_tr_b16 v[56:57], v250 offset:24576
  ds_read_b64_tr_b16 v[58:59], v250 offset:25600
  s_waitcnt lgkmcnt(10)
  v_mfma_f32_32x32x16_bf16 v[16:31], v[196:199], v[36:39], v[16:31]
  buffer_load_dwordx4 v[196:199], v3, s[36:39], s57 offen offset:2048
  ds_read_b64_tr_b16 v[60:61], v1 offset:28672
  ds_read_b64_tr_b16 v[62:63], v1 offset:29696
  s_waitcnt lgkmcnt(10)
  v_mfma_f32_32x32x16_bf16 v[16:31], v[200:203], v[40:43], v[16:31]
  ds_read_b64_tr_b16 v[32:33], v250 offset:32768
  ds_read_b64_tr_b16 v[34:35], v250 offset:33792
  s_waitcnt lgkmcnt(10)
  v_mfma_f32_32x32x16_bf16 v[16:31], v[204:207], v[44:47], v[16:31]
  ds_read_b64_tr_b16 v[36:37], v1 offset:36864
  ds_read_b64_tr_b16 v[38:39], v1 offset:37888
  s_waitcnt lgkmcnt(10)
  v_mfma_f32_32x32x16_bf16 v[16:31], v[208:211], v[48:51], v[16:31]
  ds_read_b64_tr_b16 v[40:41], v250 offset:40960
  ds_read_b64_tr_b16 v[42:43], v250 offset:41984
  s_waitcnt lgkmcnt(10)
  v_mfma_f32_32x32x16_bf16 v[16:31], v[212:215], v[52:55], v[16:31]
  ds_read_b64_tr_b16 v[44:45], v1 offset:45056
  ds_read_b64_tr_b16 v[46:47], v1 offset:46080
  s_waitcnt lgkmcnt(10)
  v_mfma_f32_32x32x16_bf16 v[16:31], v[216:219], v[56:59], v[16:31]
  ds_read_b64_tr_b16 v[48:49], v250 offset:49152
  ds_read_b64_tr_b16 v[50:51], v250 offset:50176
  s_waitcnt lgkmcnt(10)
  v_mfma_f32_32x32x16_bf16 v[16:31], v[220:223], v[60:63], v[16:31]
  ds_read_b64_tr_b16 v[52:53], v1 offset:53248
  ds_read_b64_tr_b16 v[54:55], v1 offset:54272
  s_waitcnt lgkmcnt(10)
  v_mfma_f32_32x32x16_bf16 v[16:31], v[224:227], v[32:35], v[16:31]
  ds_read_b64_tr_b16 v[56:57], v250 offset:57344
  ds_read_b64_tr_b16 v[58:59], v250 offset:58368
  s_waitcnt lgkmcnt(10)
  v_mfma_f32_32x32x16_bf16 v[16:31], v[228:231], v[36:39], v[16:31]
  ds_read_b64_tr_b16 v[60:61], v1 offset:61440
  ds_read_b64_tr_b16 v[62:63], v1 offset:62464
  s_waitcnt lgkmcnt(10)
  v_mfma_f32_32x32x16_bf16 v[16:31], v[232:235], v[40:43], v[16:31]
  s_waitcnt lgkmcnt(8)
  v_mfma_f32_32x32x16_bf16 v[16:31], v[236:239], v[44:47], v[16:31]
  s_waitcnt lgkmcnt(6)
  v_mfma_f32_32x32x16_bf16 v[16:31], v[240:243], v[48:51], v[16:31]
  s_waitcnt lgkmcnt(4)
  v_mfma_f32_32x32x16_bf16 v[16:31], v[244:247], v[52:55], v[16:31]
  s_waitcnt vmcnt(1) lgkmcnt(2)
  v_mfma_f32_32x32x16_bf16 v[16:31], v[192:195], v[56:59], v[16:31]
  s_waitcnt vmcnt(0) lgkmcnt(0)
  v_mfma_f32_32x32x16_bf16 v[16:31], v[196:199], v[60:63], v[16:31]
  s_setprio 2
  s_lshl_b32 s53, s49, 1
  s_add_u32 s53, s53, s66
  s_lshl_b32 s53, s53, 1
  s_add_u32 s53, s53, s3
  s_lshl_b32 s53, s53, 14
  s_add_u32 s24, s53, 5242880
  s_add_u32 s25, s53, 5246976
  s_add_u32 s26, s53, 5251072
  s_add_u32 s27, s53, 5255168
  v_sub_f32 v9, 1.0, v248
  s_lshl_b32 s51, s3, 31
  v_xor_b32 v11, s51, v9
  s_mov_b32 s34, 0
  ds_write_b128 v249, v[16:19] offset:0
  ds_write_b128 v249, v[20:23] offset:1024
  ds_write_b128 v249, v[24:27] offset:2048
  ds_write_b128 v249, v[28:31] offset:3072
  ds_write_b32 v254, v4 offset:64
  buffer_load_dwordx4 v[32:35], v3, s[32:35], 0 offen
  buffer_load_dwordx4 v[36:39], v3, s[32:35], 0 offen
  buffer_load_dwordx4 v[40:43], v3, s[32:35], 0 offen
  buffer_load_dwordx4 v[44:47], v3, s[32:35], 0 offen
  buffer_load_dwordx4 v[48:51], v3, s[32:35], 0 offen
  buffer_load_dwordx4 v[52:55], v3, s[32:35], 0 offen
  buffer_load_dwordx4 v[56:59], v3, s[32:35], 0 offen
  buffer_load_dwordx4 v[60:63], v3, s[32:35], 0 offen
  v_pk_mul_f32 v[16:17], v[16:17], v[10:11] op_sel:[0,1] op_sel_hi:[1,1]
  v_pk_mul_f32 v[18:19], v[18:19], v[10:11] op_sel:[0,1] op_sel_hi:[1,1]
  v_pk_mul_f32 v[20:21], v[20:21], v[10:11] op_sel:[0,1] op_sel_hi:[1,1]
  v_pk_mul_f32 v[22:23], v[22:23], v[10:11] op_sel:[0,1] op_sel_hi:[1,1]
  v_pk_mul_f32 v[24:25], v[24:25], v[10:11] op_sel:[0,1] op_sel_hi:[1,1]
  v_pk_mul_f32 v[26:27], v[26:27], v[10:11] op_sel:[0,1] op_sel_hi:[1,1]
  v_pk_mul_f32 v[28:29], v[28:29], v[10:11] op_sel:[0,1] op_sel_hi:[1,1]
  v_pk_mul_f32 v[30:31], v[30:31], v[10:11] op_sel:[0,1] op_sel_hi:[1,1]
KG_LW41:
  ds_read_b32 v8, v255 offset:64
  s_waitcnt lgkmcnt(0)
  v_readfirstlane_b32 s51, v8
  s_cmp_ge_u32 s51, 1
  s_cbranch_scc1 KG_LD41
  s_sleep 1
  s_sub_u32 s72, s72, 1
  s_cbranch_scc0 KG_LW41
  s_mov_b32 s72, 0
KG_LD41:
  ds_read_b128 v[192:195], v6 offset:0
  ds_read_b128 v[196:199], v6 offset:1024
  ds_read_b128 v[200:203], v6 offset:2048
  ds_read_b128 v[204:207], v6 offset:3072
  v_mov_b32 v10, 2
  s_waitcnt lgkmcnt(3)
  v_pk_fma_f32 v[16:17], v[192:193], v[8:9], v[16:17] op_sel:[0,1,0] op_sel_hi:[1,1,1]
  v_pk_fma_f32 v[18:19], v[194:195], v[8:9], v[18:19] op_sel:[0,1,0] op_sel_hi:[1,1,1]
  s_waitcnt lgkmcnt(2)
  v_pk_fma_f32 v[20:21], v[196:197], v[8:9], v[20:21] op_sel:[0,1,0] op_sel_hi:[1,1,1]
  v_pk_fma_f32 v[22:23], v[198:199], v[8:9], v[22:23] op_sel:[0,1,0] op_sel_hi:[1,1,1]
  s_waitcnt lgkmcnt(1)
  v_pk_fma_f32 v[24:25], v[200:201], v[8:9], v[24:25] op_sel:[0,1,0] op_sel_hi:[1,1,1]
  v_pk_fma_f32 v[26:27], v[202:203], v[8:9], v[26:27] op_sel:[0,1,0] op_sel_hi:[1,1,1]
  s_waitcnt lgkmcnt(0)
  v_pk_fma_f32 v[28:29], v[204:205], v[8:9], v[28:29] op_sel:[0,1,0] op_sel_hi:[1,1,1]
  v_pk_fma_f32 v[30:31], v[206:207], v[8:9], v[30:31] op_sel:[0,1,0] op_sel_hi:[1,1,1]
  ds_write_b32 v254, v10 offset:64
  s_mov_b32 s59, 262144
  s_movk_i32 s58, 0xff
  s_mov_b32 s55, s59
KG_LW42:
  ds_read_b32 v8, v255 offset:64
  s_waitcnt lgkmcnt(0)
  v_readfirstlane_b32 s51, v8
  s_cmp_ge_u32 s51, 2
  s_cbranch_scc1 KG_LD42
  s_sleep 1
  s_sub_u32 s72, s72, 1
  s_cbranch_scc0 KG_LW42
  s_mov_b32 s72, 0
KG_LD42:
KG_LW43:
  ds_read_b32 v8, v7 offset:144
  s_waitcnt lgkmcnt(0)
  v_readfirstlane_b32 s51, v8
  s_cmp_ge_u32 s51, 1
  s_cbranch_scc1 KG_LD43
  s_sleep 4
  s_sub_u32 s72, s72, 1
  s_cbranch_scc0 KG_LW43
  s_mov_b32 s72, 0
KG_LD43:
  buffer_load_dwordx4 v[192:195], v3, s[28:31], s24 offen offset:0 sc1
  buffer_load_dwordx4 v[196:199], v3, s[28:31], s24 offen offset:2048 sc1
  buffer_load_dwordx4 v[200:203], v3, s[28:31], s25 offen offset:0 sc1
  buffer_load_dwordx4 v[204:207], v3, s[28:31], s25 offen offset:2048 sc1
  buffer_load_dwordx4 v[208:211], v3, s[28:31], s26 offen offset:0 sc1
  buffer_load_dwordx4 v[212:215], v3, s[28:31], s26 offen offset:2048 sc1
  buffer_load_dwordx4 v[216:219], v3, s[28:31], s27 offen offset:0 sc1
  buffer_load_dwordx4 v[220:223], v3, s[28:31], s27 offen offset:2048 sc1
  s_waitcnt vmcnt(7)
  v_cmp_eq_u32 vcc, -1, v195
  s_cbranch_vccnz KG_OC00_0
  s_setprio 0
  v_mfma_f32_32x32x16_bf16 v[48:63], v[68:71], v[192:195], v[48:63]
  v_mfma_f32_32x32x16_bf16 v[32:47], v[64:67], v[192:195], v[32:47]
  s_setprio 2
  s_bitset0_b32 s58, 0
KG_OC00_0:
  s_waitcnt vmcnt(6)
  v_cmp_eq_u32 vcc, -1, v199
  s_cbranch_vccnz KG_OC00_1
  s_setprio 0
  v_mfma_f32_32x32x16_bf16 v[48:63], v[76:79], v[196:199], v[48:63]
  v_mfma_f32_32x32x16_bf16 v[32:47], v[72:75], v[196:199], v[32:47]
  s_setprio 2
  s_bitset0_b32 s58, 1
KG_OC00_1:
  s_waitcnt vmcnt(5)
  v_cmp_eq_u32 vcc, -1, v203
  s_cbranch_vccnz KG_OC00_2
  s_setprio 0
  v_mfma_f32_32x32x16_bf16 v[48:63], v[84:87], v[200:203], v[48:63]
  v_mfma_f32_32x32x16_bf16 v[32:47], v[80:83], v[200:203], v[32:47]
  s_setprio 2
  s_bitset0_b32 s58, 2
KG_OC00_2:
  s_waitcnt vmcnt(4)
  v_cmp_eq_u32 vcc, -1, v207
  s_cbranch_vccnz KG_OC00_3
  s_setprio 0
  v_mfma_f32_32x32x16_bf16 v[48:63], v[92:95], v[204:207], v[48:63]
  v_mfma_f32_32x32x16_bf16 v[32:47], v[88:91], v[204:207], v[32:47]
  s_setprio 2
  s_bitset0_b32 s58, 3
KG_OC00_3:
  s_waitcnt vmcnt(3)
  v_cmp_eq_u32 vcc, -1, v211
  s_cbranch_vccnz KG_OC00_4
  s_setprio 0
  v_mfma_f32_32x32x16_bf16 v[48:63], v[100:103], v[208:211], v[48:63]
  v_mfma_f32_32x32x16_bf16 v[32:47], v[96:99], v[208:211], v[32:47]
  s_setprio 2
  s_bitset0_b32 s58, 4
KG_OC00_4:
  s_waitcnt vmcnt(2)
  v_cmp_eq_u32 vcc, -1, v215
  s_cbranch_vccnz KG_OC00_5
  s_setprio 0
  v_mfma_f32_32x32x16_bf16 v[48:63], v[108:111], v[212:215], v[48:63]
  v_mfma_f32_32x32x16_bf16 v[32:47], v[104:107], v[212:215], v[32:47]
  s_setprio 2
  s_bitset0_b32 s58, 5
KG_OC00_5:
  s_waitcnt vmcnt(1)
  v_cmp_eq_u32 vcc, -1, v219
  s_cbranch_vccnz KG_OC00_6
  s_setprio 0
  v_mfma_f32_32x32x16_bf16 v[48:63], v[116:119], v[216:219], v[48:63]
  v_mfma_f32_32x32x16_bf16 v[32:47], v[112:115], v[216:219], v[32:47]
  s_setprio 2
  s_bitset0_b32 s58, 6
KG_OC00_6:
  s_waitcnt vmcnt(0)
  v_cmp_eq_u32 vcc, -1, v223
  s_cbranch_vccnz KG_OC00_7
  s_setprio 0
  v_mfma_f32_32x32x16_bf16 v[48:63], v[124:127], v[220:223], v[48:63]
  v_mfma_f32_32x32x16_bf16 v[32:47], v[120:123], v[220:223], v[32:47]
  s_setprio 2
  s_bitset0_b32 s58, 7
KG_OC00_7:
KG_OR0:
  s_cmp_eq_u32 s58, 0
  s_cbranch_scc1 KG_OD0
  s_sub_u32 s55, s55, 1
  s_cbranch_scc1 KG_OD0
  s_and_b32 s51, s58, 0xf
  s_cbranch_scc0 KG_OGL0_0
  s_bitcmp1_b32 s58, 0
  s_cbranch_scc0 KG_OPL0_0
  buffer_load_dwordx4 v[192:195], v3, s[28:31], s24 offen offset:0 sc1
KG_OPL0_0:
  s_bitcmp1_b32 s58, 1
  s_cbranch_scc0 KG_OPL0_1
  buffer_load_dwordx4 v[196:199], v3, s[28:31], s24 offen offset:2048 sc1
KG_OPL0_1:
  s_bitcmp1_b32 s58, 2
  s_cbranch_scc0 KG_OPL0_2
  buffer_load_dwordx4 v[200:203], v3, s[28:31], s25 offen offset:0 sc1
KG_OPL0_2:
  s_bitcmp1_b32 s58, 3
  s_cbranch_scc0 KG_OPL0_3
  buffer_load_dwordx4 v[204:207], v3, s[28:31], s25 offen offset:2048 sc1
KG_OPL0_3:
KG_OGL0_0:
  s_and_b32 s51, s58, 0xf0
  s_cbranch_scc0 KG_OGL0_1
  s_bitcmp1_b32 s58, 4
  s_cbranch_scc0 KG_OPL0_4
  buffer_load_dwordx4 v[208:211], v3, s[28:31], s26 offen offset:0 sc1
KG_OPL0_4:
  s_bitcmp1_b32 s58, 5
  s_cbranch_scc0 KG_OPL0_5
  buffer_load_dwordx4 v[212:215], v3, s[28:31], s26 offen offset:2048 sc1
KG_OPL0_5:
  s_bitcmp1_b32 s58, 6
  s_cbranch_scc0 KG_OPL0_6
  buffer_load_dwordx4 v[216:219], v3, s[28:31], s27 offen offset:0 sc1
KG_OPL0_6:
  s_bitcmp1_b32 s58, 7
  s_cbranch_scc0 KG_OPL0_7
  buffer_load_dwordx4 v[220:223], v3, s[28:31], s27 offen offset:2048 sc1
KG_OPL0_7:
KG_OGL0_1:
  s_waitcnt vmcnt(0)
  s_and_b32 s51, s58, 0xf
  s_cbranch_scc0 KG_OGC0_0
  s_bitcmp1_b32 s58, 0
  s_cbranch_scc0 KG_OPC0_0
  v_cmp_eq_u32 vcc, -1, v195
  s_cbranch_vccnz KG_OC01_0
  s_setprio 0
  v_mfma_f32_32x32x16_bf16 v[48:63], v[68:71], v[192:195], v[48:63]
  v_mfma_f32_32x32x16_bf16 v[32:47], v[64:67], v[192:195], v[32:47]
  s_setprio 2
  s_and_b32 s58, s58, 0xfe
  s_cbranch_scc0 KG_OD0
KG_OC01_0:
KG_OPC0_0:
  s_bitcmp1_b32 s58, 1
  s_cbranch_scc0 KG_OPC0_1
  v_cmp_eq_u32 vcc, -1, v199
  s_cbranch_vccnz KG_OC01_1
  s_setprio 0
  v_mfma_f32_32x32x16_bf16 v[48:63], v[76:79], v[196:199], v[48:63]
  v_mfma_f32_32x32x16_bf16 v[32:47], v[72:75], v[196:199], v[32:47]
  s_setprio 2
  s_and_b32 s58, s58, 0xfd
  s_cbranch_scc0 KG_OD0
KG_OC01_1:
KG_OPC0_1:
  s_bitcmp1_b32 s58, 2
  s_cbranch_scc0 KG_OPC0_2
  v_cmp_eq_u32 vcc, -1, v203
  s_cbranch_vccnz KG_OC01_2
  s_setprio 0
  v_mfma_f32_32x32x16_bf16 v[48:63], v[84:87], v[200:203], v[48:63]
  v_mfma_f32_32x32x16_bf16 v[32:47], v[80:83], v[200:203], v[32:47]
  s_setprio 2
  s_and_b32 s58, s58, 0xfb
  s_cbranch_scc0 KG_OD0
KG_OC01_2:
KG_OPC0_2:
  s_bitcmp1_b32 s58, 3
  s_cbranch_scc0 KG_OPC0_3
  v_cmp_eq_u32 vcc, -1, v207
  s_cbranch_vccnz KG_OC01_3
  s_setprio 0
  v_mfma_f32_32x32x16_bf16 v[48:63], v[92:95], v[204:207], v[48:63]
  v_mfma_f32_32x32x16_bf16 v[32:47], v[88:91], v[204:207], v[32:47]
  s_setprio 2
  s_and_b32 s58, s58, 0xf7
  s_cbranch_scc0 KG_OD0
KG_OC01_3:
KG_OPC0_3:
KG_OGC0_0:
  s_and_b32 s51, s58, 0xf0
  s_cbranch_scc0 KG_OGC0_1
  s_bitcmp1_b32 s58, 4
  s_cbranch_scc0 KG_OPC0_4
  v_cmp_eq_u32 vcc, -1, v211
  s_cbranch_vccnz KG_OC01_4
  s_setprio 0
  v_mfma_f32_32x32x16_bf16 v[48:63], v[100:103], v[208:211], v[48:63]
  v_mfma_f32_32x32x16_bf16 v[32:47], v[96:99], v[208:211], v[32:47]
  s_setprio 2
  s_and_b32 s58, s58, 0xef
  s_cbranch_scc0 KG_OD0
KG_OC01_4:
KG_OPC0_4:
  s_bitcmp1_b32 s58, 5
  s_cbranch_scc0 KG_OPC0_5
  v_cmp_eq_u32 vcc, -1, v215
  s_cbranch_vccnz KG_OC01_5
  s_setprio 0
  v_mfma_f32_32x32x16_bf16 v[48:63], v[108:111], v[212:215], v[48:63]
  v_mfma_f32_32x32x16_bf16 v[32:47], v[104:107], v[212:215], v[32:47]
  s_setprio 2
  s_and_b32 s58, s58, 0xdf
  s_cbranch_scc0 KG_OD0
KG_OC01_5:
KG_OPC0_5:
  s_bitcmp1_b32 s58, 6
  s_cbranch_scc0 KG_OPC0_6
  v_cmp_eq_u32 vcc, -1, v219
  s_cbranch_vccnz KG_OC01_6
  s_setprio 0
  v_mfma_f32_32x32x16_bf16 v[48:63], v[116:119], v[216:219], v[48:63]
  v_mfma_f32_32x32x16_bf16 v[32:47], v[112:115], v[216:219], v[32:47]
  s_setprio 2
  s_and_b32 s58, s58, 0xbf
  s_cbranch_scc0 KG_OD0
KG_OC01_6:
KG_OPC0_6:
  s_bitcmp1_b32 s58, 7
  s_cbranch_scc0 KG_OPC0_7
  v_cmp_eq_u32 vcc, -1, v223
  s_cbranch_vccnz KG_OC01_7
  s_setprio 0
  v_mfma_f32_32x32x16_bf16 v[48:63], v[124:127], v[220:223], v[48:63]
  v_mfma_f32_32x32x16_bf16 v[32:47], v[120:123], v[220:223], v[32:47]
  s_setprio 2
  s_and_b32 s58, s58, 0x7f
  s_cbranch_scc0 KG_OD0
KG_OC01_7:
KG_OPC0_7:
KG_OGC0_1:
  s_branch KG_OR0
KG_OD0:
  s_movk_i32 s58, 0xff
  s_mov_b32 s55, s59
KG_LW44:
  ds_read_b32 v8, v254 offset:32
  s_waitcnt lgkmcnt(0)
  v_readfirstlane_b32 s51, v8
  s_cmp_ge_u32 s51, 10
  s_cbranch_scc1 KG_LD44
  s_sleep 1
  s_sub_u32 s72, s72, 1
  s_cbranch_scc0 KG_LW44
  s_mov_b32 s72, 0
KG_LD44:
  buffer_load_dwordx4 v[192:195], v3, s[28:31], s24 offen offset:1024 sc1
  buffer_load_dwordx4 v[196:199], v3, s[28:31], s24 offen offset:3072 sc1
  buffer_load_dwordx4 v[200:203], v3, s[28:31], s25 offen offset:1024 sc1
  buffer_load_dwordx4 v[204:207], v3, s[28:31], s25 offen offset:3072 sc1
  buffer_load_dwordx4 v[208:211], v3, s[28:31], s26 offen offset:1024 sc1
  buffer_load_dwordx4 v[212:215], v3, s[28:31], s26 offen offset:3072 sc1
  buffer_load_dwordx4 v[216:219], v3, s[28:31], s27 offen offset:1024 sc1
  buffer_load_dwordx4 v[220:223], v3, s[28:31], s27 offen offset:3072 sc1
  s_waitcnt vmcnt(7)
  v_cmp_eq_u32 vcc, -1, v195
  s_cbranch_vccnz KG_OC10_0
  v_mfma_f32_32x32x16_bf16 v[48:63], v[132:135], v[192:195], v[48:63]
  v_mfma_f32_32x32x16_bf16 v[32:47], v[128:131], v[192:195], v[32:47]
  s_bitset0_b32 s58, 0
KG_OC10_0:
  s_waitcnt vmcnt(6)
  v_cmp_eq_u32 vcc, -1, v199
  s_cbranch_vccnz KG_OC10_1
  v_mfma_f32_32x32x16_bf16 v[48:63], v[140:143], v[196:199], v[48:63]
  v_mfma_f32_32x32x16_bf16 v[32:47], v[136:139], v[196:199], v[32:47]
  s_bitset0_b32 s58, 1
KG_OC10_1:
  s_waitcnt vmcnt(5)
  v_cmp_eq_u32 vcc, -1, v203
  s_cbranch_vccnz KG_OC10_2
  v_mfma_f32_32x32x16_bf16 v[48:63], v[148:151], v[200:203], v[48:63]
  v_mfma_f32_32x32x16_bf16 v[32:47], v[144:147], v[200:203], v[32:47]
  s_bitset0_b32 s58, 2
KG_OC10_2:
  s_waitcnt vmcnt(4)
  v_cmp_eq_u32 vcc, -1, v207
  s_cbranch_vccnz KG_OC10_3
  v_mfma_f32_32x32x16_bf16 v[48:63], v[156:159], v[204:207], v[48:63]
  v_mfma_f32_32x32x16_bf16 v[32:47], v[152:155], v[204:207], v[32:47]
  s_bitset0_b32 s58, 3
KG_OC10_3:
  s_waitcnt vmcnt(3)
  v_cmp_eq_u32 vcc, -1, v211
  s_cbranch_vccnz KG_OC10_4
  v_mfma_f32_32x32x16_bf16 v[48:63], v[164:167], v[208:211], v[48:63]
  v_mfma_f32_32x32x16_bf16 v[32:47], v[160:163], v[208:211], v[32:47]
  s_bitset0_b32 s58, 4
KG_OC10_4:
  s_waitcnt vmcnt(2)
  v_cmp_eq_u32 vcc, -1, v215
  s_cbranch_vccnz KG_OC10_5
  v_mfma_f32_32x32x16_bf16 v[48:63], v[172:175], v[212:215], v[48:63]
  v_mfma_f32_32x32x16_bf16 v[32:47], v[168:171], v[212:215], v[32:47]
  s_bitset0_b32 s58, 5
KG_OC10_5:
  s_waitcnt vmcnt(1)
  v_cmp_eq_u32 vcc, -1, v219
  s_cbranch_vccnz KG_OC10_6
  v_mfma_f32_32x32x16_bf16 v[48:63], v[180:183], v[216:219], v[48:63]
  v_mfma_f32_32x32x16_bf16 v[32:47], v[176:179], v[216:219], v[32:47]
  s_bitset0_b32 s58, 6
KG_OC10_6:
  s_waitcnt vmcnt(0)
  v_cmp_eq_u32 vcc, -1, v223
  s_cbranch_vccnz KG_OC10_7
  v_mfma_f32_32x32x16_bf16 v[48:63], v[188:191], v[220:223], v[48:63]
  v_mfma_f32_32x32x16_bf16 v[32:47], v[184:187], v[220:223], v[32:47]
  s_bitset0_b32 s58, 7
KG_OC10_7:
KG_OR1:
  s_cmp_eq_u32 s58, 0
  s_cbranch_scc1 KG_OD1
  s_sub_u32 s55, s55, 1
  s_cbranch_scc1 KG_OD1
  s_and_b32 s51, s58, 0xf
  s_cbranch_scc0 KG_OGL1_0
  s_bitcmp1_b32 s58, 0
  s_cbranch_scc0 KG_OPL1_0
  buffer_load_dwordx4 v[192:195], v3, s[28:31], s24 offen offset:1024 sc1
KG_OPL1_0:
  s_bitcmp1_b32 s58, 1
  s_cbranch_scc0 KG_OPL1_1
  buffer_load_dwordx4 v[196:199], v3, s[28:31], s24 offen offset:3072 sc1
KG_OPL1_1:
  s_bitcmp1_b32 s58, 2
  s_cbranch_scc0 KG_OPL1_2
  buffer_load_dwordx4 v[200:203], v3, s[28:31], s25 offen offset:1024 sc1
KG_OPL1_2:
  s_bitcmp1_b32 s58, 3
  s_cbranch_scc0 KG_OPL1_3
  buffer_load_dwordx4 v[204:207], v3, s[28:31], s25 offen offset:3072 sc1
KG_OPL1_3:
KG_OGL1_0:
  s_and_b32 s51, s58, 0xf0
  s_cbranch_scc0 KG_OGL1_1
  s_bitcmp1_b32 s58, 4
  s_cbranch_scc0 KG_OPL1_4
  buffer_load_dwordx4 v[208:211], v3, s[28:31], s26 offen offset:1024 sc1
KG_OPL1_4:
  s_bitcmp1_b32 s58, 5
  s_cbranch_scc0 KG_OPL1_5
  buffer_load_dwordx4 v[212:215], v3, s[28:31], s26 offen offset:3072 sc1
KG_OPL1_5:
  s_bitcmp1_b32 s58, 6
  s_cbranch_scc0 KG_OPL1_6
  buffer_load_dwordx4 v[216:219], v3, s[28:31], s27 offen offset:1024 sc1
KG_OPL1_6:
  s_bitcmp1_b32 s58, 7
  s_cbranch_scc0 KG_OPL1_7
  buffer_load_dwordx4 v[220:223], v3, s[28:31], s27 offen offset:3072 sc1
KG_OPL1_7:
KG_OGL1_1:
  s_waitcnt vmcnt(0)
  s_and_b32 s51, s58, 0xf
  s_cbranch_scc0 KG_OGC1_0
  s_bitcmp1_b32 s58, 0
  s_cbranch_scc0 KG_OPC1_0
  v_cmp_eq_u32 vcc, -1, v195
  s_cbranch_vccnz KG_OC11_0
  v_mfma_f32_32x32x16_bf16 v[48:63], v[132:135], v[192:195], v[48:63]
  v_mfma_f32_32x32x16_bf16 v[32:47], v[128:131], v[192:195], v[32:47]
  s_and_b32 s58, s58, 0xfe
  s_cbranch_scc0 KG_OD1
KG_OC11_0:
KG_OPC1_0:
  s_bitcmp1_b32 s58, 1
  s_cbranch_scc0 KG_OPC1_1
  v_cmp_eq_u32 vcc, -1, v199
  s_cbranch_vccnz KG_OC11_1
  v_mfma_f32_32x32x16_bf16 v[48:63], v[140:143], v[196:199], v[48:63]
  v_mfma_f32_32x32x16_bf16 v[32:47], v[136:139], v[196:199], v[32:47]
  s_and_b32 s58, s58, 0xfd
  s_cbranch_scc0 KG_OD1
KG_OC11_1:
KG_OPC1_1:
  s_bitcmp1_b32 s58, 2
  s_cbranch_scc0 KG_OPC1_2
  v_cmp_eq_u32 vcc, -1, v203
  s_cbranch_vccnz KG_OC11_2
  v_mfma_f32_32x32x16_bf16 v[48:63], v[148:151], v[200:203], v[48:63]
  v_mfma_f32_32x32x16_bf16 v[32:47], v[144:147], v[200:203], v[32:47]
  s_and_b32 s58, s58, 0xfb
  s_cbranch_scc0 KG_OD1
KG_OC11_2:
KG_OPC1_2:
  s_bitcmp1_b32 s58, 3
  s_cbranch_scc0 KG_OPC1_3
  v_cmp_eq_u32 vcc, -1, v207
  s_cbranch_vccnz KG_OC11_3
  v_mfma_f32_32x32x16_bf16 v[48:63], v[156:159], v[204:207], v[48:63]
  v_mfma_f32_32x32x16_bf16 v[32:47], v[152:155], v[204:207], v[32:47]
  s_and_b32 s58, s58, 0xf7
  s_cbranch_scc0 KG_OD1
KG_OC11_3:
KG_OPC1_3:
KG_OGC1_0:
  s_and_b32 s51, s58, 0xf0
  s_cbranch_scc0 KG_OGC1_1
  s_bitcmp1_b32 s58, 4
  s_cbranch_scc0 KG_OPC1_4
  v_cmp_eq_u32 vcc, -1, v211
  s_cbranch_vccnz KG_OC11_4
  v_mfma_f32_32x32x16_bf16 v[48:63], v[164:167], v[208:211], v[48:63]
  v_mfma_f32_32x32x16_bf16 v[32:47], v[160:163], v[208:211], v[32:47]
  s_and_b32 s58, s58, 0xef
  s_cbranch_scc0 KG_OD1
KG_OC11_4:
KG_OPC1_4:
  s_bitcmp1_b32 s58, 5
  s_cbranch_scc0 KG_OPC1_5
  v_cmp_eq_u32 vcc, -1, v215
  s_cbranch_vccnz KG_OC11_5
  v_mfma_f32_32x32x16_bf16 v[48:63], v[172:175], v[212:215], v[48:63]
  v_mfma_f32_32x32x16_bf16 v[32:47], v[168:171], v[212:215], v[32:47]
  s_and_b32 s58, s58, 0xdf
  s_cbranch_scc0 KG_OD1
KG_OC11_5:
KG_OPC1_5:
  s_bitcmp1_b32 s58, 6
  s_cbranch_scc0 KG_OPC1_6
  v_cmp_eq_u32 vcc, -1, v219
  s_cbranch_vccnz KG_OC11_6
  v_mfma_f32_32x32x16_bf16 v[48:63], v[180:183], v[216:219], v[48:63]
  v_mfma_f32_32x32x16_bf16 v[32:47], v[176:179], v[216:219], v[32:47]
  s_and_b32 s58, s58, 0xbf
  s_cbranch_scc0 KG_OD1
KG_OC11_6:
KG_OPC1_6:
  s_bitcmp1_b32 s58, 7
  s_cbranch_scc0 KG_OPC1_7
  v_cmp_eq_u32 vcc, -1, v223
  s_cbranch_vccnz KG_OC11_7
  v_mfma_f32_32x32x16_bf16 v[48:63], v[188:191], v[220:223], v[48:63]
  v_mfma_f32_32x32x16_bf16 v[32:47], v[184:187], v[220:223], v[32:47]
  s_and_b32 s58, s58, 0x7f
  s_cbranch_scc0 KG_OD1
KG_OC11_7:
KG_OPC1_7:
KG_OGC1_1:
  s_branch KG_OR1
KG_OD1:
  v_mov_b32 v9, 3
  s_nop 8
  ds_write_b128 v249, v[48:51] offset:0
  ds_write_b128 v249, v[52:55] offset:1024
  ds_write_b128 v249, v[56:59] offset:2048
  ds_write_b128 v249, v[60:63] offset:3072
  ds_write_b32 v254, v9 offset:64
  ds_read_b32 v8, v255 offset:64
  ds_read_b128 v[192:195], v6 offset:0
  ds_read_b128 v[196:199], v6 offset:1024
  ds_read_b128 v[200:203], v6 offset:2048
  ds_read_b128 v[204:207], v6 offset:3072
  v_pk_fma_f32 v[16:17], v[32:33], v[248:249], v[16:17] op_sel_hi:[1,0,1]
  v_pk_fma_f32 v[18:19], v[34:35], v[248:249], v[18:19] op_sel_hi:[1,0,1]
  v_pk_fma_f32 v[20:21], v[36:37], v[248:249], v[20:21] op_sel_hi:[1,0,1]
  v_pk_fma_f32 v[22:23], v[38:39], v[248:249], v[22:23] op_sel_hi:[1,0,1]
  v_pk_fma_f32 v[24:25], v[40:41], v[248:249], v[24:25] op_sel_hi:[1,0,1]
  v_pk_fma_f32 v[26:27], v[42:43], v[248:249], v[26:27] op_sel_hi:[1,0,1]
  v_pk_fma_f32 v[28:29], v[44:45], v[248:249], v[28:29] op_sel_hi:[1,0,1]
  v_pk_fma_f32 v[30:31], v[46:47], v[248:249], v[30:31] op_sel_hi:[1,0,1]
KG_EXL:
  s_waitcnt lgkmcnt(4)
  v_readfirstlane_b32 s51, v8
  s_cmp_eq_u32 s51, 3
  s_cbranch_scc1 KG_EXD
  ds_read_b32 v8, v255 offset:64
  ds_read_b128 v[192:195], v6 offset:0
  ds_read_b128 v[196:199], v6 offset:1024
  ds_read_b128 v[200:203], v6 offset:2048
  ds_read_b128 v[204:207], v6 offset:3072
  s_sub_u32 s72, s72, 1
  s_cbranch_scc0 KG_EXL
KG_EXD:
  s_waitcnt lgkmcnt(3)
  v_pk_fma_f32 v[32:33], v[192:193], v[248:249], v[16:17] op_sel_hi:[1,0,1]
  v_pk_fma_f32 v[34:35], v[194:195], v[248:249], v[18:19] op_sel_hi:[1,0,1]
  s_waitcnt lgkmcnt(2)
  v_pk_fma_f32 v[36:37], v[196:197], v[248:249], v[20:21] op_sel_hi:[1,0,1]
  v_pk_fma_f32 v[38:39], v[198:199], v[248:249], v[22:23] op_sel_hi:[1,0,1]
  s_waitcnt lgkmcnt(1)
  v_pk_fma_f32 v[40:41], v[200:201], v[248:249], v[24:25] op_sel_hi:[1,0,1]
  v_pk_fma_f32 v[42:43], v[202:203], v[248:249], v[26:27] op_sel_hi:[1,0,1]
  s_waitcnt lgkmcnt(0)
  v_pk_fma_f32 v[44:45], v[204:205], v[248:249], v[28:29] op_sel_hi:[1,0,1]
  v_pk_fma_f32 v[46:47], v[206:207], v[248:249], v[30:31] op_sel_hi:[1,0,1]
  v_cvt_pk_bf16_f32 v32, v32, v33
  v_cvt_pk_bf16_f32 v33, v34, v35
  v_cvt_pk_bf16_f32 v34, v36, v37
  v_cvt_pk_bf16_f32 v35, v38, v39
  v_cvt_pk_bf16_f32 v36, v40, v41
  v_cvt_pk_bf16_f32 v37, v42, v43
  v_cvt_pk_bf16_f32 v38, v44, v45
  v_cvt_pk_bf16_f32 v39, v46, v47
  buffer_store_dwordx4 v[32:35], v251, s[44:47], s69 offen offset:0 nt
  buffer_store_dwordx4 v[36:39], v251, s[44:47], s69 offen offset:16 nt
  s_endpgm
KG_SPA:
  s_mov_b32 s52, 49152
  v_sub_u32 v12, 2048, v6
  v_and_b32 v12, 2047, v12
  v_lshl_add_u32 v120, v12, 3, s52
  v_sub_u32 v13, 1984, v6
  v_and_b32 v13, 2047, v13
  v_lshl_add_u32 v121, v13, 3, s52
  v_sub_u32 v12, 1920, v6
  v_and_b32 v12, 2047, v12
  v_lshl_add_u32 v122, v12, 3, s52
  v_sub_u32 v13, 1856, v6
  v_and_b32 v13, 2047, v13
  v_lshl_add_u32 v123, v13, 3, s52
  v_sub_u32 v12, 1024, v6
  v_and_b32 v12, 2047, v12
  v_lshl_add_u32 v124, v12, 3, s52
  v_sub_u32 v13, 960, v6
  v_and_b32 v13, 2047, v13
  v_lshl_add_u32 v125, v13, 3, s52
  v_sub_u32 v12, 896, v6
  v_and_b32 v12, 2047, v12
  v_lshl_add_u32 v126, v12, 3, s52
  v_sub_u32 v13, 832, v6
  v_and_b32 v13, 2047, v13
  v_lshl_add_u32 v127, v13, 3, s52
  s_branch KG_SPAR
KG_SPB:
  s_mov_b32 s62, 0x05040100
  s_mov_b32 s63, 0x07060302
  s_mov_b32 s52, 49152
  v_lshl_add_u32 v12, v6, 3, s52
  s_waitcnt vmcnt(14)
  s_nop 3
  v_perm_b32 v88, v148, v140, s62
  v_perm_b32 v89, v180, v172, s62
  ds_write_b64 v12, v[88:89] offset:0
  v_perm_b32 v90, v148, v140, s63
  v_perm_b32 v91, v180, v172, s63
  ds_write_b64 v12, v[90:91] offset:512
  v_perm_b32 v92, v149, v141, s62
  v_perm_b32 v93, v181, v173, s62
  ds_write_b64 v12, v[92:93] offset:1024
  v_perm_b32 v94, v149, v141, s63
  v_perm_b32 v95, v181, v173, s63
  ds_write_b64 v12, v[94:95] offset:1536
  v_perm_b32 v96, v150, v142, s62
  v_perm_b32 v97, v182, v174, s62
  ds_write_b64 v12, v[96:97] offset:8192
  v_perm_b32 v98, v150, v142, s63
  v_perm_b32 v99, v182, v174, s63
  ds_write_b64 v12, v[98:99] offset:8704
  v_perm_b32 v100, v151, v143, s62
  v_perm_b32 v101, v183, v175, s62
  ds_write_b64 v12, v[100:101] offset:9216
  v_perm_b32 v102, v151, v143, s63
  v_perm_b32 v103, v183, v175, s63
  ds_write_b64 v12, v[102:103] offset:9728
  s_branch KG_SPBR
KG_SPECIAL:
  ds_read_b64 v[88:89], v120
  ds_read_b64 v[90:91], v121
  ds_read_b64 v[92:93], v122
  ds_read_b64 v[94:95], v123
  ds_read_b64 v[96:97], v124
  ds_read_b64 v[98:99], v125
  ds_read_b64 v[100:101], v126
  ds_read_b64 v[102:103], v127
  v_lshlrev_b32 v12, 2, v6
  v_add_u32 v14, 65536, v12
  ds_write2st64_b32 v14, v152, v156 offset0:0 offset1:32
  ds_write2st64_b32 v14, v153, v157 offset0:1 offset1:33
  ds_write2st64_b32 v14, v154, v158 offset0:2 offset1:34
  ds_write2st64_b32 v14, v155, v159 offset0:3 offset1:35
  ds_write2st64_b32 v14, v160, v164 offset0:16 offset1:48
  ds_write2st64_b32 v14, v161, v165 offset0:17 offset1:49
  ds_write2st64_b32 v14, v162, v166 offset0:18 offset1:50
  ds_write2st64_b32 v14, v163, v167 offset0:19 offset1:51
  s_waitcnt lgkmcnt(0)
  s_mov_b64 exec, 1
  ds_add_u32 v7, v4 offset:124
  s_mov_b64 exec, -1
  v_lshlrev_b32 v168, 16, v172
  v_and_b32 v169, 0xffff0000, v172
  v_lshlrev_b32 v170, 16, v173
  v_and_b32 v171, 0xffff0000, v173
  v_lshlrev_b32 v172, 16, v174
  v_and_b32 v173, 0xffff0000, v174
  v_lshlrev_b32 v174, 16, v175
  v_and_b32 v175, 0xffff0000, v175
  v_lshlrev_b32 v176, 16, v180
  v_and_b32 v177, 0xffff0000, v180
  v_lshlrev_b32 v178, 16, v181
  v_and_b32 v179, 0xffff0000, v181
  v_lshlrev_b32 v180, 16, v182
  v_and_b32 v181, 0xffff0000, v182
  v_lshlrev_b32 v182, 16, v183
  v_and_b32 v183, 0xffff0000, v183
  v_lshlrev_b32 v10, 16, v88
  v_lshlrev_b32 v11, 16, v89
  v_and_b32 v88, 0xffff0000, v88
  v_and_b32 v89, 0xffff0000, v89
  v_add_f32 v10, v136, v10
  v_sub_f32 v88, v144, v88
  v_add_f32 v11, v168, v11
  v_sub_f32 v89, v176, v89
  v_add_f32 v136, v10, v11
  v_add_f32 v144, v88, v89
  v_sub_f32 v168, v10, v11
  v_sub_f32 v176, v88, v89
  v_lshrrev_b32 v120, 1, v120
  v_lshlrev_b32 v10, 16, v90
  v_lshlrev_b32 v11, 16, v91
  v_and_b32 v90, 0xffff0000, v90
  v_and_b32 v91, 0xffff0000, v91
  v_add_f32 v10, v137, v10
  v_sub_f32 v90, v145, v90
  v_add_f32 v11, v169, v11
  v_sub_f32 v91, v177, v91
  v_add_f32 v137, v10, v11
  v_add_f32 v145, v90, v91
  v_sub_f32 v169, v10, v11
  v_sub_f32 v177, v90, v91
  v_lshrrev_b32 v121, 1, v121
  v_lshlrev_b32 v10, 16, v92
  v_lshlrev_b32 v11, 16, v93
  v_and_b32 v92, 0xffff0000, v92
  v_and_b32 v93, 0xffff0000, v93
  v_add_f32 v10, v138, v10
  v_sub_f32 v92, v146, v92
  v_add_f32 v11, v170, v11
  v_sub_f32 v93, v178, v93
  v_add_f32 v138, v10, v11
  v_add_f32 v146, v92, v93
  v_sub_f32 v170, v10, v11
  v_sub_f32 v178, v92, v93
  v_lshrrev_b32 v122, 1, v122
  v_lshlrev_b32 v10, 16, v94
  v_lshlrev_b32 v11, 16, v95
  v_and_b32 v94, 0xffff0000, v94
  v_and_b32 v95, 0xffff0000, v95
  v_add_f32 v10, v139, v10
  v_sub_f32 v94, v147, v94
  v_add_f32 v11, v171, v11
  v_sub_f32 v95, v179, v95
  v_add_f32 v139, v10, v11
  v_add_f32 v147, v94, v95
  v_sub_f32 v171, v10, v11
  v_sub_f32 v179, v94, v95
  v_lshrrev_b32 v123, 1, v123
  v_lshlrev_b32 v10, 16, v96
  v_lshlrev_b32 v11, 16, v97
  v_and_b32 v96, 0xffff0000, v96
  v_and_b32 v97, 0xffff0000, v97
  v_add_f32 v10, v140, v10
  v_sub_f32 v96, v148, v96
  v_add_f32 v11, v172, v11
  v_sub_f32 v97, v180, v97
  v_add_f32 v140, v10, v11
  v_add_f32 v148, v96, v97
  v_sub_f32 v172, v10, v11
  v_sub_f32 v180, v96, v97
  v_lshrrev_b32 v124, 1, v124
  v_lshlrev_b32 v10, 16, v98
  v_lshlrev_b32 v11, 16, v99
  v_and_b32 v98, 0xffff0000, v98
  v_and_b32 v99, 0xffff0000, v99
  v_add_f32 v10, v141, v10
  v_sub_f32 v98, v149, v98
  v_add_f32 v11, v173, v11
  v_sub_f32 v99, v181, v99
  v_add_f32 v141, v10, v11
  v_add_f32 v149, v98, v99
  v_sub_f32 v173, v10, v11
  v_sub_f32 v181, v98, v99
  v_lshrrev_b32 v125, 1, v125
  v_lshlrev_b32 v10, 16, v100
  v_lshlrev_b32 v11, 16, v101
  v_and_b32 v100, 0xffff0000, v100
  v_and_b32 v101, 0xffff0000, v101
  v_add_f32 v10, v142, v10
  v_sub_f32 v100, v150, v100
  v_add_f32 v11, v174, v11
  v_sub_f32 v101, v182, v101
  v_add_f32 v142, v10, v11
  v_add_f32 v150, v100, v101
  v_sub_f32 v174, v10, v11
  v_sub_f32 v182, v100, v101
  v_lshrrev_b32 v126, 1, v126
  v_lshlrev_b32 v10, 16, v102
  v_lshlrev_b32 v11, 16, v103
  v_and_b32 v102, 0xffff0000, v102
  v_and_b32 v103, 0xffff0000, v103
  v_add_f32 v10, v143, v10
  v_sub_f32 v102, v151, v102
  v_add_f32 v11, v175, v11
  v_sub_f32 v103, v183, v103
  v_add_f32 v143, v10, v11
  v_add_f32 v151, v102, v103
  v_sub_f32 v175, v10, v11
  v_sub_f32 v183, v102, v103
  v_lshrrev_b32 v127, 1, v127
KG_LW45:
  ds_read_b32 v8, v7 offset:124
  s_waitcnt lgkmcnt(0)
  v_readfirstlane_b32 s51, v8
  s_cmp_ge_u32 s51, 4
  s_cbranch_scc1 KG_LD45
  s_sleep 1
  s_sub_u32 s72, s72, 1
  s_cbranch_scc0 KG_LW45
  s_mov_b32 s72, 0
KG_LD45:
  ds_read2st64_b32 v[88:89], v120 offset0:160 offset1:192
  ds_read2st64_b32 v[90:91], v121 offset0:160 offset1:192
  ds_read2st64_b32 v[92:93], v122 offset0:160 offset1:192
  ds_read2st64_b32 v[94:95], v123 offset0:160 offset1:192
  ds_read2st64_b32 v[96:97], v124 offset0:160 offset1:192
  ds_read2st64_b32 v[98:99], v125 offset0:160 offset1:192
  ds_read2st64_b32 v[100:101], v126 offset0:160 offset1:192
  ds_read2st64_b32 v[102:103], v127 offset0:160 offset1:192
  s_mov_b32 s51, 1040187392
  v_mul_f32 v8, v152, v136
  v_mul_f32 v9, v152, v144
  v_fma_f32 v8, -v156, v144, v8
  v_fma_f32 v9, v156, v136, v9
  s_waitcnt lgkmcnt(7)
  v_fma_f32 v8, v88, v168, v8
  v_fma_f32 v9, v88, v176, v9
  v_fma_f32 v8, v89, v176, v8
  v_fma_f32 v9, -v89, v168, v9
  v_mul_f32 v152, s51, v8
  v_mul_f32 v156, s51, v9
  v_mul_f32 v10, v153, v137
  v_mul_f32 v11, v153, v145
  v_fma_f32 v10, -v157, v145, v10
  v_fma_f32 v11, v157, v137, v11
  s_waitcnt lgkmcnt(6)
  v_fma_f32 v10, v90, v169, v10
  v_fma_f32 v11, v90, v177, v11
  v_fma_f32 v10, v91, v177, v10
  v_fma_f32 v11, -v91, v169, v11
  v_mul_f32 v153, s51, v10
  v_mul_f32 v157, s51, v11
  v_mul_f32 v8, v154, v138
  v_mul_f32 v9, v154, v146
  v_fma_f32 v8, -v158, v146, v8
  v_fma_f32 v9, v158, v138, v9
  s_waitcnt lgkmcnt(5)
  v_fma_f32 v8, v92, v170, v8
  v_fma_f32 v9, v92, v178, v9
  v_fma_f32 v8, v93, v178, v8
  v_fma_f32 v9, -v93, v170, v9
  v_mul_f32 v154, s51, v8
  v_mul_f32 v158, s51, v9
  v_mul_f32 v10, v155, v139
  v_mul_f32 v11, v155, v147
  v_fma_f32 v10, -v159, v147, v10
  v_fma_f32 v11, v159, v139, v11
  s_waitcnt lgkmcnt(4)
  v_fma_f32 v10, v94, v171, v10
  v_fma_f32 v11, v94, v179, v11
  v_fma_f32 v10, v95, v179, v10
  v_fma_f32 v11, -v95, v171, v11
  v_mul_f32 v155, s51, v10
  v_mul_f32 v159, s51, v11
  v_mul_f32 v8, v160, v140
  v_mul_f32 v9, v160, v148
  v_fma_f32 v8, -v164, v148, v8
  v_fma_f32 v9, v164, v140, v9
  s_waitcnt lgkmcnt(3)
  v_fma_f32 v8, v96, v172, v8
  v_fma_f32 v9, v96, v180, v9
  v_fma_f32 v8, v97, v180, v8
  v_fma_f32 v9, -v97, v172, v9
  v_mul_f32 v160, s51, v8
  v_mul_f32 v164, s51, v9
  v_mul_f32 v10, v161, v141
  v_mul_f32 v11, v161, v149
  v_fma_f32 v10, -v165, v149, v10
  v_fma_f32 v11, v165, v141, v11
  s_waitcnt lgkmcnt(2)
  v_fma_f32 v10, v98, v173, v10
  v_fma_f32 v11, v98, v181, v11
  v_fma_f32 v10, v99, v181, v10
  v_fma_f32 v11, -v99, v173, v11
  v_mul_f32 v161, s51, v10
  v_mul_f32 v165, s51, v11
  v_mul_f32 v8, v162, v142
  v_mul_f32 v9, v162, v150
  v_fma_f32 v8, -v166, v150, v8
  v_fma_f32 v9, v166, v142, v9
  s_waitcnt lgkmcnt(1)
  v_fma_f32 v8, v100, v174, v8
  v_fma_f32 v9, v100, v182, v9
  v_fma_f32 v8, v101, v182, v8
  v_fma_f32 v9, -v101, v174, v9
  v_mul_f32 v162, s51, v8
  v_mul_f32 v166, s51, v9
  v_mul_f32 v10, v163, v143
  v_mul_f32 v11, v163, v151
  v_fma_f32 v10, -v167, v151, v10
  v_fma_f32 v11, v167, v143, v11
  s_waitcnt lgkmcnt(0)
  v_fma_f32 v10, v102, v175, v10
  v_fma_f32 v11, v102, v183, v11
  v_fma_f32 v10, v103, v183, v10
  v_fma_f32 v11, -v103, v175, v11
  v_mul_f32 v163, s51, v10
  v_mul_f32 v167, s51, v11
  s_branch KG_STEP3
KG_END:
  s_endpgm
.section .rodata,"a"
.p2align 6
.amdhsa_kernel gated_mix__grouped_kv_mqa__spectral_gfnet__prompt_kernel
  .amdhsa_next_free_vgpr 256
  .amdhsa_next_free_sgpr 74
  .amdhsa_accum_offset 256
  .amdhsa_group_segment_fixed_size 0
  .amdhsa_kernarg_size 96
  .amdhsa_user_sgpr_count 2
  .amdhsa_user_sgpr_kernarg_segment_ptr 1
  .amdhsa_system_sgpr_workgroup_id_x 1
.end_amdhsa_kernel
.set C0, 16256
.set C1, 16256
.set C2, 16256
.set C3, 16256
.set C4, 16256
.set C5, 16256
.set C6, 16255
.set C7, 16255
.set C8, 16255
.set C9, 16254
.set C10, 16254
.set C11, 16254
.set C12, 16253
.set C13, 16253
.set C14, 16252
.set C15, 16252
.set C16, 16251
.set C17, 16250
.set C18, 16250
.set C19, 16249
.set C20, 16248
.set C21, 16248
.set C22, 16247
.set C23, 16246
.set C24, 16245
.set C25, 16244
.set C26, 16243
.set C27, 16242
.set C28, 16241
.set C29, 16240
.set C30, 16239
.set C31, 16238
.set C32, 16237
.set C33, 16235
.set C34, 16234
.set C35, 16233
.set C36, 16231
.set C37, 16230
.set C38, 16229
.set C39, 16227
.set C40, 16226
.set C41, 16224
.set C42, 16223
.set C43, 16221
.set C44, 16220
.set C45, 16218
.set C46, 16216
.set C47, 16215
.set C48, 16213
.set C49, 16211
.set C50, 16209
.set C51, 16207
.set C52, 16206
.set C53, 16204
.set C54, 16202
.set C55, 16200
.set C56, 16198
.set C57, 16196
.set C58, 16194
.set C59, 16192
.set C60, 16190
.set C61, 16188
.set C62, 16185
.set C63, 16183
.set C64, 16181
.set C65, 16179
.set C66, 16177
.set C67, 16174
.set C68, 16172
.set C69, 16170
.set C70, 16167
.set C71, 16165
.set C72, 16162
.set C73, 16160
.set C74, 16157
.set C75, 16155
.set C76, 16152
.set C77, 16150
.set C78, 16147
.set C79, 16145
.set C80, 16142
.set C81, 16140
.set C82, 16137
.set C83, 16134
.set C84, 16132
.set C85, 16129
.set C86, 16124
.set C87, 16119
.set C88, 16113
.set C89, 16108
.set C90, 16102
.set C91, 16097
.set C92, 16091
.set C93, 16085
.set C94, 16079
.set C95, 16074
.set C96, 16068
.set C97, 16062
.set C98, 16056
.set C99, 16050
.set C100, 16044
.set C101, 16039
.set C102, 16033
.set C103, 16027
.set C104, 16021
.set C105, 16015
.set C106, 16009
.set C107, 16002
.set C108, 15993
.set C109, 15981
.set C110, 15968
.set C111, 15956
.set C112, 15944
.set C113, 15931
.set C114, 15919
.set C115, 15907
.set C116, 15894
.set C117, 15882
.set C118, 15867
.set C119, 15842
.set C120, 15817
.set C121, 15792
.set C122, 15767
.set C123, 15739
.set C124, 15689
.set C125, 15639
.set C126, 15561
.set C127, 15433
.set C128, 0
.set C129, 48201
.set C130, 48329
.set C131, 48407
.set C132, 48457
.set C133, 48507
.set C134, 48535
.set C135, 48560
.set C136, 48585
.set C137, 48610
.set C138, 48635
.set C139, 48650
.set C140, 48662
.set C141, 48675
.set C142, 48687
.set C143, 48699
.set C144, 48712
.set C145, 48724
.set C146, 48736
.set C147, 48749
.set C148, 48761
.set C149, 48770
.set C150, 48777
.set C151, 48783
.set C152, 48789
.set C153, 48795
.set C154, 48801
.set C155, 48807
.set C156, 48812
.set C157, 48818
.set C158, 48824
.set C159, 48830
.set C160, 48836
.set C161, 48842
.set C162, 48847
.set C163, 48853
.set C164, 48859
.set C165, 48865
.set C166, 48870
.set C167, 48876
.set C168, 48881
.set C169, 48887
.set C170, 48892
.set C171, 48897
.set C172, 48900
.set C173, 48902
.set C174, 48905
.set C175, 48908
.set C176, 48910
.set C177, 48913
.set C178, 48915
.set C179, 48918
.set C180, 48920
.set C181, 48923
.set C182, 48925
.set C183, 48928
.set C184, 48930
.set C185, 48933
.set C186, 48935
.set C187, 48938
.set C188, 48940
.set C189, 48942
.set C190, 48945
.set C191, 48947
.set C192, 48949
.set C193, 48951
.set C194, 48953
.set C195, 48956
.set C196, 48958
.set C197, 48960
.set C198, 48962
.set C199, 48964
.set C200, 48966
.set C201, 48968
.set C202, 48970
.set C203, 48972
.set C204, 48974
.set C205, 48975
.set C206, 48977
.set C207, 48979
.set C208, 48981
.set C209, 48983
.set C210, 48984
.set C211, 48986
.set C212, 48988
.set C213, 48989
.set C214, 48991
.set C215, 48992
.set C216, 48994
.set C217, 48995
.set C218, 48997
.set C219, 48998
.set C220, 48999
.set C221, 49001
.set C222, 49002
.set C223, 49003
.set C224, 49005
.set C225, 49006
.set C226, 49007
.set C227, 49008
.set C228, 49009
.set C229, 49010
.set C230, 49011
.set C231, 49012
.set C232, 49013
.set C233, 49014
.set C234, 49015
.set C235, 49016
.set C236, 49016
.set C237, 49017
.set C238, 49018
.set C239, 49018
.set C240, 49019
.set C241, 49020
.set C242, 49020
.set C243, 49021
.set C244, 49021
.set C245, 49022
.set C246, 49022
.set C247, 49022
.set C248, 49023
.set C249, 49023
.set C250, 49023
.set C251, 49024
.set C252, 49024
.set C253, 49024
.set C254, 49024
.set C255, 49024
.set C256, 49024
.set C257, 49024
.set C258, 49024
.set C259, 49024
.set C260, 49024
.set C261, 49024
.set C262, 49023
.set C263, 49023
.set C264, 49023
.set C265, 49022
.set C266, 49022
.set C267, 49022
.set C268, 49021
.set C269, 49021
.set C270, 49020
.set C271, 49020
.set C272, 49019
.set C273, 49018
.set C274, 49018
.set C275, 49017
.set C276, 49016
.set C277, 49016
.set C278, 49015
.set C279, 49014
.set C280, 49013
.set C281, 49012
.set C282, 49011
.set C283, 49010
.set C284, 49009
.set C285, 49008
.set C286, 49007
.set C287, 49006
.set C288, 49005
.set C289, 49003
.set C290, 49002
.set C291, 49001
.set C292, 48999
.set C293, 48998
.set C294, 48997
.set C295, 48995
.set C296, 48994
.set C297, 48992
.set C298, 48991
.set C299, 48989
.set C300, 48988
.set C301, 48986
.set C302, 48984
.set C303, 48983
.set C304, 48981
.set C305, 48979
.set C306, 48977
.set C307, 48975
.set C308, 48974
.set C309, 48972
.set C310, 48970
.set C311, 48968
.set C312, 48966
.set C313, 48964
.set C314, 48962
.set C315, 48960
.set C316, 48958
.set C317, 48956
.set C318, 48953
.set C319, 48951
.set C320, 48949
.set C321, 48947
.set C322, 48945
.set C323, 48942
.set C324, 48940
.set C325, 48938
.set C326, 48935
.set C327, 48933
.set C328, 48930
.set C329, 48928
.set C330, 48925
.set C331, 48923
.set C332, 48920
.set C333, 48918
.set C334, 48915
.set C335, 48913
.set C336, 48910
.set C337, 48908
.set C338, 48905
.set C339, 48902
.set C340, 48900
.set C341, 48897
.set C342, 48892
.set C343, 48887
.set C344, 48881
.set C345, 48876
.set C346, 48870
.set C347, 48865
.set C348, 48859
.set C349, 48853
.set C350, 48847
.set C351, 48842
.set C352, 48836
.set C353, 48830
.set C354, 48824
.set C355, 48818
.set C356, 48812
.set C357, 48807
.set C358, 48801
.set C359, 48795
.set C360, 48789
.set C361, 48783
.set C362, 48777
.set C363, 48770
.set C364, 48761
.set C365, 48749
.set C366, 48736
.set C367, 48724
.set C368, 48712
.set C369, 48699
.set C370, 48687
.set C371, 48675
.set C372, 48662
.set C373, 48650
.set C374, 48635
.set C375, 48610
.set C376, 48585
.set C377, 48560
.set C378, 48535
.set C379, 48507
.set C380, 48457
.set C381, 48407
.set C382, 48329
.set C383, 48201
.set C384, 0
.set C385, 15433
.set C386, 15561
.set C387, 15639
.set C388, 15689
.set C389, 15739
.set C390, 15767
.set C391, 15792
.set C392, 15817
.set C393, 15842
.set C394, 15867
.set C395, 15882
.set C396, 15894
.set C397, 15907
.set C398, 15919
.set C399, 15931
.set C400, 15944
.set C401, 15956
.set C402, 15968
.set C403, 15981
.set C404, 15993
.set C405, 16002
.set C406, 16009
.set C407, 16015
.set C408, 16021
.set C409, 16027
.set C410, 16033
.set C411, 16039
.set C412, 16044
.set C413, 16050
.set C414, 16056
.set C415, 16062
.set C416, 16068
.set C417, 16074
.set C418, 16079
.set C419, 16085
.set C420, 16091
.set C421, 16097
.set C422, 16102
.set C423, 16108
.set C424, 16113
.set C425, 16119
.set C426, 16124
.set C427, 16129
.set C428, 16132
.set C429, 16134
.set C430, 16137
.set C431, 16140
.set C432, 16142
.set C433, 16145
.set C434, 16147
.set C435, 16150
.set C436, 16152
.set C437, 16155
.set C438, 16157
.set C439, 16160
.set C440, 16162
.set C441, 16165
.set C442, 16167
.set C443, 16170
.set C444, 16172
.set C445, 16174
.set C446, 16177
.set C447, 16179
.set C448, 16181
.set C449, 16183
.set C450, 16185
.set C451, 16188
.set C452, 16190
.set C453, 16192
.set C454, 16194
.set C455, 16196
.set C456, 16198
.set C457, 16200
.set C458, 16202
.set C459, 16204
.set C460, 16206
.set C461, 16207
.set C462, 16209
.set C463, 16211
.set C464, 16213
.set C465, 16215
.set C466, 16216
.set C467, 16218
.set C468, 16220
.set C469, 16221
.set C470, 16223
.set C471, 16224
.set C472, 16226
.set C473, 16227
.set C474, 16229
.set C475, 16230
.set C476, 16231
.set C477, 16233
.set C478, 16234
.set C479, 16235
.set C480, 16237
.set C481, 16238
.set C482, 16239
.set C483, 16240
.set C484, 16241
.set C485, 16242
.set C486, 16243
.set C487, 16244
.set C488, 16245
.set C489, 16246
.set C490, 16247
.set C491, 16248
.set C492, 16248
.set C493, 16249
.set C494, 16250
.set C495, 16250
.set C496, 16251
.set C497, 16252
.set C498, 16252
.set C499, 16253
.set C500, 16253
.set C501, 16254
.set C502, 16254
.set C503, 16254
.set C504, 16255
.set C505, 16255
.set C506, 16255
.set C507, 16256
.set C508, 16256
.set C509, 16256
.set C510, 16256
.set C511, 16256
.altmacro
.macro EC a
.short C\a
.endm
.macro F8 mul, add, k0
EC %((\mul*(\k0+0)+\add)&511)
EC %((\mul*(\k0+2)+\add)&511)
EC %((\mul*(\k0+4)+\add)&511)
EC %((\mul*(\k0+6)+\add)&511)
EC %((\mul*(\k0+8)+\add)&511)
EC %((\mul*(\k0+10)+\add)&511)
EC %((\mul*(\k0+12)+\add)&511)
EC %((\mul*(\k0+14)+\add)&511)
.endm
.p2align 8
TAB_F:
.set tI, 0
.rept 16384
  .set tL, tI & 63
  .set tO, (tL >> 4) & 1
  .set tF, ((tI >> 11) << 4) + (((tI >> 6) & 1) << 3) + (tL & 4) + ((tL >> 2) & 2) + ((tL >> 1) & 1)
  .set tS, ((tF == 0) & tL & 1) << 7
  .set tK, (((tI >> 7) & 15) << 5) + ((tL >> 5) << 4) + tO
  .set tM, tF + tS
  .set tA, ((tL & 1) << 7) - tS + tS * tO
  F8 %tM, %tA, %tK
  .set tI, tI + 1
.endr
.p2align 8
TAB_K2:
.short 16256,16256,16256,16256,16256,16256,16256,16256,16256,16255,16251,16245,16237,16226,16213,16198,16256,16251,16237,16213,16181,16142,16068,15944,16256,16245,16213,16162,16068,15817,48712,48881
.short 16256,16237,16181,16068,0,48836,48949,49005,16256,16226,16142,15817,48836,48966,49019,49013,16256,16213,16068,48712,48949,49019,49005,48910,16256,16198,15944,48881,49005,49013,48910,15817
.short 16256,16181,0,48949,49024,48949,0,16181,16256,16162,48712,48994,49005,48789,16142,16255,16256,16142,48836,49019,48949,15944,16237,16213,16256,16113,48910,49023,48836,16162,16251,16021
.short 16256,16068,48949,49005,0,16237,16181,48836,16256,16021,48981,48966,16068,16255,15944,48994,16256,15944,49005,48910,16181,16213,48836,49019,16256,15817,49019,48789,16237,16113,48981,48930
.short 16256,16256,16256,16256,16256,16256,16256,16256,16181,16162,16142,16113,16068,16021,15944,15817,0,48712,48836,48910,48949,48981,49005,49019,48949,48994,49019,49023,49005,48966,48910,48789
.short 49024,49005,48949,48836,0,16068,16181,16237,48949,48789,15944,16162,16237,16255,16213,16113,0,16142,16237,16251,16181,15944,48836,48981,16181,16255,16213,16021,48836,48994,49019,48930
.short 16256,16181,0,48949,49024,48949,0,16181,16181,48585,48981,49013,48836,16113,16251,16198,0,48981,49005,48712,16181,16251,16068,48910,48949,49013,48712,16198,16237,15817,48981,48994
.short 49024,48836,16181,16237,0,49005,48949,16068,48949,16113,16251,15817,49005,48930,16142,16245,0,16251,16068,48981,48949,16142,16237,48712,16181,16198,48910,48994,16068,16245,48712,49023
.short 16256,16256,16256,16256,16256,16256,16256,16256,0,48585,48712,48789,48836,48881,48910,48930,49024,49019,49005,48981,48949,48910,48836,48712,0,16021,16142,16198,16237,16255,16251,16226
.short 16256,16237,16181,16068,0,48836,48949,49005,0,48881,48981,49023,49005,48930,48712,16021,49024,48981,48836,15944,16181,16251,16237,16142,0,16162,16251,16226,16068,48789,48981,49023
.short 16256,16181,0,48949,49024,48949,0,16181,0,48966,49019,48881,16068,16245,16213,15817,49024,48910,16068,16251,16181,48712,49005,48981,0,16226,16213,48585,49005,48966,15944,16245
.short 16256,16068,48949,49005,0,16237,16181,48836,0,49013,48910,16162,16237,48585,49019,48881,49024,48712,16237,16142,48949,48981,16068,16251,0,16255,15944,49013,48836,16226,16142,48966
.short 16256,16256,16256,16256,16256,16256,16256,16256,48949,48966,48981,48994,49005,49013,49019,49023,0,15944,16068,16142,16181,16213,16237,16251,16181,16113,15944,48585,48836,48930,48981,49013
.short 49024,49005,48949,48836,0,16068,16181,16237,16181,16245,16251,16198,16068,48585,48910,48994,0,48910,49005,49019,48949,48712,16068,16213,48949,48585,16142,16245,16237,16113,48712,48966
.short 16256,16181,0,48949,49024,48949,0,16181,48949,49023,48910,16021,16237,16226,15944,48930,0,16213,16237,15944,48949,49019,48836,16142,16181,48789,49019,48930,16068,16255,16142,48881
.short 49024,48836,16181,16237,0,49005,48949,16068,16181,16226,48712,49023,48836,16198,16213,48789,0,49019,48836,16213,16181,48910,49005,15944,48949,16162,16213,48881,49005,16021,16251,48585
.short 0,0,0,0,0,0,0,0,0,48585,48712,48789,48836,48881,48910,48930,0,48712,48836,48910,48949,48981,49005,49019,0,48789,48910,48966,49005,49023,49019,48994
.short 0,48836,48949,49005,49024,49005,48949,48836,0,48881,48981,49023,49005,48930,48712,16021,0,48910,49005,49019,48949,48712,16068,16213,0,48930,49019,48994,48836,16021,16213,16255
.short 0,48949,49024,48949,0,16181,16256,16181,0,48966,49019,48881,16068,16245,16213,15817,0,48981,49005,48712,16181,16251,16068,48910,0,48994,48981,15817,16237,16198,48712,49013
.short 0,49005,48949,16068,16256,16068,48949,49005,0,49013,48910,16162,16237,48585,49019,48881,0,49019,48836,16213,16181,48910,49005,15944,0,49023,48712,16245,16068,48994,48910,16198
.short 0,0,0,0,0,0,0,0,48949,48966,48981,48994,49005,49013,49019,49023,49024,49019,49005,48981,48949,48910,48836,48712,48949,48881,48712,15817,16068,16162,16213,16245
.short 0,16068,16181,16237,16256,16237,16181,16068,16181,16245,16251,16198,16068,48585,48910,48994,16256,16213,16068,48712,48949,49019,49005,48910,16181,15817,48910,49013,49005,48881,15944,16198
.short 0,48949,49024,48949,0,16181,16256,16181,48949,49023,48910,16021,16237,16226,15944,48930,49024,48910,16068,16251,16181,48712,49005,48981,48949,16021,16251,16162,48836,49023,48910,16113
.short 0,16237,16181,48836,49024,48836,16181,16237,16181,16226,48712,49023,48836,16198,16213,48789,16256,15944,49005,48910,16181,16213,48836,49019,16181,48930,48981,16113,16237,48789,49019,15817
.short 0,0,0,0,0,0,0,0,49024,49023,49019,49013,49005,48994,48981,48966,0,15944,16068,16142,16181,16213,16237,16251,16256,16245,16213,16162,16068,15817,48712,48881
.short 0,48836,48949,49005,49024,49005,48949,48836,49024,48994,48910,48585,16068,16198,16251,16245,0,16142,16237,16251,16181,15944,48836,48981,16256,16198,15944,48881,49005,49013,48910,15817
.short 0,48949,49024,48949,0,16181,16256,16181,49024,48930,15944,16226,16237,16021,48910,49023,0,16213,16237,15944,48949,49019,48836,16142,16256,16113,48910,49023,48836,16162,16251,16021
.short 0,49005,48949,16068,16256,16068,48949,49005,49024,48789,16213,16198,48836,49023,48712,16226,0,16251,16068,48981,48949,16142,16237,48712,16256,15817,49019,48789,16237,16113,48981,48930
.short 0,0,0,0,0,0,0,0,48949,48930,48910,48881,48836,48789,48712,48585,16256,16251,16237,16213,16181,16142,16068,15944,48949,48994,49019,49023,49005,48966,48910,48789
.short 0,16068,16181,16237,16256,16237,16181,16068,16181,16021,48712,48930,49005,49023,48981,48881,49024,48981,48836,15944,16181,16251,16237,16142,16181,16255,16213,16021,48836,48994,49019,48930
.short 0,48949,49024,48949,0,16181,16256,16181,48949,15817,16213,16245,16068,48881,49019,48966,16256,16142,48836,49019,48949,15944,16237,16213,48949,49013,48712,16198,16237,15817,48981,48994
.short 0,16237,16181,48836,49024,48836,16181,16237,16181,48881,49019,48585,16237,16162,48910,49013,49024,48712,16237,16142,48949,48981,16068,16251,16181,16198,48910,48994,16068,16245,48712,49023
.short 0,0,0,0,0,0,0,0,0,15817,15944,16021,16068,16113,16142,16162,0,15944,16068,16142,16181,16213,16237,16251,0,16021,16142,16198,16237,16255,16251,16226
.short 0,16068,16181,16237,16256,16237,16181,16068,0,16113,16213,16255,16237,16162,15944,48789,0,16142,16237,16251,16181,15944,48836,48981,0,16162,16251,16226,16068,48789,48981,49023
.short 0,16181,16256,16181,0,48949,49024,48949,0,16198,16251,16113,48836,49013,48981,48585,0,16213,16237,15944,48949,49019,48836,16142,0,16226,16213,48585,49005,48966,15944,16245
.short 0,16237,16181,48836,49024,48836,16181,16237,0,16245,16142,48930,49005,15817,16251,16113,0,16251,16068,48981,48949,16142,16237,48712,0,16255,15944,49013,48836,16226,16142,48966
.short 0,0,0,0,0,0,0,0,16181,16198,16213,16226,16237,16245,16251,16255,16256,16251,16237,16213,16181,16142,16068,15944,16181,16113,15944,48585,48836,48930,48981,49013
.short 0,48836,48949,49005,49024,49005,48949,48836,48949,49013,49019,48966,48836,15817,16142,16226,49024,48981,48836,15944,16181,16251,16237,16142,48949,48585,16142,16245,16237,16113,48712,48966
.short 0,16181,16256,16181,0,48949,49024,48949,16181,16255,16142,48789,49005,48994,48712,16162,16256,16142,48836,49019,48949,15944,16237,16213,16181,48789,49019,48930,16068,16255,16142,48881
.short 0,49005,48949,16068,16256,16068,48949,49005,48949,48994,15944,16255,16068,48966,48981,16021,49024,48712,16237,16142,48949,48981,16068,16251,48949,16162,16213,48881,49005,16021,16251,48585
.short 0,0,0,0,0,0,0,0,16256,16255,16251,16245,16237,16226,16213,16198,0,48712,48836,48910,48949,48981,49005,49019,49024,49013,48981,48930,48836,48585,15944,16113
.short 0,16068,16181,16237,16256,16237,16181,16068,16256,16226,16142,15817,48836,48966,49019,49013,0,48910,49005,49019,48949,48712,16068,16213,49024,48966,48712,16113,16237,16245,16142,48585
.short 0,16181,16256,16181,0,48949,49024,48949,16256,16162,48712,48994,49005,48789,16142,16255,0,48981,49005,48712,16181,16251,16068,48910,49024,48881,16142,16255,16068,48930,49019,48789
.short 0,16237,16181,48836,49024,48836,16181,16237,16256,16021,48981,48966,16068,16255,15944,48994,0,49019,48836,16213,16181,48910,49005,15944,49024,48585,16251,16021,49005,48881,16213,16162
.short 0,0,0,0,0,0,0,0,16181,16162,16142,16113,16068,16021,15944,15817,49024,49019,49005,48981,48949,48910,48836,48712,16181,16226,16251,16255,16237,16198,16142,16021
.short 0,48836,48949,49005,49024,49005,48949,48836,48949,48789,15944,16162,16237,16255,16213,16113,16256,16213,16068,48712,48949,49019,49005,48910,48949,49023,48981,48789,16068,16226,16251,16162
.short 0,16181,16256,16181,0,48949,49024,48949,16181,48585,48981,49013,48836,16113,16251,16198,49024,48910,16068,16251,16181,48712,49005,48981,16181,16245,15944,48966,49005,48585,16213,16226
.short 0,49005,48949,16068,16256,16068,48949,49005,48949,16113,16251,15817,49005,48930,16142,16245,16256,15944,49005,48910,16181,16213,48836,49019,48949,48966,16142,16226,48836,49013,15944,16255
.short 16256,16256,16256,16256,16256,16256,16256,16256,49024,49023,49019,49013,49005,48994,48981,48966,16256,16251,16237,16213,16181,16142,16068,15944,49024,49013,48981,48930,48836,48585,15944,16113
.short 16256,16237,16181,16068,0,48836,48949,49005,49024,48994,48910,48585,16068,16198,16251,16245,16256,16213,16068,48712,48949,49019,49005,48910,49024,48966,48712,16113,16237,16245,16142,48585
.short 16256,16181,0,48949,49024,48949,0,16181,49024,48930,15944,16226,16237,16021,48910,49023,16256,16142,48836,49019,48949,15944,16237,16213,49024,48881,16142,16255,16068,48930,49019,48789
.short 16256,16068,48949,49005,0,16237,16181,48836,49024,48789,16213,16198,48836,49023,48712,16226,16256,15944,49005,48910,16181,16213,48836,49019,49024,48585,16251,16021,49005,48881,16213,16162
.short 16256,16256,16256,16256,16256,16256,16256,16256,48949,48930,48910,48881,48836,48789,48712,48585,0,48712,48836,48910,48949,48981,49005,49019,16181,16226,16251,16255,16237,16198,16142,16021
.short 49024,49005,48949,48836,0,16068,16181,16237,16181,16021,48712,48930,49005,49023,48981,48881,0,16142,16237,16251,16181,15944,48836,48981,48949,49023,48981,48789,16068,16226,16251,16162
.short 16256,16181,0,48949,49024,48949,0,16181,48949,15817,16213,16245,16068,48881,49019,48966,0,48981,49005,48712,16181,16251,16068,48910,16181,16245,15944,48966,49005,48585,16213,16226
.short 49024,48836,16181,16237,0,49005,48949,16068,16181,48881,49019,48585,16237,16162,48910,49013,0,16251,16068,48981,48949,16142,16237,48712,48949,48966,16142,16226,48836,49013,15944,16255
.short 16256,16256,16256,16256,16256,16256,16256,16256,0,15817,15944,16021,16068,16113,16142,16162,49024,49019,49005,48981,48949,48910,48836,48712,0,48789,48910,48966,49005,49023,49019,48994
.short 16256,16237,16181,16068,0,48836,48949,49005,0,16113,16213,16255,16237,16162,15944,48789,49024,48981,48836,15944,16181,16251,16237,16142,0,48930,49019,48994,48836,16021,16213,16255
.short 16256,16181,0,48949,49024,48949,0,16181,0,16198,16251,16113,48836,49013,48981,48585,49024,48910,16068,16251,16181,48712,49005,48981,0,48994,48981,15817,16237,16198,48712,49013
.short 16256,16068,48949,49005,0,16237,16181,48836,0,16245,16142,48930,49005,15817,16251,16113,49024,48712,16237,16142,48949,48981,16068,16251,0,49023,48712,16245,16068,48994,48910,16198
.short 16256,16256,16256,16256,16256,16256,16256,16256,16181,16198,16213,16226,16237,16245,16251,16255,0,15944,16068,16142,16181,16213,16237,16251,48949,48881,48712,15817,16068,16162,16213,16245
.short 49024,49005,48949,48836,0,16068,16181,16237,48949,49013,49019,48966,48836,15817,16142,16226,0,48910,49005,49019,48949,48712,16068,16213,16181,15817,48910,49013,49005,48881,15944,16198
.short 16256,16181,0,48949,49024,48949,0,16181,16181,16255,16142,48789,49005,48994,48712,16162,0,16213,16237,15944,48949,49019,48836,16142,48949,16021,16251,16162,48836,49023,48910,16113
.short 49024,48836,16181,16237,0,49005,48949,16068,48949,48994,15944,16255,16068,48966,48981,16021,0,49019,48836,16213,16181,48910,49005,15944,16181,48930,48981,16113,16237,48789,49019,15817
.short 0,0,0,0,0,0,0,0,0,15817,15944,16021,16068,16113,16142,16162,0,48712,48836,48910,48949,48981,49005,49019,0,16021,16142,16198,16237,16255,16251,16226
.short 0,48836,48949,49005,49024,49005,48949,48836,0,16113,16213,16255,16237,16162,15944,48789,0,48910,49005,49019,48949,48712,16068,16213,0,16162,16251,16226,16068,48789,48981,49023
.short 0,48949,49024,48949,0,16181,16256,16181,0,16198,16251,16113,48836,49013,48981,48585,0,48981,49005,48712,16181,16251,16068,48910,0,16226,16213,48585,49005,48966,15944,16245
.short 0,49005,48949,16068,16256,16068,48949,49005,0,16245,16142,48930,49005,15817,16251,16113,0,49019,48836,16213,16181,48910,49005,15944,0,16255,15944,49013,48836,16226,16142,48966
.short 0,0,0,0,0,0,0,0,16181,16198,16213,16226,16237,16245,16251,16255,49024,49019,49005,48981,48949,48910,48836,48712,16181,16113,15944,48585,48836,48930,48981,49013
.short 0,16068,16181,16237,16256,16237,16181,16068,48949,49013,49019,48966,48836,15817,16142,16226,16256,16213,16068,48712,48949,49019,49005,48910,48949,48585,16142,16245,16237,16113,48712,48966
.short 0,48949,49024,48949,0,16181,16256,16181,16181,16255,16142,48789,49005,48994,48712,16162,49024,48910,16068,16251,16181,48712,49005,48981,16181,48789,49019,48930,16068,16255,16142,48881
.short 0,16237,16181,48836,49024,48836,16181,16237,48949,48994,15944,16255,16068,48966,48981,16021,16256,15944,49005,48910,16181,16213,48836,49019,48949,16162,16213,48881,49005,16021,16251,48585
.short 0,0,0,0,0,0,0,0,16256,16255,16251,16245,16237,16226,16213,16198,0,15944,16068,16142,16181,16213,16237,16251,49024,49013,48981,48930,48836,48585,15944,16113
.short 0,48836,48949,49005,49024,49005,48949,48836,16256,16226,16142,15817,48836,48966,49019,49013,0,16142,16237,16251,16181,15944,48836,48981,49024,48966,48712,16113,16237,16245,16142,48585
.short 0,48949,49024,48949,0,16181,16256,16181,16256,16162,48712,48994,49005,48789,16142,16255,0,16213,16237,15944,48949,49019,48836,16142,49024,48881,16142,16255,16068,48930,49019,48789
.short 0,49005,48949,16068,16256,16068,48949,49005,16256,16021,48981,48966,16068,16255,15944,48994,0,16251,16068,48981,48949,16142,16237,48712,49024,48585,16251,16021,49005,48881,16213,16162
.short 0,0,0,0,0,0,0,0,16181,16162,16142,16113,16068,16021,15944,15817,16256,16251,16237,16213,16181,16142,16068,15944,16181,16226,16251,16255,16237,16198,16142,16021
.short 0,16068,16181,16237,16256,16237,16181,16068,48949,48789,15944,16162,16237,16255,16213,16113,49024,48981,48836,15944,16181,16251,16237,16142,48949,49023,48981,48789,16068,16226,16251,16162
.short 0,48949,49024,48949,0,16181,16256,16181,16181,48585,48981,49013,48836,16113,16251,16198,16256,16142,48836,49019,48949,15944,16237,16213,16181,16245,15944,48966,49005,48585,16213,16226
.short 0,16237,16181,48836,49024,48836,16181,16237,48949,16113,16251,15817,49005,48930,16142,16245,49024,48712,16237,16142,48949,48981,16068,16251,48949,48966,16142,16226,48836,49013,15944,16255
.short 0,0,0,0,0,0,0,0,0,48585,48712,48789,48836,48881,48910,48930,0,15944,16068,16142,16181,16213,16237,16251,0,48789,48910,48966,49005,49023,49019,48994
.short 0,16068,16181,16237,16256,16237,16181,16068,0,48881,48981,49023,49005,48930,48712,16021,0,16142,16237,16251,16181,15944,48836,48981,0,48930,49019,48994,48836,16021,16213,16255
.short 0,16181,16256,16181,0,48949,49024,48949,0,48966,49019,48881,16068,16245,16213,15817,0,16213,16237,15944,48949,49019,48836,16142,0,48994,48981,15817,16237,16198,48712,49013
.short 0,16237,16181,48836,49024,48836,16181,16237,0,49013,48910,16162,16237,48585,49019,48881,0,16251,16068,48981,48949,16142,16237,48712,0,49023,48712,16245,16068,48994,48910,16198
.short 0,0,0,0,0,0,0,0,48949,48966,48981,48994,49005,49013,49019,49023,16256,16251,16237,16213,16181,16142,16068,15944,48949,48881,48712,15817,16068,16162,16213,16245
.short 0,48836,48949,49005,49024,49005,48949,48836,16181,16245,16251,16198,16068,48585,48910,48994,49024,48981,48836,15944,16181,16251,16237,16142,16181,15817,48910,49013,49005,48881,15944,16198
.short 0,16181,16256,16181,0,48949,49024,48949,48949,49023,48910,16021,16237,16226,15944,48930,16256,16142,48836,49019,48949,15944,16237,16213,48949,16021,16251,16162,48836,49023,48910,16113
.short 0,49005,48949,16068,16256,16068,48949,49005,16181,16226,48712,49023,48836,16198,16213,48789,49024,48712,16237,16142,48949,48981,16068,16251,16181,48930,48981,16113,16237,48789,49019,15817
.short 0,0,0,0,0,0,0,0,49024,49023,49019,49013,49005,48994,48981,48966,0,48712,48836,48910,48949,48981,49005,49019,16256,16245,16213,16162,16068,15817,48712,48881
.short 0,16068,16181,16237,16256,16237,16181,16068,49024,48994,48910,48585,16068,16198,16251,16245,0,48910,49005,49019,48949,48712,16068,16213,16256,16198,15944,48881,49005,49013,48910,15817
.short 0,16181,16256,16181,0,48949,49024,48949,49024,48930,15944,16226,16237,16021,48910,49023,0,48981,49005,48712,16181,16251,16068,48910,16256,16113,48910,49023,48836,16162,16251,16021
.short 0,16237,16181,48836,49024,48836,16181,16237,49024,48789,16213,16198,48836,49023,48712,16226,0,49019,48836,16213,16181,48910,49005,15944,16256,15817,49019,48789,16237,16113,48981,48930
.short 0,0,0,0,0,0,0,0,48949,48930,48910,48881,48836,48789,48712,48585,49024,49019,49005,48981,48949,48910,48836,48712,48949,48994,49019,49023,49005,48966,48910,48789
.short 0,48836,48949,49005,49024,49005,48949,48836,16181,16021,48712,48930,49005,49023,48981,48881,16256,16213,16068,48712,48949,49019,49005,48910,16181,16255,16213,16021,48836,48994,49019,48930
.short 0,16181,16256,16181,0,48949,49024,48949,48949,15817,16213,16245,16068,48881,49019,48966,49024,48910,16068,16251,16181,48712,49005,48981,48949,49013,48712,16198,16237,15817,48981,48994
.short 0,49005,48949,16068,16256,16068,48949,49005,16181,48881,49019,48585,16237,16162,48910,49013,16256,15944,49005,48910,16181,16213,48836,49019,16181,16198,48910,48994,16068,16245,48712,49023
.short 16256,0,49024,0,16256,0,49024,0,16256,48585,49019,16021,16237,48881,48981,16162,16256,48712,49005,16142,16181,48981,48836,16251,16256,48789,48981,16198,16068,49023,15944,16226
.short 16256,48836,48949,16237,0,49005,16181,16068,16256,48881,48910,16255,48836,48930,16251,48789,16256,48910,48836,16251,48949,48712,16237,48981,16256,48930,48712,16226,49005,16021,16142,49023
.short 16256,48949,0,16181,49024,16181,0,48949,16256,48966,15944,16113,49005,16245,48910,48585,16256,48981,16068,15944,48949,16251,49005,16142,16256,48994,16142,48585,48836,16198,49019,16245
.short 16256,49005,16181,48836,0,16068,48949,16237,16256,49013,16213,48930,16068,48585,48712,16113,16256,49019,16237,48981,16181,48910,16068,48712,16256,49023,16251,49013,16237,48994,16213,48966
.short 16256,0,49024,0,16256,0,49024,0,16181,48966,48910,16226,16068,49013,48712,16255,0,49019,16068,16213,48949,48910,16237,15944,48949,48881,16251,48585,49005,16162,16142,49013
.short 49024,16068,16181,49005,0,16237,48949,48836,48949,16245,48712,48966,16237,48585,48981,16226,0,16213,49005,15944,16181,49019,16068,16142,16181,15817,48981,16245,48836,48881,16251,48966
.short 16256,48949,0,16181,49024,16181,0,48949,16181,49023,16213,48789,48836,16226,49019,16162,0,48910,16237,49019,16181,48712,48836,16213,48949,16021,15944,48930,16237,49023,16213,48881
.short 49024,16237,48949,16068,0,48836,16181,49005,48949,16226,49019,16255,49005,16198,48910,16021,0,15944,48836,16142,48949,16213,49005,16251,16181,48930,16142,48881,16068,48789,15944,48585
.short 16256,0,49024,0,16256,0,49024,0,0,49023,15944,16245,48836,48994,16142,16198,49024,15944,16237,48910,48949,16213,16068,49019,0,16245,48910,48930,16237,15817,49019,16113
.short 16256,48836,48949,16237,0,49005,16181,16068,0,48994,16213,15817,49005,16198,15944,49013,49024,16142,16068,49019,16181,15944,49005,16213,0,16198,49019,16113,16068,49013,16213,48585
.short 16256,48949,0,16181,49024,16181,0,48949,0,48930,16251,48994,16068,16021,48981,16255,49024,16213,48836,48712,16181,49019,16237,48910,0,16113,48981,16255,49005,16162,48712,48789
.short 16256,49005,16181,48836,0,16068,48949,16237,0,48789,16142,48966,16237,49023,16251,48994,49024,16251,49005,16213,48949,16142,48836,15944,0,15817,48712,16021,48836,16113,48910,16162
.short 16256,0,49024,0,16256,0,49024,0,48949,48930,16213,16113,49005,48789,16251,15817,0,16251,48836,48981,16181,16142,49005,48712,16181,48994,48712,16255,48836,48966,16213,16021
.short 49024,16068,16181,49005,0,16237,48949,48836,16181,16021,49019,16162,16068,49023,16142,16113,0,48981,16237,48712,48949,16251,48836,48910,48949,16255,48910,48789,16237,48994,15944,16162
.short 16256,48949,0,16181,49024,16181,0,48949,48949,15817,16142,49013,16237,48881,48712,16198,0,16142,49005,16251,48949,15944,16068,48981,16181,49013,16251,48966,16068,15817,48910,16226
.short 49024,16237,48949,16068,0,48836,16181,49005,16181,48881,15944,15817,48836,16162,48981,16245,0,48712,16068,48910,16181,48981,16237,49019,48949,16198,48981,16226,49005,16245,49019,16255
.short 0,49024,0,16256,0,49024,0,16256,0,49023,15944,16245,48836,48994,16142,16198,0,49019,16068,16213,48949,48910,16237,15944,0,49013,16142,16162,49005,48585,16251,48881
.short 0,49005,16181,16068,49024,16068,16181,49005,0,48994,16213,15817,49005,16198,15944,49013,0,48981,16237,48712,48949,16251,48836,48910,0,48966,16251,48881,48836,16245,48981,15817
.short 0,48949,16256,48949,0,16181,49024,16181,0,48930,16251,48994,16068,16021,48981,16255,0,48910,16237,49019,16181,48712,48836,16213,0,48881,16213,49023,16237,48930,15944,16021
.short 0,48836,16181,49005,16256,49005,16181,48836,0,48789,16142,48966,16237,49023,16251,48994,0,48712,16068,48910,16181,48981,16237,49019,0,48585,15944,48789,16068,48881,16142,48930
.short 0,49024,0,16256,0,49024,0,16256,48949,48930,16213,16113,49005,48789,16251,15817,49024,15944,16237,48910,48949,16213,16068,49019,48949,16226,15944,49023,16068,16198,48981,48789
.short 0,16237,48949,48836,16256,48836,48949,16237,16181,16021,49019,16162,16068,49023,16142,16113,16256,48910,48836,16251,48949,48712,16237,48981,16181,49023,16142,16021,49005,16226,48712,48930
.short 0,48949,16256,48949,0,16181,49024,16181,48949,15817,16142,49013,16237,48881,48712,16198,49024,16213,48836,48712,16181,49019,16237,48910,48949,16245,49019,16198,48836,48585,16142,48994
.short 0,16068,48949,16237,49024,16237,48949,16068,16181,48881,15944,15817,48836,16162,48981,16245,16256,49019,16237,48981,16181,48910,16068,48712,16181,48966,16213,48994,16237,49013,16251,49023
.short 0,49024,0,16256,0,49024,0,16256,49024,15817,16251,48789,49005,16113,16213,48930,0,16251,48836,48981,16181,16142,49005,48712,16256,48789,48981,16198,16068,49023,15944,16226
.short 0,49005,16181,16068,49024,16068,16181,49005,49024,16113,16142,49023,16068,16162,49019,16021,0,16213,49005,15944,16181,49019,16068,16142,16256,48930,48712,16226,49005,16021,16142,49023
.short 0,48949,16256,48949,0,16181,49024,16181,49024,16198,48712,48881,16237,49013,16142,15817,0,16142,49005,16251,48949,15944,16068,48981,16256,48994,16142,48585,48836,16198,49019,16245
.short 0,48836,16181,49005,16256,49005,16181,48836,49024,16245,48981,16162,48836,15817,15944,48881,0,15944,48836,16142,48949,16213,49005,16251,16256,49023,16251,49013,16237,48994,16213,48966
.short 0,49024,0,16256,0,49024,0,16256,48949,16198,16142,48994,48836,16245,15944,49023,16256,48712,49005,16142,16181,48981,48836,16251,48949,48881,16251,48585,49005,16162,16142,49013
.short 0,16237,48949,48836,16256,48836,48949,16237,16181,49013,15944,16198,49005,15817,16213,48994,49024,16142,16068,49019,16181,15944,49005,16213,16181,15817,48981,16245,48836,48881,16251,48966
.short 0,48949,16256,48949,0,16181,49024,16181,48949,16255,48981,16021,16068,48994,16251,48930,16256,48981,16068,15944,48949,16251,49005,16142,48949,16021,15944,48930,16237,49023,16213,48881
.short 0,16068,48949,16237,49024,16237,48949,16068,16181,48994,16251,49023,16237,48966,16142,48789,49024,16251,49005,16213,48949,16142,48836,15944,16181,48930,16142,48881,16068,48789,15944,48585
.short 0,16256,0,49024,0,16256,0,49024,0,16255,48712,49013,16068,16226,48910,48966,0,16251,48836,48981,16181,16142,49005,48712,0,16245,48910,48930,16237,15817,49019,16113
.short 0,16237,48949,48836,16256,48836,48949,16237,0,16226,48981,48585,16237,48966,48712,16245,0,16213,49005,15944,16181,49019,16068,16142,0,16198,49019,16113,16068,49013,16213,48585
.short 0,16181,49024,16181,0,48949,16256,48949,0,16162,49019,16226,48836,48789,16213,49023,0,16142,49005,16251,48949,15944,16068,48981,0,16113,48981,16255,49005,16162,48712,48789
.short 0,16068,48949,16237,49024,16237,48949,16068,0,16021,48910,16198,49005,16255,49019,16226,0,15944,48836,16142,48949,16213,49005,16251,0,15817,48712,16021,48836,16113,48910,16162
.short 0,16256,0,49024,0,16256,0,49024,16181,16162,48981,48881,16237,16021,49019,48585,16256,48712,49005,16142,16181,48981,48836,16251,16181,48994,48712,16255,48836,48966,16213,16021
.short 0,49005,16181,16068,49024,16068,16181,49005,48949,48789,16251,48930,48836,16255,48910,48881,49024,16142,16068,49019,16181,15944,49005,16213,48949,16255,48910,48789,16237,48994,15944,16162
.short 0,16181,49024,16181,0,48949,16256,48949,16181,48585,48910,16245,49005,16113,15944,48966,16256,48981,16068,15944,48949,16251,49005,16142,16181,49013,16251,48966,16068,15817,48910,16226
.short 0,48836,16181,49005,16256,49005,16181,48836,48949,16113,48712,48585,16068,48930,16213,49013,49024,16251,49005,16213,48949,16142,48836,15944,48949,16198,48981,16226,49005,16245,49019,16255
.short 0,16256,0,49024,0,16256,0,49024,16256,48585,49019,16021,16237,48881,48981,16162,0,49019,16068,16213,48949,48910,16237,15944,49024,16021,16213,48966,48836,16255,48712,48994
.short 0,16237,48949,48836,16256,48836,48949,16237,16256,48881,48910,16255,48836,48930,16251,48789,0,48981,16237,48712,48949,16251,48836,48910,49024,16162,15944,48994,16237,48789,48910,16255
.short 0,16181,49024,16181,0,48949,16256,48949,16256,48966,15944,16113,49005,16245,48910,48585,0,48910,16237,49019,16181,48712,48836,16213,49024,16226,48910,15817,16068,48966,16251,49013
.short 0,16068,48949,16237,49024,16237,48949,16068,16256,49013,16213,48930,16068,48585,48712,16113,0,48712,16068,48910,16181,48981,16237,49019,49024,16255,49019,16245,49005,16226,48981,16198
.short 0,16256,0,49024,0,16256,0,49024,16181,48966,48910,16226,16068,49013,48712,16255,49024,15944,16237,48910,48949,16213,16068,49019,16181,16113,49019,15817,16237,48930,48910,16245
.short 0,49005,16181,16068,49024,16068,16181,49005,48949,16245,48712,48966,16237,48585,48981,16226,16256,48910,48836,16251,48949,48712,16237,48981,48949,48585,16213,49013,16068,16113,49019,16198
.short 0,16181,49024,16181,0,48949,16256,48949,16181,49023,16213,48789,48836,16226,49019,16162,49024,16213,48836,48712,16181,49019,16237,48910,16181,48789,48712,16162,49005,16255,48981,16113
.short 0,48836,16181,49005,16256,49005,16181,48836,48949,16226,49019,16255,49005,16198,48910,16021,16256,49019,16237,48981,16181,48910,16068,48712,48949,16162,48910,16113,48836,16021,48712,15817
.short 16256,0,49024,0,16256,0,49024,0,49024,15817,16251,48789,49005,16113,16213,48930,16256,48712,49005,16142,16181,48981,48836,16251,49024,16021,16213,48966,48836,16255,48712,48994
.short 16256,48836,48949,16237,0,49005,16181,16068,49024,16113,16142,49023,16068,16162,49019,16021,16256,48910,48836,16251,48949,48712,16237,48981,49024,16162,15944,48994,16237,48789,48910,16255
.short 16256,48949,0,16181,49024,16181,0,48949,49024,16198,48712,48881,16237,49013,16142,15817,16256,48981,16068,15944,48949,16251,49005,16142,49024,16226,48910,15817,16068,48966,16251,49013
.short 16256,49005,16181,48836,0,16068,48949,16237,49024,16245,48981,16162,48836,15817,15944,48881,16256,49019,16237,48981,16181,48910,16068,48712,49024,16255,49019,16245,49005,16226,48981,16198
.short 16256,0,49024,0,16256,0,49024,0,48949,16198,16142,48994,48836,16245,15944,49023,0,49019,16068,16213,48949,48910,16237,15944,16181,16113,49019,15817,16237,48930,48910,16245
.short 49024,16068,16181,49005,0,16237,48949,48836,16181,49013,15944,16198,49005,15817,16213,48994,0,16213,49005,15944,16181,49019,16068,16142,48949,48585,16213,49013,16068,16113,49019,16198
.short 16256,48949,0,16181,49024,16181,0,48949,48949,16255,48981,16021,16068,48994,16251,48930,0,48910,16237,49019,16181,48712,48836,16213,16181,48789,48712,16162,49005,16255,48981,16113
.short 49024,16237,48949,16068,0,48836,16181,49005,16181,48994,16251,49023,16237,48966,16142,48789,0,15944,48836,16142,48949,16213,49005,16251,48949,16162,48910,16113,48836,16021,48712,15817
.short 16256,0,49024,0,16256,0,49024,0,0,16255,48712,49013,16068,16226,48910,48966,49024,15944,16237,48910,48949,16213,16068,49019,0,49013,16142,16162,49005,48585,16251,48881
.short 16256,48836,48949,16237,0,49005,16181,16068,0,16226,48981,48585,16237,48966,48712,16245,49024,16142,16068,49019,16181,15944,49005,16213,0,48966,16251,48881,48836,16245,48981,15817
.short 16256,48949,0,16181,49024,16181,0,48949,0,16162,49019,16226,48836,48789,16213,49023,49024,16213,48836,48712,16181,49019,16237,48910,0,48881,16213,49023,16237,48930,15944,16021
.short 16256,49005,16181,48836,0,16068,48949,16237,0,16021,48910,16198,49005,16255,49019,16226,49024,16251,49005,16213,48949,16142,48836,15944,0,48585,15944,48789,16068,48881,16142,48930
.short 16256,0,49024,0,16256,0,49024,0,16181,16162,48981,48881,16237,16021,49019,48585,0,16251,48836,48981,16181,16142,49005,48712,48949,16226,15944,49023,16068,16198,48981,48789
.short 49024,16068,16181,49005,0,16237,48949,48836,48949,48789,16251,48930,48836,16255,48910,48881,0,48981,16237,48712,48949,16251,48836,48910,16181,49023,16142,16021,49005,16226,48712,48930
.short 16256,48949,0,16181,49024,16181,0,48949,16181,48585,48910,16245,49005,16113,15944,48966,0,16142,49005,16251,48949,15944,16068,48981,48949,16245,49019,16198,48836,48585,16142,48994
.short 49024,16237,48949,16068,0,48836,16181,49005,48949,16113,48712,48585,16068,48930,16213,49013,0,48712,16068,48910,16181,48981,16237,49019,16181,48966,16213,48994,16237,49013,16251,49023
.short 0,49024,0,16256,0,49024,0,16256,0,16255,48712,49013,16068,16226,48910,48966,0,49019,16068,16213,48949,48910,16237,15944,0,16245,48910,48930,16237,15817,49019,16113
.short 0,49005,16181,16068,49024,16068,16181,49005,0,16226,48981,48585,16237,48966,48712,16245,0,48981,16237,48712,48949,16251,48836,48910,0,16198,49019,16113,16068,49013,16213,48585
.short 0,48949,16256,48949,0,16181,49024,16181,0,16162,49019,16226,48836,48789,16213,49023,0,48910,16237,49019,16181,48712,48836,16213,0,16113,48981,16255,49005,16162,48712,48789
.short 0,48836,16181,49005,16256,49005,16181,48836,0,16021,48910,16198,49005,16255,49019,16226,0,48712,16068,48910,16181,48981,16237,49019,0,15817,48712,16021,48836,16113,48910,16162
.short 0,49024,0,16256,0,49024,0,16256,16181,16162,48981,48881,16237,16021,49019,48585,49024,15944,16237,48910,48949,16213,16068,49019,16181,48994,48712,16255,48836,48966,16213,16021
.short 0,16237,48949,48836,16256,48836,48949,16237,48949,48789,16251,48930,48836,16255,48910,48881,16256,48910,48836,16251,48949,48712,16237,48981,48949,16255,48910,48789,16237,48994,15944,16162
.short 0,48949,16256,48949,0,16181,49024,16181,16181,48585,48910,16245,49005,16113,15944,48966,49024,16213,48836,48712,16181,49019,16237,48910,16181,49013,16251,48966,16068,15817,48910,16226
.short 0,16068,48949,16237,49024,16237,48949,16068,48949,16113,48712,48585,16068,48930,16213,49013,16256,49019,16237,48981,16181,48910,16068,48712,48949,16198,48981,16226,49005,16245,49019,16255
.short 0,49024,0,16256,0,49024,0,16256,16256,48585,49019,16021,16237,48881,48981,16162,0,16251,48836,48981,16181,16142,49005,48712,49024,16021,16213,48966,48836,16255,48712,48994
.short 0,49005,16181,16068,49024,16068,16181,49005,16256,48881,48910,16255,48836,48930,16251,48789,0,16213,49005,15944,16181,49019,16068,16142,49024,16162,15944,48994,16237,48789,48910,16255
.short 0,48949,16256,48949,0,16181,49024,16181,16256,48966,15944,16113,49005,16245,48910,48585,0,16142,49005,16251,48949,15944,16068,48981,49024,16226,48910,15817,16068,48966,16251,49013
.short 0,48836,16181,49005,16256,49005,16181,48836,16256,49013,16213,48930,16068,48585,48712,16113,0,15944,48836,16142,48949,16213,49005,16251,49024,16255,49019,16245,49005,16226,48981,16198
.short 0,49024,0,16256,0,49024,0,16256,16181,48966,48910,16226,16068,49013,48712,16255,16256,48712,49005,16142,16181,48981,48836,16251,16181,16113,49019,15817,16237,48930,48910,16245
.short 0,16237,48949,48836,16256,48836,48949,16237,48949,16245,48712,48966,16237,48585,48981,16226,49024,16142,16068,49019,16181,15944,49005,16213,48949,48585,16213,49013,16068,16113,49019,16198
.short 0,48949,16256,48949,0,16181,49024,16181,16181,49023,16213,48789,48836,16226,49019,16162,16256,48981,16068,15944,48949,16251,49005,16142,16181,48789,48712,16162,49005,16255,48981,16113
.short 0,16068,48949,16237,49024,16237,48949,16068,48949,16226,49019,16255,49005,16198,48910,16021,49024,16251,49005,16213,48949,16142,48836,15944,48949,16162,48910,16113,48836,16021,48712,15817
.short 0,16256,0,49024,0,16256,0,49024,0,49023,15944,16245,48836,48994,16142,16198,0,16251,48836,48981,16181,16142,49005,48712,0,49013,16142,16162,49005,48585,16251,48881
.short 0,16237,48949,48836,16256,48836,48949,16237,0,48994,16213,15817,49005,16198,15944,49013,0,16213,49005,15944,16181,49019,16068,16142,0,48966,16251,48881,48836,16245,48981,15817
.short 0,16181,49024,16181,0,48949,16256,48949,0,48930,16251,48994,16068,16021,48981,16255,0,16142,49005,16251,48949,15944,16068,48981,0,48881,16213,49023,16237,48930,15944,16021
.short 0,16068,48949,16237,49024,16237,48949,16068,0,48789,16142,48966,16237,49023,16251,48994,0,15944,48836,16142,48949,16213,49005,16251,0,48585,15944,48789,16068,48881,16142,48930
.short 0,16256,0,49024,0,16256,0,49024,48949,48930,16213,16113,49005,48789,16251,15817,16256,48712,49005,16142,16181,48981,48836,16251,48949,16226,15944,49023,16068,16198,48981,48789
.short 0,49005,16181,16068,49024,16068,16181,49005,16181,16021,49019,16162,16068,49023,16142,16113,49024,16142,16068,49019,16181,15944,49005,16213,16181,49023,16142,16021,49005,16226,48712,48930
.short 0,16181,49024,16181,0,48949,16256,48949,48949,15817,16142,49013,16237,48881,48712,16198,16256,48981,16068,15944,48949,16251,49005,16142,48949,16245,49019,16198,48836,48585,16142,48994
.short 0,48836,16181,49005,16256,49005,16181,48836,16181,48881,15944,15817,48836,16162,48981,16245,49024,16251,49005,16213,48949,16142,48836,15944,16181,48966,16213,48994,16237,49013,16251,49023
.short 0,16256,0,49024,0,16256,0,49024,49024,15817,16251,48789,49005,16113,16213,48930,0,49019,16068,16213,48949,48910,16237,15944,16256,48789,48981,16198,16068,49023,15944,16226
.short 0,16237,48949,48836,16256,48836,48949,16237,49024,16113,16142,49023,16068,16162,49019,16021,0,48981,16237,48712,48949,16251,48836,48910,16256,48930,48712,16226,49005,16021,16142,49023
.short 0,16181,49024,16181,0,48949,16256,48949,49024,16198,48712,48881,16237,49013,16142,15817,0,48910,16237,49019,16181,48712,48836,16213,16256,48994,16142,48585,48836,16198,49019,16245
.short 0,16068,48949,16237,49024,16237,48949,16068,49024,16245,48981,16162,48836,15817,15944,48881,0,48712,16068,48910,16181,48981,16237,49019,16256,49023,16251,49013,16237,48994,16213,48966
.short 0,16256,0,49024,0,16256,0,49024,48949,16198,16142,48994,48836,16245,15944,49023,49024,15944,16237,48910,48949,16213,16068,49019,48949,48881,16251,48585,49005,16162,16142,49013
.short 0,49005,16181,16068,49024,16068,16181,49005,16181,49013,15944,16198,49005,15817,16213,48994,16256,48910,48836,16251,48949,48712,16237,48981,16181,15817,48981,16245,48836,48881,16251,48966
.short 0,16181,49024,16181,0,48949,16256,48949,48949,16255,48981,16021,16068,48994,16251,48930,49024,16213,48836,48712,16181,49019,16237,48910,48949,16021,15944,48930,16237,49023,16213,48881
.short 0,48836,16181,49005,16256,49005,16181,48836,16181,48994,16251,49023,16237,48966,16142,48789,16256,49019,16237,48981,16181,48910,16068,48712,16181,48930,16142,48881,16068,48789,15944,48585
.short 16256,49024,16256,49024,16256,49024,16256,49024,16256,49023,16251,49013,16237,48994,16213,48966,16256,49019,16237,48981,16181,48910,16068,48712,16256,49013,16213,48930,16068,48585,48712,16113
.short 16256,49005,16181,48836,0,16068,48949,16237,16256,48994,16142,48585,48836,16198,49019,16245,16256,48981,16068,15944,48949,16251,49005,16142,16256,48966,15944,16113,49005,16245,48910,48585
.short 16256,48949,0,16181,49024,16181,0,48949,16256,48930,48712,16226,49005,16021,16142,49023,16256,48910,48836,16251,48949,48712,16237,48981,16256,48881,48910,16255,48836,48930,16251,48789
.short 16256,48836,48949,16237,0,49005,16181,16068,16256,48789,48981,16198,16068,49023,15944,16226,16256,48712,49005,16142,16181,48981,48836,16251,16256,48585,49019,16021,16237,48881,48981,16162
.short 16256,49024,16256,49024,16256,49024,16256,49024,16181,48930,16142,48881,16068,48789,15944,48585,0,15944,48836,16142,48949,16213,49005,16251,48949,16226,49019,16255,49005,16198,48910,16021
.short 49024,16237,48949,16068,0,48836,16181,49005,48949,16021,15944,48930,16237,49023,16213,48881,0,48910,16237,49019,16181,48712,48836,16213,16181,49023,16213,48789,48836,16226,49019,16162
.short 16256,48949,0,16181,49024,16181,0,48949,16181,15817,48981,16245,48836,48881,16251,48966,0,16213,49005,15944,16181,49019,16068,16142,48949,16245,48712,48966,16237,48585,48981,16226
.short 49024,16068,16181,49005,0,16237,48949,48836,48949,48881,16251,48585,49005,16162,16142,49013,0,49019,16068,16213,48949,48910,16237,15944,16181,48966,48910,16226,16068,49013,48712,16255
.short 16256,49024,16256,49024,16256,49024,16256,49024,0,15817,48712,16021,48836,16113,48910,16162,49024,16251,49005,16213,48949,16142,48836,15944,0,48789,16142,48966,16237,49023,16251,48994
.short 16256,49005,16181,48836,0,16068,48949,16237,0,16113,48981,16255,49005,16162,48712,48789,49024,16213,48836,48712,16181,49019,16237,48910,0,48930,16251,48994,16068,16021,48981,16255
.short 16256,48949,0,16181,49024,16181,0,48949,0,16198,49019,16113,16068,49013,16213,48585,49024,16142,16068,49019,16181,15944,49005,16213,0,48994,16213,15817,49005,16198,15944,49013
.short 16256,48836,48949,16237,0,49005,16181,16068,0,16245,48910,48930,16237,15817,49019,16113,49024,15944,16237,48910,48949,16213,16068,49019,0,49023,15944,16245,48836,48994,16142,16198
.short 16256,49024,16256,49024,16256,49024,16256,49024,48949,16198,48981,16226,49005,16245,49019,16255,0,48712,16068,48910,16181,48981,16237,49019,16181,48881,15944,15817,48836,16162,48981,16245
.short 49024,16237,48949,16068,0,48836,16181,49005,16181,49013,16251,48966,16068,15817,48910,16226,0,16142,49005,16251,48949,15944,16068,48981,48949,15817,16142,49013,16237,48881,48712,16198
.short 16256,48949,0,16181,49024,16181,0,48949,48949,16255,48910,48789,16237,48994,15944,16162,0,48981,16237,48712,48949,16251,48836,48910,16181,16021,49019,16162,16068,49023,16142,16113
.short 49024,16068,16181,49005,0,16237,48949,48836,16181,48994,48712,16255,48836,48966,16213,16021,0,16251,48836,48981,16181,16142,49005,48712,48949,48930,16213,16113,49005,48789,16251,15817
.short 0,0,0,0,0,0,0,0,0,15817,48712,16021,48836,16113,48910,16162,0,15944,48836,16142,48949,16213,49005,16251,0,16021,48910,16198,49005,16255,49019,16226
.short 0,16068,48949,16237,49024,16237,48949,16068,0,16113,48981,16255,49005,16162,48712,48789,0,16142,49005,16251,48949,15944,16068,48981,0,16162,49019,16226,48836,48789,16213,49023
.short 0,16181,49024,16181,0,48949,16256,48949,0,16198,49019,16113,16068,49013,16213,48585,0,16213,49005,15944,16181,49019,16068,16142,0,16226,48981,48585,16237,48966,48712,16245
.short 0,16237,48949,48836,16256,48836,48949,16237,0,16245,48910,48930,16237,15817,49019,16113,0,16251,48836,48981,16181,16142,49005,48712,0,16255,48712,49013,16068,16226,48910,48966
.short 0,0,0,0,0,0,0,0,48949,16198,48981,16226,49005,16245,49019,16255,49024,16251,49005,16213,48949,16142,48836,15944,48949,16113,48712,48585,16068,48930,16213,49013
.short 0,48836,16181,49005,16256,49005,16181,48836,16181,49013,16251,48966,16068,15817,48910,16226,16256,48981,16068,15944,48949,16251,49005,16142,16181,48585,48910,16245,49005,16113,15944,48966
.short 0,16181,49024,16181,0,48949,16256,48949,48949,16255,48910,48789,16237,48994,15944,16162,49024,16142,16068,49019,16181,15944,49005,16213,48949,48789,16251,48930,48836,16255,48910,48881
.short 0,49005,16181,16068,49024,16068,16181,49005,16181,48994,48712,16255,48836,48966,16213,16021,16256,48712,49005,16142,16181,48981,48836,16251,16181,16162,48981,48881,16237,16021,49019,48585
.short 0,0,0,0,0,0,0,0,49024,16255,49019,16245,49005,16226,48981,16198,0,48712,16068,48910,16181,48981,16237,49019,16256,49013,16213,48930,16068,48585,48712,16113
.short 0,16068,48949,16237,49024,16237,48949,16068,49024,16226,48910,15817,16068,48966,16251,49013,0,48910,16237,49019,16181,48712,48836,16213,16256,48966,15944,16113,49005,16245,48910,48585
.short 0,16181,49024,16181,0,48949,16256,48949,49024,16162,15944,48994,16237,48789,48910,16255,0,48981,16237,48712,48949,16251,48836,48910,16256,48881,48910,16255,48836,48930,16251,48789
.short 0,16237,48949,48836,16256,48836,48949,16237,49024,16021,16213,48966,48836,16255,48712,48994,0,49019,16068,16213,48949,48910,16237,15944,16256,48585,49019,16021,16237,48881,48981,16162
.short 0,0,0,0,0,0,0,0,48949,16162,48910,16113,48836,16021,48712,15817,16256,49019,16237,48981,16181,48910,16068,48712,48949,16226,49019,16255,49005,16198,48910,16021
.short 0,48836,16181,49005,16256,49005,16181,48836,16181,48789,48712,16162,49005,16255,48981,16113,49024,16213,48836,48712,16181,49019,16237,48910,16181,49023,16213,48789,48836,16226,49019,16162
.short 0,16181,49024,16181,0,48949,16256,48949,48949,48585,16213,49013,16068,16113,49019,16198,16256,48910,48836,16251,48949,48712,16237,48981,48949,16245,48712,48966,16237,48585,48981,16226
.short 0,49005,16181,16068,49024,16068,16181,49005,16181,16113,49019,15817,16237,48930,48910,16245,49024,15944,16237,48910,48949,16213,16068,49019,16181,48966,48910,16226,16068,49013,48712,16255
.short 0,0,0,0,0,0,0,0,0,48585,15944,48789,16068,48881,16142,48930,0,48712,16068,48910,16181,48981,16237,49019,0,48789,16142,48966,16237,49023,16251,48994
.short 0,48836,16181,49005,16256,49005,16181,48836,0,48881,16213,49023,16237,48930,15944,16021,0,48910,16237,49019,16181,48712,48836,16213,0,48930,16251,48994,16068,16021,48981,16255
.short 0,48949,16256,48949,0,16181,49024,16181,0,48966,16251,48881,48836,16245,48981,15817,0,48981,16237,48712,48949,16251,48836,48910,0,48994,16213,15817,49005,16198,15944,49013
.short 0,49005,16181,16068,49024,16068,16181,49005,0,49013,16142,16162,49005,48585,16251,48881,0,49019,16068,16213,48949,48910,16237,15944,0,49023,15944,16245,48836,48994,16142,16198
.short 0,0,0,0,0,0,0,0,16181,48966,16213,48994,16237,49013,16251,49023,16256,49019,16237,48981,16181,48910,16068,48712,16181,48881,15944,15817,48836,16162,48981,16245
.short 0,16068,48949,16237,49024,16237,48949,16068,48949,16245,49019,16198,48836,48585,16142,48994,49024,16213,48836,48712,16181,49019,16237,48910,48949,15817,16142,49013,16237,48881,48712,16198
.short 0,48949,16256,48949,0,16181,49024,16181,16181,49023,16142,16021,49005,16226,48712,48930,16256,48910,48836,16251,48949,48712,16237,48981,16181,16021,49019,16162,16068,49023,16142,16113
.short 0,16237,48949,48836,16256,48836,48949,16237,48949,16226,15944,49023,16068,16198,48981,48789,49024,15944,16237,48910,48949,16213,16068,49019,48949,48930,16213,16113,49005,48789,16251,15817
.short 0,0,0,0,0,0,0,0,16256,49023,16251,49013,16237,48994,16213,48966,0,15944,48836,16142,48949,16213,49005,16251,49024,16245,48981,16162,48836,15817,15944,48881
.short 0,48836,16181,49005,16256,49005,16181,48836,16256,48994,16142,48585,48836,16198,49019,16245,0,16142,49005,16251,48949,15944,16068,48981,49024,16198,48712,48881,16237,49013,16142,15817
.short 0,48949,16256,48949,0,16181,49024,16181,16256,48930,48712,16226,49005,16021,16142,49023,0,16213,49005,15944,16181,49019,16068,16142,49024,16113,16142,49023,16068,16162,49019,16021
.short 0,49005,16181,16068,49024,16068,16181,49005,16256,48789,48981,16198,16068,49023,15944,16226,0,16251,48836,48981,16181,16142,49005,48712,49024,15817,16251,48789,49005,16113,16213,48930
.short 0,0,0,0,0,0,0,0,16181,48930,16142,48881,16068,48789,15944,48585,49024,16251,49005,16213,48949,16142,48836,15944,16181,48994,16251,49023,16237,48966,16142,48789
.short 0,16068,48949,16237,49024,16237,48949,16068,48949,16021,15944,48930,16237,49023,16213,48881,16256,48981,16068,15944,48949,16251,49005,16142,48949,16255,48981,16021,16068,48994,16251,48930
.short 0,48949,16256,48949,0,16181,49024,16181,16181,15817,48981,16245,48836,48881,16251,48966,49024,16142,16068,49019,16181,15944,49005,16213,16181,49013,15944,16198,49005,15817,16213,48994
.short 0,16237,48949,48836,16256,48836,48949,16237,48949,48881,16251,48585,49005,16162,16142,49013,16256,48712,49005,16142,16181,48981,48836,16251,48949,16198,16142,48994,48836,16245,15944,49023
.short 16256,49024,16256,49024,16256,49024,16256,49024,49024,16255,49019,16245,49005,16226,48981,16198,16256,49019,16237,48981,16181,48910,16068,48712,49024,16245,48981,16162,48836,15817,15944,48881
.short 16256,49005,16181,48836,0,16068,48949,16237,49024,16226,48910,15817,16068,48966,16251,49013,16256,48981,16068,15944,48949,16251,49005,16142,49024,16198,48712,48881,16237,49013,16142,15817
.short 16256,48949,0,16181,49024,16181,0,48949,49024,16162,15944,48994,16237,48789,48910,16255,16256,48910,48836,16251,48949,48712,16237,48981,49024,16113,16142,49023,16068,16162,49019,16021
.short 16256,48836,48949,16237,0,49005,16181,16068,49024,16021,16213,48966,48836,16255,48712,48994,16256,48712,49005,16142,16181,48981,48836,16251,49024,15817,16251,48789,49005,16113,16213,48930
.short 16256,49024,16256,49024,16256,49024,16256,49024,48949,16162,48910,16113,48836,16021,48712,15817,0,15944,48836,16142,48949,16213,49005,16251,16181,48994,16251,49023,16237,48966,16142,48789
.short 49024,16237,48949,16068,0,48836,16181,49005,16181,48789,48712,16162,49005,16255,48981,16113,0,48910,16237,49019,16181,48712,48836,16213,48949,16255,48981,16021,16068,48994,16251,48930
.short 16256,48949,0,16181,49024,16181,0,48949,48949,48585,16213,49013,16068,16113,49019,16198,0,16213,49005,15944,16181,49019,16068,16142,16181,49013,15944,16198,49005,15817,16213,48994
.short 49024,16068,16181,49005,0,16237,48949,48836,16181,16113,49019,15817,16237,48930,48910,16245,0,49019,16068,16213,48949,48910,16237,15944,48949,16198,16142,48994,48836,16245,15944,49023
.short 16256,49024,16256,49024,16256,49024,16256,49024,0,48585,15944,48789,16068,48881,16142,48930,49024,16251,49005,16213,48949,16142,48836,15944,0,16021,48910,16198,49005,16255,49019,16226
.short 16256,49005,16181,48836,0,16068,48949,16237,0,48881,16213,49023,16237,48930,15944,16021,49024,16213,48836,48712,16181,49019,16237,48910,0,16162,49019,16226,48836,48789,16213,49023
.short 16256,48949,0,16181,49024,16181,0,48949,0,48966,16251,48881,48836,16245,48981,15817,49024,16142,16068,49019,16181,15944,49005,16213,0,16226,48981,48585,16237,48966,48712,16245
.short 16256,48836,48949,16237,0,49005,16181,16068,0,49013,16142,16162,49005,48585,16251,48881,49024,15944,16237,48910,48949,16213,16068,49019,0,16255,48712,49013,16068,16226,48910,48966
.short 16256,49024,16256,49024,16256,49024,16256,49024,16181,48966,16213,48994,16237,49013,16251,49023,0,48712,16068,48910,16181,48981,16237,49019,48949,16113,48712,48585,16068,48930,16213,49013
.short 49024,16237,48949,16068,0,48836,16181,49005,48949,16245,49019,16198,48836,48585,16142,48994,0,16142,49005,16251,48949,15944,16068,48981,16181,48585,48910,16245,49005,16113,15944,48966
.short 16256,48949,0,16181,49024,16181,0,48949,16181,49023,16142,16021,49005,16226,48712,48930,0,48981,16237,48712,48949,16251,48836,48910,48949,48789,16251,48930,48836,16255,48910,48881
.short 49024,16068,16181,49005,0,16237,48949,48836,48949,16226,15944,49023,16068,16198,48981,48789,0,16251,48836,48981,16181,16142,49005,48712,16181,16162,48981,48881,16237,16021,49019,48585
.short 0,0,0,0,0,0,0,0,0,48585,15944,48789,16068,48881,16142,48930,0,15944,48836,16142,48949,16213,49005,16251,0,48789,16142,48966,16237,49023,16251,48994
.short 0,16068,48949,16237,49024,16237,48949,16068,0,48881,16213,49023,16237,48930,15944,16021,0,16142,49005,16251,48949,15944,16068,48981,0,48930,16251,48994,16068,16021,48981,16255
.short 0,16181,49024,16181,0,48949,16256,48949,0,48966,16251,48881,48836,16245,48981,15817,0,16213,49005,15944,16181,49019,16068,16142,0,48994,16213,15817,49005,16198,15944,49013
.short 0,16237,48949,48836,16256,48836,48949,16237,0,49013,16142,16162,49005,48585,16251,48881,0,16251,48836,48981,16181,16142,49005,48712,0,49023,15944,16245,48836,48994,16142,16198
.short 0,0,0,0,0,0,0,0,16181,48966,16213,48994,16237,49013,16251,49023,49024,16251,49005,16213,48949,16142,48836,15944,16181,48881,15944,15817,48836,16162,48981,16245
.short 0,48836,16181,49005,16256,49005,16181,48836,48949,16245,49019,16198,48836,48585,16142,48994,16256,48981,16068,15944,48949,16251,49005,16142,48949,15817,16142,49013,16237,48881,48712,16198
.short 0,16181,49024,16181,0,48949,16256,48949,16181,49023,16142,16021,49005,16226,48712,48930,49024,16142,16068,49019,16181,15944,49005,16213,16181,16021,49019,16162,16068,49023,16142,16113
.short 0,49005,16181,16068,49024,16068,16181,49005,48949,16226,15944,49023,16068,16198,48981,48789,16256,48712,49005,16142,16181,48981,48836,16251,48949,48930,16213,16113,49005,48789,16251,15817
.short 0,0,0,0,0,0,0,0,16256,49023,16251,49013,16237,48994,16213,48966,0,48712,16068,48910,16181,48981,16237,49019,49024,16245,48981,16162,48836,15817,15944,48881
.short 0,16068,48949,16237,49024,16237,48949,16068,16256,48994,16142,48585,48836,16198,49019,16245,0,48910,16237,49019,16181,48712,48836,16213,49024,16198,48712,48881,16237,49013,16142,15817
.short 0,16181,49024,16181,0,48949,16256,48949,16256,48930,48712,16226,49005,16021,16142,49023,0,48981,16237,48712,48949,16251,48836,48910,49024,16113,16142,49023,16068,16162,49019,16021
.short 0,16237,48949,48836,16256,48836,48949,16237,16256,48789,48981,16198,16068,49023,15944,16226,0,49019,16068,16213,48949,48910,16237,15944,49024,15817,16251,48789,49005,16113,16213,48930
.short 0,0,0,0,0,0,0,0,16181,48930,16142,48881,16068,48789,15944,48585,16256,49019,16237,48981,16181,48910,16068,48712,16181,48994,16251,49023,16237,48966,16142,48789
.short 0,48836,16181,49005,16256,49005,16181,48836,48949,16021,15944,48930,16237,49023,16213,48881,49024,16213,48836,48712,16181,49019,16237,48910,48949,16255,48981,16021,16068,48994,16251,48930
.short 0,16181,49024,16181,0,48949,16256,48949,16181,15817,48981,16245,48836,48881,16251,48966,16256,48910,48836,16251,48949,48712,16237,48981,16181,49013,15944,16198,49005,15817,16213,48994
.short 0,49005,16181,16068,49024,16068,16181,49005,48949,48881,16251,48585,49005,16162,16142,49013,49024,15944,16237,48910,48949,16213,16068,49019,48949,16198,16142,48994,48836,16245,15944,49023
.short 0,0,0,0,0,0,0,0,0,15817,48712,16021,48836,16113,48910,16162,0,48712,16068,48910,16181,48981,16237,49019,0,16021,48910,16198,49005,16255,49019,16226
.short 0,48836,16181,49005,16256,49005,16181,48836,0,16113,48981,16255,49005,16162,48712,48789,0,48910,16237,49019,16181,48712,48836,16213,0,16162,49019,16226,48836,48789,16213,49023
.short 0,48949,16256,48949,0,16181,49024,16181,0,16198,49019,16113,16068,49013,16213,48585,0,48981,16237,48712,48949,16251,48836,48910,0,16226,48981,48585,16237,48966,48712,16245
.short 0,49005,16181,16068,49024,16068,16181,49005,0,16245,48910,48930,16237,15817,49019,16113,0,49019,16068,16213,48949,48910,16237,15944,0,16255,48712,49013,16068,16226,48910,48966
.short 0,0,0,0,0,0,0,0,48949,16198,48981,16226,49005,16245,49019,16255,16256,49019,16237,48981,16181,48910,16068,48712,48949,16113,48712,48585,16068,48930,16213,49013
.short 0,16068,48949,16237,49024,16237,48949,16068,16181,49013,16251,48966,16068,15817,48910,16226,49024,16213,48836,48712,16181,49019,16237,48910,16181,48585,48910,16245,49005,16113,15944,48966
.short 0,48949,16256,48949,0,16181,49024,16181,48949,16255,48910,48789,16237,48994,15944,16162,16256,48910,48836,16251,48949,48712,16237,48981,48949,48789,16251,48930,48836,16255,48910,48881
.short 0,16237,48949,48836,16256,48836,48949,16237,16181,48994,48712,16255,48836,48966,16213,16021,49024,15944,16237,48910,48949,16213,16068,49019,16181,16162,48981,48881,16237,16021,49019,48585
.short 0,0,0,0,0,0,0,0,49024,16255,49019,16245,49005,16226,48981,16198,0,15944,48836,16142,48949,16213,49005,16251,16256,49013,16213,48930,16068,48585,48712,16113
.short 0,48836,16181,49005,16256,49005,16181,48836,49024,16226,48910,15817,16068,48966,16251,49013,0,16142,49005,16251,48949,15944,16068,48981,16256,48966,15944,16113,49005,16245,48910,48585
.short 0,48949,16256,48949,0,16181,49024,16181,49024,16162,15944,48994,16237,48789,48910,16255,0,16213,49005,15944,16181,49019,16068,16142,16256,48881,48910,16255,48836,48930,16251,48789
.short 0,49005,16181,16068,49024,16068,16181,49005,49024,16021,16213,48966,48836,16255,48712,48994,0,16251,48836,48981,16181,16142,49005,48712,16256,48585,49019,16021,16237,48881,48981,16162
.short 0,0,0,0,0,0,0,0,48949,16162,48910,16113,48836,16021,48712,15817,49024,16251,49005,16213,48949,16142,48836,15944,48949,16226,49019,16255,49005,16198,48910,16021
.short 0,16068,48949,16237,49024,16237,48949,16068,16181,48789,48712,16162,49005,16255,48981,16113,16256,48981,16068,15944,48949,16251,49005,16142,16181,49023,16213,48789,48836,16226,49019,16162
.short 0,48949,16256,48949,0,16181,49024,16181,48949,48585,16213,49013,16068,16113,49019,16198,49024,16142,16068,49019,16181,15944,49005,16213,48949,16245,48712,48966,16237,48585,48981,16226
.short 0,16237,48949,48836,16256,48836,48949,16237,16181,16113,49019,15817,16237,48930,48910,16245,16256,48712,49005,16142,16181,48981,48836,16251,16181,48966,48910,16226,16068,49013,48712,16255
.short 16256,0,49024,0,16256,0,49024,0,16256,15817,49019,48789,16237,16113,48981,48930,16256,15944,49005,48910,16181,16213,48836,49019,16256,16021,48981,48966,16068,16255,15944,48994
.short 16256,16068,48949,49005,0,16237,16181,48836,16256,16113,48910,49023,48836,16162,16251,16021,16256,16142,48836,49019,48949,15944,16237,16213,16256,16162,48712,48994,49005,48789,16142,16255
.short 16256,16181,0,48949,49024,48949,0,16181,16256,16198,15944,48881,49005,49013,48910,15817,16256,16213,16068,48712,48949,49019,49005,48910,16256,16226,16142,15817,48836,48966,49019,49013
.short 16256,16237,16181,16068,0,48836,48949,49005,16256,16245,16213,16162,16068,15817,48712,48881,16256,16251,16237,16213,16181,16142,16068,15944,16256,16255,16251,16245,16237,16226,16213,16198
.short 16256,0,49024,0,16256,0,49024,0,16181,16198,48910,48994,16068,16245,48712,49023,0,16251,16068,48981,48949,16142,16237,48712,48949,16113,16251,15817,49005,48930,16142,16245
.short 49024,48836,16181,16237,0,49005,48949,16068,48949,49013,48712,16198,16237,15817,48981,48994,0,48981,49005,48712,16181,16251,16068,48910,16181,48585,48981,49013,48836,16113,16251,16198
.short 16256,16181,0,48949,49024,48949,0,16181,16181,16255,16213,16021,48836,48994,49019,48930,0,16142,16237,16251,16181,15944,48836,48981,48949,48789,15944,16162,16237,16255,16213,16113
.short 49024,49005,48949,48836,0,16068,16181,16237,48949,48994,49019,49023,49005,48966,48910,48789,0,48712,48836,48910,48949,48981,49005,49019,16181,16162,16142,16113,16068,16021,15944,15817
.short 16256,0,49024,0,16256,0,49024,0,0,16255,15944,49013,48836,16226,16142,48966,49024,48712,16237,16142,48949,48981,16068,16251,0,49013,48910,16162,16237,48585,49019,48881
.short 16256,16068,48949,49005,0,16237,16181,48836,0,16226,16213,48585,49005,48966,15944,16245,49024,48910,16068,16251,16181,48712,49005,48981,0,48966,49019,48881,16068,16245,16213,15817
.short 16256,16181,0,48949,49024,48949,0,16181,0,16162,16251,16226,16068,48789,48981,49023,49024,48981,48836,15944,16181,16251,16237,16142,0,48881,48981,49023,49005,48930,48712,16021
.short 16256,16237,16181,16068,0,48836,48949,49005,0,16021,16142,16198,16237,16255,16251,16226,49024,49019,49005,48981,48949,48910,48836,48712,0,48585,48712,48789,48836,48881,48910,48930
.short 16256,0,49024,0,16256,0,49024,0,48949,16162,16213,48881,49005,16021,16251,48585,0,49019,48836,16213,16181,48910,49005,15944,16181,16226,48712,49023,48836,16198,16213,48789
.short 49024,48836,16181,16237,0,49005,48949,16068,16181,48789,49019,48930,16068,16255,16142,48881,0,16213,16237,15944,48949,49019,48836,16142,48949,49023,48910,16021,16237,16226,15944,48930
.short 16256,16181,0,48949,49024,48949,0,16181,48949,48585,16142,16245,16237,16113,48712,48966,0,48910,49005,49019,48949,48712,16068,16213,16181,16245,16251,16198,16068,48585,48910,48994
.short 49024,49005,48949,48836,0,16068,16181,16237,16181,16113,15944,48585,48836,48930,48981,49013,0,15944,16068,16142,16181,16213,16237,16251,48949,48966,48981,48994,49005,49013,49019,49023
.short 0,16256,0,49024,0,16256,0,49024,0,16255,15944,49013,48836,16226,16142,48966,0,16251,16068,48981,48949,16142,16237,48712,0,16245,16142,48930,49005,15817,16251,16113
.short 0,16237,16181,48836,49024,48836,16181,16237,0,16226,16213,48585,49005,48966,15944,16245,0,16213,16237,15944,48949,49019,48836,16142,0,16198,16251,16113,48836,49013,48981,48585
.short 0,16181,16256,16181,0,48949,49024,48949,0,16162,16251,16226,16068,48789,48981,49023,0,16142,16237,16251,16181,15944,48836,48981,0,16113,16213,16255,16237,16162,15944,48789
.short 0,16068,16181,16237,16256,16237,16181,16068,0,16021,16142,16198,16237,16255,16251,16226,0,15944,16068,16142,16181,16213,16237,16251,0,15817,15944,16021,16068,16113,16142,16162
.short 0,16256,0,49024,0,16256,0,49024,48949,16162,16213,48881,49005,16021,16251,48585,49024,48712,16237,16142,48949,48981,16068,16251,48949,48994,15944,16255,16068,48966,48981,16021
.short 0,49005,48949,16068,16256,16068,48949,49005,16181,48789,49019,48930,16068,16255,16142,48881,16256,16142,48836,49019,48949,15944,16237,16213,16181,16255,16142,48789,49005,48994,48712,16162
.short 0,16181,16256,16181,0,48949,49024,48949,48949,48585,16142,16245,16237,16113,48712,48966,49024,48981,48836,15944,16181,16251,16237,16142,48949,49013,49019,48966,48836,15817,16142,16226
.short 0,48836,48949,49005,49024,49005,48949,48836,16181,16113,15944,48585,48836,48930,48981,49013,16256,16251,16237,16213,16181,16142,16068,15944,16181,16198,16213,16226,16237,16245,16251,16255
.short 0,16256,0,49024,0,16256,0,49024,49024,48585,16251,16021,49005,48881,16213,16162,0,49019,48836,16213,16181,48910,49005,15944,16256,16021,48981,48966,16068,16255,15944,48994
.short 0,16237,16181,48836,49024,48836,16181,16237,49024,48881,16142,16255,16068,48930,49019,48789,0,48981,49005,48712,16181,16251,16068,48910,16256,16162,48712,48994,49005,48789,16142,16255
.short 0,16181,16256,16181,0,48949,49024,48949,49024,48966,48712,16113,16237,16245,16142,48585,0,48910,49005,49019,48949,48712,16068,16213,16256,16226,16142,15817,48836,48966,49019,49013
.short 0,16068,16181,16237,16256,16237,16181,16068,49024,49013,48981,48930,48836,48585,15944,16113,0,48712,48836,48910,48949,48981,49005,49019,16256,16255,16251,16245,16237,16226,16213,16198
.short 0,16256,0,49024,0,16256,0,49024,48949,48966,16142,16226,48836,49013,15944,16255,16256,15944,49005,48910,16181,16213,48836,49019,48949,16113,16251,15817,49005,48930,16142,16245
.short 0,49005,48949,16068,16256,16068,48949,49005,16181,16245,15944,48966,49005,48585,16213,16226,49024,48910,16068,16251,16181,48712,49005,48981,16181,48585,48981,49013,48836,16113,16251,16198
.short 0,16181,16256,16181,0,48949,49024,48949,48949,49023,48981,48789,16068,16226,16251,16162,16256,16213,16068,48712,48949,49019,49005,48910,48949,48789,15944,16162,16237,16255,16213,16113
.short 0,48836,48949,49005,49024,49005,48949,48836,16181,16226,16251,16255,16237,16198,16142,16021,49024,49019,49005,48981,48949,48910,48836,48712,16181,16162,16142,16113,16068,16021,15944,15817
.short 0,49024,0,16256,0,49024,0,16256,0,49023,48712,16245,16068,48994,48910,16198,0,49019,48836,16213,16181,48910,49005,15944,0,49013,48910,16162,16237,48585,49019,48881
.short 0,49005,48949,16068,16256,16068,48949,49005,0,48994,48981,15817,16237,16198,48712,49013,0,48981,49005,48712,16181,16251,16068,48910,0,48966,49019,48881,16068,16245,16213,15817
.short 0,48949,49024,48949,0,16181,16256,16181,0,48930,49019,48994,48836,16021,16213,16255,0,48910,49005,49019,48949,48712,16068,16213,0,48881,48981,49023,49005,48930,48712,16021
.short 0,48836,48949,49005,49024,49005,48949,48836,0,48789,48910,48966,49005,49023,49019,48994,0,48712,48836,48910,48949,48981,49005,49019,0,48585,48712,48789,48836,48881,48910,48930
.short 0,49024,0,16256,0,49024,0,16256,16181,48930,48981,16113,16237,48789,49019,15817,16256,15944,49005,48910,16181,16213,48836,49019,16181,16226,48712,49023,48836,16198,16213,48789
.short 0,16237,16181,48836,49024,48836,16181,16237,48949,16021,16251,16162,48836,49023,48910,16113,49024,48910,16068,16251,16181,48712,49005,48981,48949,49023,48910,16021,16237,16226,15944,48930
.short 0,48949,49024,48949,0,16181,16256,16181,16181,15817,48910,49013,49005,48881,15944,16198,16256,16213,16068,48712,48949,49019,49005,48910,16181,16245,16251,16198,16068,48585,48910,48994
.short 0,16068,16181,16237,16256,16237,16181,16068,48949,48881,48712,15817,16068,16162,16213,16245,49024,49019,49005,48981,48949,48910,48836,48712,48949,48966,48981,48994,49005,49013,49019,49023
.short 0,49024,0,16256,0,49024,0,16256,16256,15817,49019,48789,16237,16113,48981,48930,0,16251,16068,48981,48949,16142,16237,48712,49024,48789,16213,16198,48836,49023,48712,16226
.short 0,49005,48949,16068,16256,16068,48949,49005,16256,16113,48910,49023,48836,16162,16251,16021,0,16213,16237,15944,48949,49019,48836,16142,49024,48930,15944,16226,16237,16021,48910,49023
.short 0,48949,49024,48949,0,16181,16256,16181,16256,16198,15944,48881,49005,49013,48910,15817,0,16142,16237,16251,16181,15944,48836,48981,49024,48994,48910,48585,16068,16198,16251,16245
.short 0,48836,48949,49005,49024,49005,48949,48836,16256,16245,16213,16162,16068,15817,48712,48881,0,15944,16068,16142,16181,16213,16237,16251,49024,49023,49019,49013,49005,48994,48981,48966
.short 0,49024,0,16256,0,49024,0,16256,16181,16198,48910,48994,16068,16245,48712,49023,49024,48712,16237,16142,48949,48981,16068,16251,16181,48881,49019,48585,16237,16162,48910,49013
.short 0,16237,16181,48836,49024,48836,16181,16237,48949,49013,48712,16198,16237,15817,48981,48994,16256,16142,48836,49019,48949,15944,16237,16213,48949,15817,16213,16245,16068,48881,49019,48966
.short 0,48949,49024,48949,0,16181,16256,16181,16181,16255,16213,16021,48836,48994,49019,48930,49024,48981,48836,15944,16181,16251,16237,16142,16181,16021,48712,48930,49005,49023,48981,48881
.short 0,16068,16181,16237,16256,16237,16181,16068,48949,48994,49019,49023,49005,48966,48910,48789,16256,16251,16237,16213,16181,16142,16068,15944,48949,48930,48910,48881,48836,48789,48712,48585
.short 16256,0,49024,0,16256,0,49024,0,49024,48585,16251,16021,49005,48881,16213,16162,16256,15944,49005,48910,16181,16213,48836,49019,49024,48789,16213,16198,48836,49023,48712,16226
.short 16256,16068,48949,49005,0,16237,16181,48836,49024,48881,16142,16255,16068,48930,49019,48789,16256,16142,48836,49019,48949,15944,16237,16213,49024,48930,15944,16226,16237,16021,48910,49023
.short 16256,16181,0,48949,49024,48949,0,16181,49024,48966,48712,16113,16237,16245,16142,48585,16256,16213,16068,48712,48949,49019,49005,48910,49024,48994,48910,48585,16068,16198,16251,16245
.short 16256,16237,16181,16068,0,48836,48949,49005,49024,49013,48981,48930,48836,48585,15944,16113,16256,16251,16237,16213,16181,16142,16068,15944,49024,49023,49019,49013,49005,48994,48981,48966
.short 16256,0,49024,0,16256,0,49024,0,48949,48966,16142,16226,48836,49013,15944,16255,0,16251,16068,48981,48949,16142,16237,48712,16181,48881,49019,48585,16237,16162,48910,49013
.short 49024,48836,16181,16237,0,49005,48949,16068,16181,16245,15944,48966,49005,48585,16213,16226,0,48981,49005,48712,16181,16251,16068,48910,48949,15817,16213,16245,16068,48881,49019,48966
.short 16256,16181,0,48949,49024,48949,0,16181,48949,49023,48981,48789,16068,16226,16251,16162,0,16142,16237,16251,16181,15944,48836,48981,16181,16021,48712,48930,49005,49023,48981,48881
.short 49024,49005,48949,48836,0,16068,16181,16237,16181,16226,16251,16255,16237,16198,16142,16021,0,48712,48836,48910,48949,48981,49005,49019,48949,48930,48910,48881,48836,48789,48712,48585
.short 16256,0,49024,0,16256,0,49024,0,0,49023,48712,16245,16068,48994,48910,16198,49024,48712,16237,16142,48949,48981,16068,16251,0,16245,16142,48930,49005,15817,16251,16113
.short 16256,16068,48949,49005,0,16237,16181,48836,0,48994,48981,15817,16237,16198,48712,49013,49024,48910,16068,16251,16181,48712,49005,48981,0,16198,16251,16113,48836,49013,48981,48585
.short 16256,16181,0,48949,49024,48949,0,16181,0,48930,49019,48994,48836,16021,16213,16255,49024,48981,48836,15944,16181,16251,16237,16142,0,16113,16213,16255,16237,16162,15944,48789
.short 16256,16237,16181,16068,0,48836,48949,49005,0,48789,48910,48966,49005,49023,49019,48994,49024,49019,49005,48981,48949,48910,48836,48712,0,15817,15944,16021,16068,16113,16142,16162
.short 16256,0,49024,0,16256,0,49024,0,16181,48930,48981,16113,16237,48789,49019,15817,0,49019,48836,16213,16181,48910,49005,15944,48949,48994,15944,16255,16068,48966,48981,16021
.short 49024,48836,16181,16237,0,49005,48949,16068,48949,16021,16251,16162,48836,49023,48910,16113,0,16213,16237,15944,48949,49019,48836,16142,16181,16255,16142,48789,49005,48994,48712,16162
.short 16256,16181,0,48949,49024,48949,0,16181,16181,15817,48910,49013,49005,48881,15944,16198,0,48910,49005,49019,48949,48712,16068,16213,48949,49013,49019,48966,48836,15817,16142,16226
.short 49024,49005,48949,48836,0,16068,16181,16237,48949,48881,48712,15817,16068,16162,16213,16245,0,15944,16068,16142,16181,16213,16237,16251,16181,16198,16213,16226,16237,16245,16251,16255
.short 0,16256,0,49024,0,16256,0,49024,0,49023,48712,16245,16068,48994,48910,16198,0,16251,16068,48981,48949,16142,16237,48712,0,49013,48910,16162,16237,48585,49019,48881
.short 0,16237,16181,48836,49024,48836,16181,16237,0,48994,48981,15817,16237,16198,48712,49013,0,16213,16237,15944,48949,49019,48836,16142,0,48966,49019,48881,16068,16245,16213,15817
.short 0,16181,16256,16181,0,48949,49024,48949,0,48930,49019,48994,48836,16021,16213,16255,0,16142,16237,16251,16181,15944,48836,48981,0,48881,48981,49023,49005,48930,48712,16021
.short 0,16068,16181,16237,16256,16237,16181,16068,0,48789,48910,48966,49005,49023,49019,48994,0,15944,16068,16142,16181,16213,16237,16251,0,48585,48712,48789,48836,48881,48910,48930
.short 0,16256,0,49024,0,16256,0,49024,16181,48930,48981,16113,16237,48789,49019,15817,49024,48712,16237,16142,48949,48981,16068,16251,16181,16226,48712,49023,48836,16198,16213,48789
.short 0,49005,48949,16068,16256,16068,48949,49005,48949,16021,16251,16162,48836,49023,48910,16113,16256,16142,48836,49019,48949,15944,16237,16213,48949,49023,48910,16021,16237,16226,15944,48930
.short 0,16181,16256,16181,0,48949,49024,48949,16181,15817,48910,49013,49005,48881,15944,16198,49024,48981,48836,15944,16181,16251,16237,16142,16181,16245,16251,16198,16068,48585,48910,48994
.short 0,48836,48949,49005,49024,49005,48949,48836,48949,48881,48712,15817,16068,16162,16213,16245,16256,16251,16237,16213,16181,16142,16068,15944,48949,48966,48981,48994,49005,49013,49019,49023
.short 0,16256,0,49024,0,16256,0,49024,16256,15817,49019,48789,16237,16113,48981,48930,0,49019,48836,16213,16181,48910,49005,15944,49024,48789,16213,16198,48836,49023,48712,16226
.short 0,16237,16181,48836,49024,48836,16181,16237,16256,16113,48910,49023,48836,16162,16251,16021,0,48981,49005,48712,16181,16251,16068,48910,49024,48930,15944,16226,16237,16021,48910,49023
.short 0,16181,16256,16181,0,48949,49024,48949,16256,16198,15944,48881,49005,49013,48910,15817,0,48910,49005,49019,48949,48712,16068,16213,49024,48994,48910,48585,16068,16198,16251,16245
.short 0,16068,16181,16237,16256,16237,16181,16068,16256,16245,16213,16162,16068,15817,48712,48881,0,48712,48836,48910,48949,48981,49005,49019,49024,49023,49019,49013,49005,48994,48981,48966
.short 0,16256,0,49024,0,16256,0,49024,16181,16198,48910,48994,16068,16245,48712,49023,16256,15944,49005,48910,16181,16213,48836,49019,16181,48881,49019,48585,16237,16162,48910,49013
.short 0,49005,48949,16068,16256,16068,48949,49005,48949,49013,48712,16198,16237,15817,48981,48994,49024,48910,16068,16251,16181,48712,49005,48981,48949,15817,16213,16245,16068,48881,49019,48966
.short 0,16181,16256,16181,0,48949,49024,48949,16181,16255,16213,16021,48836,48994,49019,48930,16256,16213,16068,48712,48949,49019,49005,48910,16181,16021,48712,48930,49005,49023,48981,48881
.short 0,48836,48949,49005,49024,49005,48949,48836,48949,48994,49019,49023,49005,48966,48910,48789,49024,49019,49005,48981,48949,48910,48836,48712,48949,48930,48910,48881,48836,48789,48712,48585
.short 0,49024,0,16256,0,49024,0,16256,0,16255,15944,49013,48836,16226,16142,48966,0,49019,48836,16213,16181,48910,49005,15944,0,16245,16142,48930,49005,15817,16251,16113
.short 0,49005,48949,16068,16256,16068,48949,49005,0,16226,16213,48585,49005,48966,15944,16245,0,48981,49005,48712,16181,16251,16068,48910,0,16198,16251,16113,48836,49013,48981,48585
.short 0,48949,49024,48949,0,16181,16256,16181,0,16162,16251,16226,16068,48789,48981,49023,0,48910,49005,49019,48949,48712,16068,16213,0,16113,16213,16255,16237,16162,15944,48789
.short 0,48836,48949,49005,49024,49005,48949,48836,0,16021,16142,16198,16237,16255,16251,16226,0,48712,48836,48910,48949,48981,49005,49019,0,15817,15944,16021,16068,16113,16142,16162
.short 0,49024,0,16256,0,49024,0,16256,48949,16162,16213,48881,49005,16021,16251,48585,16256,15944,49005,48910,16181,16213,48836,49019,48949,48994,15944,16255,16068,48966,48981,16021
.short 0,16237,16181,48836,49024,48836,16181,16237,16181,48789,49019,48930,16068,16255,16142,48881,49024,48910,16068,16251,16181,48712,49005,48981,16181,16255,16142,48789,49005,48994,48712,16162
.short 0,48949,49024,48949,0,16181,16256,16181,48949,48585,16142,16245,16237,16113,48712,48966,16256,16213,16068,48712,48949,49019,49005,48910,48949,49013,49019,48966,48836,15817,16142,16226
.short 0,16068,16181,16237,16256,16237,16181,16068,16181,16113,15944,48585,48836,48930,48981,49013,49024,49019,49005,48981,48949,48910,48836,48712,16181,16198,16213,16226,16237,16245,16251,16255
.short 0,49024,0,16256,0,49024,0,16256,49024,48585,16251,16021,49005,48881,16213,16162,0,16251,16068,48981,48949,16142,16237,48712,16256,16021,48981,48966,16068,16255,15944,48994
.short 0,49005,48949,16068,16256,16068,48949,49005,49024,48881,16142,16255,16068,48930,49019,48789,0,16213,16237,15944,48949,49019,48836,16142,16256,16162,48712,48994,49005,48789,16142,16255
.short 0,48949,49024,48949,0,16181,16256,16181,49024,48966,48712,16113,16237,16245,16142,48585,0,16142,16237,16251,16181,15944,48836,48981,16256,16226,16142,15817,48836,48966,49019,49013
.short 0,48836,48949,49005,49024,49005,48949,48836,49024,49013,48981,48930,48836,48585,15944,16113,0,15944,16068,16142,16181,16213,16237,16251,16256,16255,16251,16245,16237,16226,16213,16198
.short 0,49024,0,16256,0,49024,0,16256,48949,48966,16142,16226,48836,49013,15944,16255,49024,48712,16237,16142,48949,48981,16068,16251,48949,16113,16251,15817,49005,48930,16142,16245
.short 0,16237,16181,48836,49024,48836,16181,16237,16181,16245,15944,48966,49005,48585,16213,16226,16256,16142,48836,49019,48949,15944,16237,16213,16181,48585,48981,49013,48836,16113,16251,16198
.short 0,48949,49024,48949,0,16181,16256,16181,48949,49023,48981,48789,16068,16226,16251,16162,49024,48981,48836,15944,16181,16251,16237,16142,48949,48789,15944,16162,16237,16255,16213,16113
.short 0,16068,16181,16237,16256,16237,16181,16068,16181,16226,16251,16255,16237,16198,16142,16021,16256,16251,16237,16213,16181,16142,16068,15944,16181,16162,16142,16113,16068,16021,15944,15817
.short 16256,16256,16256,16256,16256,16256,16256,16256,16256,16251,16237,16213,49024,49019,49005,48981,16256,16237,16181,16068,16256,16237,16181,16068,16256,16213,16068,48712,49024,48981,48836,15944
.short 16256,16181,0,48949,16256,16181,0,48949,16256,16142,48836,49019,49024,48910,16068,16251,16256,16068,48949,49005,16256,16068,48949,49005,16256,15944,49005,48910,49024,48712,16237,16142
.short 16256,0,49024,0,16256,0,49024,0,16256,48712,49005,16142,49024,15944,16237,48910,16256,48836,48949,16237,16256,48836,48949,16237,16256,48910,48836,16251,49024,16142,16068,49019
.short 16256,48949,0,16181,16256,48949,0,16181,16256,48981,16068,15944,49024,16213,48836,48712,16256,49005,16181,48836,16256,49005,16181,48836,16256,49019,16237,48981,49024,16251,49005,16213
.short 16256,16256,16256,16256,16256,16256,16256,16256,16181,16142,16068,15944,48949,48910,48836,48712,0,48836,48949,49005,0,48836,48949,49005,48949,49019,49005,48910,16181,16251,16237,16142
.short 49024,48949,0,16181,49024,48949,0,16181,48949,15944,16237,16213,16181,48712,49005,48981,0,16237,16181,48836,0,16237,16181,48836,16181,16213,48836,49019,48949,48981,16068,16251
.short 16256,0,49024,0,16256,0,49024,0,16181,48981,48836,16251,48949,16213,16068,49019,0,49005,16181,16068,0,49005,16181,16068,48949,48712,16237,48981,16181,15944,49005,16213
.short 49024,16181,0,48949,49024,16181,0,48949,48949,16251,49005,16142,16181,49019,16237,48910,0,16068,48949,16237,0,16068,48949,16237,16181,48910,16068,48712,48949,16142,48836,15944
.short 16256,16256,16256,16256,16256,16256,16256,16256,0,48712,48836,48910,0,15944,16068,16142,49024,49005,48949,48836,49024,49005,48949,48836,0,16142,16237,16251,0,48910,49005,49019
.short 16256,16181,0,48949,16256,16181,0,48949,0,48981,49005,48712,0,16213,16237,15944,49024,48836,16181,16237,49024,48836,16181,16237,0,16251,16068,48981,0,49019,48836,16213
.short 16256,0,49024,0,16256,0,49024,0,0,49019,16068,16213,0,16251,48836,48981,49024,16068,16181,49005,49024,16068,16181,49005,0,16213,49005,15944,0,48981,16237,48712
.short 16256,48949,0,16181,16256,48949,0,16181,0,48910,16237,49019,0,16142,49005,16251,49024,16237,48949,16068,49024,16237,48949,16068,0,15944,48836,16142,0,48712,16068,48910
.short 16256,16256,16256,16256,16256,16256,16256,16256,48949,48981,49005,49019,16181,16213,16237,16251,0,16068,16181,16237,0,16068,16181,16237,16181,15944,48836,48981,48949,48712,16068,16213
.short 49024,48949,0,16181,49024,48949,0,16181,16181,16251,16068,48910,48949,49019,48836,16142,0,49005,48949,16068,0,49005,48949,16068,48949,16142,16237,48712,16181,48910,49005,15944
.short 16256,0,49024,0,16256,0,49024,0,48949,48910,16237,15944,16181,16142,49005,48712,0,16237,48949,48836,0,16237,48949,48836,16181,49019,16068,16142,48949,16251,48836,48910
.short 49024,16181,0,48949,49024,16181,0,48949,16181,48712,48836,16213,48949,15944,16068,48981,0,48836,16181,49005,0,48836,16181,49005,48949,16213,49005,16251,16181,48981,16237,49019
.short 0,0,0,0,0,0,0,0,0,48712,48836,48910,0,15944,16068,16142,0,48836,48949,49005,0,48836,48949,49005,0,48910,49005,49019,0,16142,16237,16251
.short 0,48949,49024,48949,0,48949,49024,48949,0,48981,49005,48712,0,16213,16237,15944,0,49005,48949,16068,0,49005,48949,16068,0,49019,48836,16213,0,16251,16068,48981
.short 0,49024,0,16256,0,49024,0,16256,0,49019,16068,16213,0,16251,48836,48981,0,49005,16181,16068,0,49005,16181,16068,0,48981,16237,48712,0,16213,49005,15944
.short 0,48949,16256,48949,0,48949,16256,48949,0,48910,16237,49019,0,16142,49005,16251,0,48836,16181,49005,0,48836,16181,49005,0,48712,16068,48910,0,15944,48836,16142
.short 0,0,0,0,0,0,0,0,48949,48981,49005,49019,16181,16213,16237,16251,49024,49005,48949,48836,49024,49005,48949,48836,48949,48712,16068,16213,16181,15944,48836,48981
.short 0,16181,16256,16181,0,16181,16256,16181,16181,16251,16068,48910,48949,49019,48836,16142,16256,16068,48949,49005,16256,16068,48949,49005,16181,48910,49005,15944,48949,16142,16237,48712
.short 0,49024,0,16256,0,49024,0,16256,48949,48910,16237,15944,16181,16142,49005,48712,49024,16068,16181,49005,49024,16068,16181,49005,48949,16251,48836,48910,16181,49019,16068,16142
.short 0,16181,49024,16181,0,16181,49024,16181,16181,48712,48836,16213,48949,15944,16068,48981,16256,49005,16181,48836,16256,49005,16181,48836,16181,48981,16237,49019,48949,16213,49005,16251
.short 0,0,0,0,0,0,0,0,49024,49019,49005,48981,16256,16251,16237,16213,0,16068,16181,16237,0,16068,16181,16237,16256,16213,16068,48712,49024,48981,48836,15944
.short 0,48949,49024,48949,0,48949,49024,48949,49024,48910,16068,16251,16256,16142,48836,49019,0,16237,16181,48836,0,16237,16181,48836,16256,15944,49005,48910,49024,48712,16237,16142
.short 0,49024,0,16256,0,49024,0,16256,49024,15944,16237,48910,16256,48712,49005,16142,0,16237,48949,48836,0,16237,48949,48836,16256,48910,48836,16251,49024,16142,16068,49019
.short 0,48949,16256,48949,0,48949,16256,48949,49024,16213,48836,48712,16256,48981,16068,15944,0,16068,48949,16237,0,16068,48949,16237,16256,49019,16237,48981,49024,16251,49005,16213
.short 0,0,0,0,0,0,0,0,48949,48910,48836,48712,16181,16142,16068,15944,16256,16237,16181,16068,16256,16237,16181,16068,48949,49019,49005,48910,16181,16251,16237,16142
.short 0,16181,16256,16181,0,16181,16256,16181,16181,48712,49005,48981,48949,15944,16237,16213,49024,48836,16181,16237,49024,48836,16181,16237,16181,16213,48836,49019,48949,48981,16068,16251
.short 0,49024,0,16256,0,49024,0,16256,48949,16213,16068,49019,16181,48981,48836,16251,16256,48836,48949,16237,16256,48836,48949,16237,48949,48712,16237,48981,16181,15944,49005,16213
.short 0,16181,49024,16181,0,16181,49024,16181,16181,49019,16237,48910,48949,16251,49005,16142,49024,16237,48949,16068,49024,16237,48949,16068,16181,48910,16068,48712,48949,16142,48836,15944
.short 0,0,0,0,0,0,0,0,0,15944,16068,16142,0,48712,48836,48910,0,16068,16181,16237,0,16068,16181,16237,0,16142,16237,16251,0,48910,49005,49019
.short 0,16181,16256,16181,0,16181,16256,16181,0,16213,16237,15944,0,48981,49005,48712,0,16237,16181,48836,0,16237,16181,48836,0,16251,16068,48981,0,49019,48836,16213
.short 0,16256,0,49024,0,16256,0,49024,0,16251,48836,48981,0,49019,16068,16213,0,16237,48949,48836,0,16237,48949,48836,0,16213,49005,15944,0,48981,16237,48712
.short 0,16181,49024,16181,0,16181,49024,16181,0,16142,49005,16251,0,48910,16237,49019,0,16068,48949,16237,0,16068,48949,16237,0,15944,48836,16142,0,48712,16068,48910
.short 0,0,0,0,0,0,0,0,16181,16213,16237,16251,48949,48981,49005,49019,16256,16237,16181,16068,16256,16237,16181,16068,16181,15944,48836,48981,48949,48712,16068,16213
.short 0,48949,49024,48949,0,48949,49024,48949,48949,49019,48836,16142,16181,16251,16068,48910,49024,48836,16181,16237,49024,48836,16181,16237,48949,16142,16237,48712,16181,48910,49005,15944
.short 0,16256,0,49024,0,16256,0,49024,16181,16142,49005,48712,48949,48910,16237,15944,16256,48836,48949,16237,16256,48836,48949,16237,16181,49019,16068,16142,48949,16251,48836,48910
.short 0,48949,16256,48949,0,48949,16256,48949,48949,15944,16068,48981,16181,48712,48836,16213,49024,16237,48949,16068,49024,16237,48949,16068,48949,16213,49005,16251,16181,48981,16237,49019
.short 0,0,0,0,0,0,0,0,16256,16251,16237,16213,49024,49019,49005,48981,0,48836,48949,49005,0,48836,48949,49005,49024,48981,48836,15944,16256,16213,16068,48712
.short 0,16181,16256,16181,0,16181,16256,16181,16256,16142,48836,49019,49024,48910,16068,16251,0,49005,48949,16068,0,49005,48949,16068,49024,48712,16237,16142,16256,15944,49005,48910
.short 0,16256,0,49024,0,16256,0,49024,16256,48712,49005,16142,49024,15944,16237,48910,0,49005,16181,16068,0,49005,16181,16068,49024,16142,16068,49019,16256,48910,48836,16251
.short 0,16181,49024,16181,0,16181,49024,16181,16256,48981,16068,15944,49024,16213,48836,48712,0,48836,16181,49005,0,48836,16181,49005,49024,16251,49005,16213,16256,49019,16237,48981
.short 0,0,0,0,0,0,0,0,16181,16142,16068,15944,48949,48910,48836,48712,49024,49005,48949,48836,49024,49005,48949,48836,16181,16251,16237,16142,48949,49019,49005,48910
.short 0,48949,49024,48949,0,48949,49024,48949,48949,15944,16237,16213,16181,48712,49005,48981,16256,16068,48949,49005,16256,16068,48949,49005,48949,48981,16068,16251,16181,16213,48836,49019
.short 0,16256,0,49024,0,16256,0,49024,16181,48981,48836,16251,48949,16213,16068,49019,49024,16068,16181,49005,49024,16068,16181,49005,16181,15944,49005,16213,48949,48712,16237,48981
.short 0,48949,16256,48949,0,48949,16256,48949,48949,16251,49005,16142,16181,49019,16237,48910,16256,49005,16181,48836,16256,49005,16181,48836,48949,16142,48836,15944,16181,48910,16068,48712
.short 16256,49024,16256,49024,16256,49024,16256,49024,16256,49019,16237,48981,49024,16251,49005,16213,16256,49005,16181,48836,16256,49005,16181,48836,16256,48981,16068,15944,49024,16213,48836,48712
.short 16256,48949,0,16181,16256,48949,0,16181,16256,48910,48836,16251,49024,16142,16068,49019,16256,48836,48949,16237,16256,48836,48949,16237,16256,48712,49005,16142,49024,15944,16237,48910
.short 16256,0,49024,0,16256,0,49024,0,16256,15944,49005,48910,49024,48712,16237,16142,16256,16068,48949,49005,16256,16068,48949,49005,16256,16142,48836,49019,49024,48910,16068,16251
.short 16256,16181,0,48949,16256,16181,0,48949,16256,16213,16068,48712,49024,48981,48836,15944,16256,16237,16181,16068,16256,16237,16181,16068,16256,16251,16237,16213,49024,49019,49005,48981
.short 16256,49024,16256,49024,16256,49024,16256,49024,16181,48910,16068,48712,48949,16142,48836,15944,0,16068,48949,16237,0,16068,48949,16237,48949,16251,49005,16142,16181,49019,16237,48910
.short 49024,16181,0,48949,49024,16181,0,48949,48949,48712,16237,48981,16181,15944,49005,16213,0,49005,16181,16068,0,49005,16181,16068,16181,48981,48836,16251,48949,16213,16068,49019
.short 16256,0,49024,0,16256,0,49024,0,16181,16213,48836,49019,48949,48981,16068,16251,0,16237,16181,48836,0,16237,16181,48836,48949,15944,16237,16213,16181,48712,49005,48981
.short 49024,48949,0,16181,49024,48949,0,16181,48949,49019,49005,48910,16181,16251,16237,16142,0,48836,48949,49005,0,48836,48949,49005,16181,16142,16068,15944,48949,48910,48836,48712
.short 16256,49024,16256,49024,16256,49024,16256,49024,0,15944,48836,16142,0,48712,16068,48910,49024,16237,48949,16068,49024,16237,48949,16068,0,48910,16237,49019,0,16142,49005,16251
.short 16256,48949,0,16181,16256,48949,0,16181,0,16213,49005,15944,0,48981,16237,48712,49024,16068,16181,49005,49024,16068,16181,49005,0,49019,16068,16213,0,16251,48836,48981
.short 16256,0,49024,0,16256,0,49024,0,0,16251,16068,48981,0,49019,48836,16213,49024,48836,16181,16237,49024,48836,16181,16237,0,48981,49005,48712,0,16213,16237,15944
.short 16256,16181,0,48949,16256,16181,0,48949,0,16142,16237,16251,0,48910,49005,49019,49024,49005,48949,48836,49024,49005,48949,48836,0,48712,48836,48910,0,15944,16068,16142
.short 16256,49024,16256,49024,16256,49024,16256,49024,48949,16213,49005,16251,16181,48981,16237,49019,0,48836,16181,49005,0,48836,16181,49005,16181,48712,48836,16213,48949,15944,16068,48981
.short 49024,16181,0,48949,49024,16181,0,48949,16181,49019,16068,16142,48949,16251,48836,48910,0,16237,48949,48836,0,16237,48949,48836,48949,48910,16237,15944,16181,16142,49005,48712
.short 16256,0,49024,0,16256,0,49024,0,48949,16142,16237,48712,16181,48910,49005,15944,0,49005,48949,16068,0,49005,48949,16068,16181,16251,16068,48910,48949,49019,48836,16142
.short 49024,48949,0,16181,49024,48949,0,16181,16181,15944,48836,48981,48949,48712,16068,16213,0,16068,16181,16237,0,16068,16181,16237,48949,48981,49005,49019,16181,16213,16237,16251
.short 0,0,0,0,0,0,0,0,0,15944,48836,16142,0,48712,16068,48910,0,16068,48949,16237,0,16068,48949,16237,0,16142,49005,16251,0,48910,16237,49019
.short 0,16181,49024,16181,0,16181,49024,16181,0,16213,49005,15944,0,48981,16237,48712,0,16237,48949,48836,0,16237,48949,48836,0,16251,48836,48981,0,49019,16068,16213
.short 0,16256,0,49024,0,16256,0,49024,0,16251,16068,48981,0,49019,48836,16213,0,16237,16181,48836,0,16237,16181,48836,0,16213,16237,15944,0,48981,49005,48712
.short 0,16181,16256,16181,0,16181,16256,16181,0,16142,16237,16251,0,48910,49005,49019,0,16068,16181,16237,0,16068,16181,16237,0,15944,16068,16142,0,48712,48836,48910
.short 0,0,0,0,0,0,0,0,48949,16213,49005,16251,16181,48981,16237,49019,49024,16237,48949,16068,49024,16237,48949,16068,48949,15944,16068,48981,16181,48712,48836,16213
.short 0,48949,16256,48949,0,48949,16256,48949,16181,49019,16068,16142,48949,16251,48836,48910,16256,48836,48949,16237,16256,48836,48949,16237,16181,16142,49005,48712,48949,48910,16237,15944
.short 0,16256,0,49024,0,16256,0,49024,48949,16142,16237,48712,16181,48910,49005,15944,49024,48836,16181,16237,49024,48836,16181,16237,48949,49019,48836,16142,16181,16251,16068,48910
.short 0,48949,49024,48949,0,48949,49024,48949,16181,15944,48836,48981,48949,48712,16068,16213,16256,16237,16181,16068,16256,16237,16181,16068,16181,16213,16237,16251,48949,48981,49005,49019
.short 0,0,0,0,0,0,0,0,49024,16251,49005,16213,16256,49019,16237,48981,0,48836,16181,49005,0,48836,16181,49005,16256,48981,16068,15944,49024,16213,48836,48712
.short 0,16181,49024,16181,0,16181,49024,16181,49024,16142,16068,49019,16256,48910,48836,16251,0,49005,16181,16068,0,49005,16181,16068,16256,48712,49005,16142,49024,15944,16237,48910
.short 0,16256,0,49024,0,16256,0,49024,49024,48712,16237,16142,16256,15944,49005,48910,0,49005,48949,16068,0,49005,48949,16068,16256,16142,48836,49019,49024,48910,16068,16251
.short 0,16181,16256,16181,0,16181,16256,16181,49024,48981,48836,15944,16256,16213,16068,48712,0,48836,48949,49005,0,48836,48949,49005,16256,16251,16237,16213,49024,49019,49005,48981
.short 0,0,0,0,0,0,0,0,48949,16142,48836,15944,16181,48910,16068,48712,16256,49005,16181,48836,16256,49005,16181,48836,48949,16251,49005,16142,16181,49019,16237,48910
.short 0,48949,16256,48949,0,48949,16256,48949,16181,15944,49005,16213,48949,48712,16237,48981,49024,16068,16181,49005,49024,16068,16181,49005,16181,48981,48836,16251,48949,16213,16068,49019
.short 0,16256,0,49024,0,16256,0,49024,48949,48981,16068,16251,16181,16213,48836,49019,16256,16068,48949,49005,16256,16068,48949,49005,48949,15944,16237,16213,16181,48712,49005,48981
.short 0,48949,49024,48949,0,48949,49024,48949,16181,16251,16237,16142,48949,49019,49005,48910,49024,49005,48949,48836,49024,49005,48949,48836,16181,16142,16068,15944,48949,48910,48836,48712
.short 0,0,0,0,0,0,0,0,0,48712,16068,48910,0,15944,48836,16142,0,48836,16181,49005,0,48836,16181,49005,0,48910,16237,49019,0,16142,49005,16251
.short 0,48949,16256,48949,0,48949,16256,48949,0,48981,16237,48712,0,16213,49005,15944,0,49005,16181,16068,0,49005,16181,16068,0,49019,16068,16213,0,16251,48836,48981
.short 0,49024,0,16256,0,49024,0,16256,0,49019,48836,16213,0,16251,16068,48981,0,49005,48949,16068,0,49005,48949,16068,0,48981,49005,48712,0,16213,16237,15944
.short 0,48949,49024,48949,0,48949,49024,48949,0,48910,49005,49019,0,16142,16237,16251,0,48836,48949,49005,0,48836,48949,49005,0,48712,48836,48910,0,15944,16068,16142
.short 0,0,0,0,0,0,0,0,16181,48981,16237,49019,48949,16213,49005,16251,16256,49005,16181,48836,16256,49005,16181,48836,16181,48712,48836,16213,48949,15944,16068,48981
.short 0,16181,49024,16181,0,16181,49024,16181,48949,16251,48836,48910,16181,49019,16068,16142,49024,16068,16181,49005,49024,16068,16181,49005,48949,48910,16237,15944,16181,16142,49005,48712
.short 0,49024,0,16256,0,49024,0,16256,16181,48910,49005,15944,48949,16142,16237,48712,16256,16068,48949,49005,16256,16068,48949,49005,16181,16251,16068,48910,48949,49019,48836,16142
.short 0,16181,16256,16181,0,16181,16256,16181,48949,48712,16068,16213,16181,15944,48836,48981,49024,49005,48949,48836,49024,49005,48949,48836,48949,48981,49005,49019,16181,16213,16237,16251
.short 0,0,0,0,0,0,0,0,16256,49019,16237,48981,49024,16251,49005,16213,0,16068,48949,16237,0,16068,48949,16237,49024,16213,48836,48712,16256,48981,16068,15944
.short 0,48949,16256,48949,0,48949,16256,48949,16256,48910,48836,16251,49024,16142,16068,49019,0,16237,48949,48836,0,16237,48949,48836,49024,15944,16237,48910,16256,48712,49005,16142
.short 0,49024,0,16256,0,49024,0,16256,16256,15944,49005,48910,49024,48712,16237,16142,0,16237,16181,48836,0,16237,16181,48836,49024,48910,16068,16251,16256,16142,48836,49019
.short 0,48949,49024,48949,0,48949,49024,48949,16256,16213,16068,48712,49024,48981,48836,15944,0,16068,16181,16237,0,16068,16181,16237,49024,49019,49005,48981,16256,16251,16237,16213
.short 0,0,0,0,0,0,0,0,16181,48910,16068,48712,48949,16142,48836,15944,49024,16237,48949,16068,49024,16237,48949,16068,16181,49019,16237,48910,48949,16251,49005,16142
.short 0,16181,49024,16181,0,16181,49024,16181,48949,48712,16237,48981,16181,15944,49005,16213,16256,48836,48949,16237,16256,48836,48949,16237,48949,16213,16068,49019,16181,48981,48836,16251
.short 0,49024,0,16256,0,49024,0,16256,16181,16213,48836,49019,48949,48981,16068,16251,49024,48836,16181,16237,49024,48836,16181,16237,16181,48712,49005,48981,48949,15944,16237,16213
.short 0,16181,16256,16181,0,16181,16256,16181,48949,49019,49005,48910,16181,16251,16237,16142,16256,16237,16181,16068,16256,16237,16181,16068,48949,48910,48836,48712,16181,16142,16068,15944
.long 1065353216,1065353216,1065353216,1065353216,1065353216,1065353137,1065352900,1065352505,1065353216,1065352900,1065351953,1065350374,1065353216,1065352505,1065350374,1065346821
.long 1065353216,1065351953,1065348163,1065341847,1065353216,1065351242,1065345321,1065335454,1065353216,1065350374,1065341847,1065327640,1065353216,1065349347,1065337743,1065318408
.long 1065353216,1065348163,1065333007,1065307757,1065353216,1065346821,1065327640,1065295689,1065353216,1065345321,1065321643,1065282205,1065353216,1065343663,1065315015,1065267305
.long 1065353216,1065341847,1065307757,1065250992,1065353216,1065339874,1065299869,1065233266,1065353216,1065337743,1065291352,1065214129,1065353216,1065335454,1065282205,1065193582
.long 1065353216,1065353216,1065353216,1065353216,1065351953,1065351242,1065350374,1065349347,1065348163,1065345321,1065341847,1065337743,1065341847,1065335454,1065327640,1065318408
.long 1065333007,1065321643,1065307757,1065291352,1065321643,1065303892,1065282205,1065256587,1065307757,1065282205,1065250992,1065214129,1065291352,1065256587,1065214129,1065163997
.long 1065272429,1065227044,1065171628,1065106216,1065250992,1065193582,1065123504,1065040811,1065227044,1065156211,1065069773,1064967812,1065200588,1065114938,1065010454,1064887254
.long 1065171628,1065069773,1064945565,1064799173,1065140169,1065020727,1064875131,1064703610,1065106216,1064967812,1064799173,1064600610,1065069773,1064911040,1064717719,1064490219
.long 1065353216,1065353216,1065353216,1065353216,1065348163,1065346821,1065345321,1065343663,1065333007,1065327640,1065321643,1065315015,1065307757,1065295689,1065282205,1065267305
.long 1065272429,1065250992,1065227044,1065200588,1065227044,1065193582,1065156211,1065114938,1065171628,1065123504,1065069773,1065010454,1065106216,1065040811,1064967812,1064887254
.long 1065030846,1064945565,1064850424,1064745479,1064945565,1064837841,1064717719,1064585291,1064850424,1064717719,1064569821,1064406871,1064745479,1064585291,1064406871,1064210424
.long 1064630795,1064440658,1064229022,1063996172,1064506439,1064283931,1064036440,1063764359,1064372488,1064115229,1063829308,1063515251,1064229022,1063934681,1063607819,1063249129
.long 1065353216,1065353216,1065353216,1065353216,1065341847,1065339874,1065337743,1065335454,1065307757,1065299869,1065291352,1065282205,1065250992,1065233266,1065214129,1065193582
.long 1065171628,1065140169,1065106216,1065069773,1065069773,1065020727,1064967812,1064911040,1064945565,1064875131,1064799173,1064717719,1064799173,1064703610,1064600610,1064490219
.long 1064630795,1064506439,1064372488,1064229022,1064440658,1064283931,1064115229,1063934681,1064229022,1064036440,1063829308,1063607819,1063996172,1063764359,1063515251,1063249129
.long 1063742424,1063468122,1063173637,1062859370,1063468122,1063148198,1062805098,1062439367,1063173637,1062805098,1062410313,1061990009,1062859370,1062439367,1061990009,1061512249
.long 2147483648,2147483648,2147483648,2147483648,2147483648,3142127558,3150516104,3155610456,2147483648,3150516104,3158904464,3163998646,2147483648,3155610456,3163998646,3168938618
.long 2147483648,3158904464,3167292080,3172385580,2147483648,3162198347,3170585018,3174854101,2147483648,3163998646,3172385580,3177321577,2147483648,3165645417,3174031367,3179535114
.long 2147483648,3167292080,3175676720,3180767493,2147483648,3168938618,3177321577,3181999034,2147483648,3170585018,3178965876,3183229635,2147483648,3171562543,3179945994,3184459191
.long 2147483648,3172385580,3180767493,3185687598,2147483648,3173208523,3181588620,3186914752,2147483648,3174031367,3182409344,3187905794,2147483648,3174854101,3183229635,3188517962
.long 2147483648,2147483648,2147483648,2147483648,3158904464,3162198347,3163998646,3165645417,3167292080,3170585018,3172385580,3174031367,3172385580,3174854101,3177321577,3179535114
.long 3175676720,3178965876,3180767493,3182409344,3178965876,3181178105,3183229635,3185278263,3180767493,3183229635,3185687598,3187905794,3182409344,3185278263,3187905794,3189332960
.long 3184049462,3187323507,3189129347,3190755490,3185687598,3188517962,3190349564,3192172729,3187323507,3189536478,3191566031,3193584023,3188313990,3190552580,3192778336,3194988722
.long 3189129347,3191566031,3193986067,3196222912,3189943222,3192576591,3195188817,3196917696,3190755490,3193584023,3196222912,3197608215,3191566031,3194588090,3196818695,3198294151
.long 2147483648,2147483648,2147483648,2147483648,3167292080,3168938618,3170585018,3171562543,3175676720,3177321577,3178965876,3179945994,3180767493,3181999034,3183229635,3184459191
.long 3184049462,3185687598,3187323507,3188313990,3187323507,3188517962,3189536478,3190552580,3189129347,3190349564,3191566031,3192778336,3190755490,3192172729,3193584023,3194988722
.long 3192374722,3193986067,3195588556,3196620435,3193986067,3195788196,3196818695,3197706494,3195588556,3196818695,3197804678,3198781124,3196620435,3197706494,3198781124,3199843102
.long 3197411377,3198586642,3199747114,3200891219,3198196453,3199458469,3200701737,3201924281,3198975188,3200321310,3201644097,3202941111,3199747114,3201174506,3202573306,3203940552
.long 2147483648,2147483648,2147483648,2147483648,3172385580,3173208523,3174031367,3174854101,3180767493,3181588620,3182409344,3183229635,3185687598,3186914752,3187905794,3188517962
.long 3189129347,3189943222,3190755490,3191566031,3191566031,3192576591,3193584023,3194588090,3193986067,3195188817,3196222912,3196818695,3196222912,3196917696,3197608215,3198294151
.long 3197411377,3198196453,3198975188,3199747114,3198586642,3199458469,3200321310,3201174506,3199747114,3200701737,3201644097,3202573306,3200891219,3201924281,3202941111,3203940552
.long 3202017408,3203124155,3204209959,3204860802,3203124155,3204299451,3204948278,3205508565,3204209959,3204948278,3205551053,3206136320,3204860802,3205508565,3206136320,3206742739
.long 1065353216,1065333007,1065272429,1065171628,1065353216,1065330403,1065262025,1065148268,1065353216,1065327640,1065250992,1065123504,1065353216,1065324721,1065239331,1065097338
.long 1065353216,1065321643,1065227044,1065069773,1065353216,1065318408,1065214129,1065040811,1065353216,1065315015,1065200588,1065010454,1065353216,1065311465,1065186420,1064978704
.long 1065353216,1065307757,1065171628,1064945565,1065353216,1065303892,1065156211,1064911040,1065353216,1065299869,1065140169,1064875131,1065353216,1065295689,1065123504,1064837841
.long 1065353216,1065291352,1065106216,1064799173,1065353216,1065286857,1065088305,1064759131,1065353216,1065282205,1065069773,1064717719,1065353216,1065277396,1065050620,1064674939
.long 1065030846,1064850424,1064630795,1064372488,1064989442,1064785978,1064538431,1064247472,1064945565,1064717719,1064440658,1064115229,1064899224,1064645661,1064337510,1063975820
.long 1064850424,1064569821,1064229022,1063829308,1064799173,1064490219,1064115229,1063675761,1064745479,1064406871,1063996172,1063515251,1064689350,1064319799,1063871889,1063347850
.long 1064630795,1064229022,1063742424,1063173637,1064569821,1064134561,1063607819,1062992692,1064506439,1064036440,1063468122,1062805098,1064440658,1063934681,1063323378,1062610942
.long 1064372488,1063829308,1063173637,1062410313,1064301939,1063720345,1063018951,1062203304,1064229022,1063607819,1062859370,1061990009,1064153747,1063491756,1062694950,1061770529
.long 1064076126,1063742424,1063372184,1062966298,1063913895,1063538604,1063122622,1062667080,1063742424,1063323378,1062859370,1062351814,1063561817,1063096909,1062582675,1062020861
.long 1063372184,1062859370,1062292797,1061674597,1063173637,1062610942,1061990009,1061313417,1062966298,1062351814,1061674597,1060937731,1062750291,1062082185,1061346857,1060547967
.long 1062525745,1061802258,1061007097,1060144571,1062292797,1061512249,1060655638,1059728000,1062051586,1061212378,1060292809,1059298729,1061802258,1060902873,1059918953,1058857247
.long 1061544963,1060583971,1059534422,1058404057,1061279856,1060255914,1059139577,1057939675,1061007097,1059918953,1058734790,1057464630,1060726850,1059573345,1058320441,1056979462
.long 1062525745,1062051586,1061544963,1061007097,1062173215,1061642373,1061075995,1060475623,1061802258,1061212378,1060583971,1059918953,1061413376,1060762284,1060069797,1059338266
.long 1061007097,1060292809,1059534422,1058734790,1060583971,1059804699,1058978834,1058109803,1060144571,1059298729,1058404057,1057464630,1059689493,1058775705,1057811152,1056636663
.long 1059219353,1058236458,1057201213,1055273845,1058734790,1057681847,1056186119,1053879082,1058236458,1057112753,1054904911,1052455328,1057725035,1056095555,1053596555,1051005599
.long 1057201213,1054904911,1052263466,1049532962,1056366795,1053690858,1050908101,1047505074,1055273845,1052455328,1049532962,1044486967,1054160449,1051200287,1047705169,1041441994
.long 2147483648,3175676720,3184049462,3189129347,2147483648,3176499214,3184868793,3189739899,2147483648,3177321577,3185687598,3190349564,2147483648,3178143800,3186505846,3190958292
.long 2147483648,3178965876,3187323507,3191566031,2147483648,3179535114,3187905794,3192172729,2147483648,3179945994,3188313990,3192778336,2147483648,3180356788,3188721847,3193382799
.long 2147483648,3180767493,3189129347,3193986067,2147483648,3181178105,3189536478,3194588090,2147483648,3181588620,3189943222,3195188817,2147483648,3181999034,3190349564,3195788196
.long 2147483648,3182409344,3190755490,3196222912,2147483648,3182819546,3191160984,3196521178,2147483648,3183229635,3191566031,3196818695,2147483648,3183639609,3191970615,3197115436
.long 3192374722,3195588556,3197411377,3198975188,3193181441,3196322416,3198000760,3199651011,3193986067,3196818695,3198586642,3200321310,3194788479,3197312821,3199168826,3200985774
.long 3195588556,3197804678,3199747114,3201644097,3196222912,3198294151,3200321310,3202295977,3196620435,3198781124,3200891219,3202941111,3197016610,3199265483,3201456649,3203579203
.long 3197411377,3199747114,3202017408,3204209959,3197804678,3200225903,3202573306,3204640671,3198196453,3200701737,3203124155,3204948278,3198586642,3201174506,3203669767,3205251785
.long 3198975188,3201644097,3204209959,3205551053,3199362031,3202110401,3204596401,3205845943,3199747114,3202573306,3204860802,3206136320,3200130378,3203032705,3205122221,3206422050
.long 3200511765,3202017408,3203488490,3204684861,3201268682,3202849373,3204388786,3205165495,3202017408,3203669767,3204860802,3205635760,3202757493,3204463110,3205294800,3206095119
.long 3203488490,3204860802,3205720106,3206543051,3204209959,3205251785,3206136320,3206979043,3204684861,3205635760,3206543051,3207402601,3205035419,3206012434,3206939914,3207813242
.long 3205380570,3206381521,3207326538,3208210498,3205720106,3206742739,3207702557,3208593916,3206053824,3207095813,3208067619,3208963061,3206381521,3207440473,3208421379,3209317511
.long 3206703001,3207776457,3208763504,3209656863,3207018070,3208103509,3209093674,3209980731,3207326538,3208421379,3209411576,3210288746,3207628219,3208729825,3209716911,3210580557
.long 3205380570,3206053824,3206703001,3207326538,3205887705,3206583187,3207250050,3207886479,3206381521,3207095813,3207776457,3208421379,3206861349,3207590886,3208281252,3208930103
.long 3207326538,3208067619,3208763504,3209411576,3207776457,3208525253,3209222323,3209864777,3208210498,3208963061,3209656863,3210288746,3208628071,3209380346,3210066323,3210682587
.long 3209028611,3209776445,3210449946,3211045465,3209411576,3210150728,3210807026,3211376612,3209776445,3210502599,3211136904,3211675326,3210122725,3210831498,3211438971,3211940976
.long 3210449946,3211136904,3211712670,3212172998,3210757665,3211418329,3211957496,3212370902,3211045465,3211675326,3212172998,3212534268,3211312956,3211907487,3212358779,3212662750
.long 1065353216,1065353216,1065353216,1065353216,1065333007,1065330403,1065327640,1065324721,1065272429,1065262025,1065250992,1065239331,1065171628,1065148268,1065123504,1065097338
.long 1065030846,1064989442,1064945565,1064899224,1064850424,1064785978,1064717719,1064645661,1064630795,1064538431,1064440658,1064337510,1064372488,1064247472,1064115229,1063975820
.long 1064076126,1063913895,1063742424,1063561817,1063742424,1063538604,1063323378,1063096909,1063372184,1063122622,1062859370,1062582675,1062966298,1062667080,1062351814,1062020861
.long 1062525745,1062173215,1061802258,1061413376,1062051586,1061642373,1061212378,1060762284,1061544963,1061075995,1060583971,1060069797,1061007097,1060475623,1059918953,1059338266
.long 1065353216,1065353216,1065353216,1065353216,1065321643,1065318408,1065315015,1065311465,1065227044,1065214129,1065200588,1065186420,1065069773,1065040811,1065010454,1064978704
.long 1064850424,1064799173,1064745479,1064689350,1064569821,1064490219,1064406871,1064319799,1064229022,1064115229,1063996172,1063871889,1063829308,1063675761,1063515251,1063347850
.long 1063372184,1063173637,1062966298,1062750291,1062859370,1062610942,1062351814,1062082185,1062292797,1061990009,1061674597,1061346857,1061674597,1061313417,1060937731,1060547967
.long 1061007097,1060583971,1060144571,1059689493,1060292809,1059804699,1059298729,1058775705,1059534422,1058978834,1058404057,1057811152,1058734790,1058109803,1057464630,1056636663
.long 1065353216,1065353216,1065353216,1065353216,1065307757,1065303892,1065299869,1065295689,1065171628,1065156211,1065140169,1065123504,1064945565,1064911040,1064875131,1064837841
.long 1064630795,1064569821,1064506439,1064440658,1064229022,1064134561,1064036440,1063934681,1063742424,1063607819,1063468122,1063323378,1063173637,1062992692,1062805098,1062610942
.long 1062525745,1062292797,1062051586,1061802258,1061802258,1061512249,1061212378,1060902873,1061007097,1060655638,1060292809,1059918953,1060144571,1059728000,1059298729,1058857247
.long 1059219353,1058734790,1058236458,1057725035,1058236458,1057681847,1057112753,1056095555,1057201213,1056186119,1054904911,1053596555,1055273845,1053879082,1052455328,1051005599
.long 1065353216,1065353216,1065353216,1065353216,1065291352,1065286857,1065282205,1065277396,1065106216,1065088305,1065069773,1065050620,1064799173,1064759131,1064717719,1064674939
.long 1064372488,1064301939,1064229022,1064153747,1063829308,1063720345,1063607819,1063491756,1063173637,1063018951,1062859370,1062694950,1062410313,1062203304,1061990009,1061770529
.long 1061544963,1061279856,1061007097,1060726850,1060583971,1060255914,1059918953,1059573345,1059534422,1059139577,1058734790,1058320441,1058404057,1057939675,1057464630,1056979462
.long 1057201213,1056366795,1055273845,1054160449,1054904911,1053690858,1052455328,1051200287,1052263466,1050908101,1049532962,1047705169,1049532962,1047505074,1044486967,1041441994
.long 2147483648,2147483648,2147483648,2147483648,3175676720,3176499214,3177321577,3178143800,3184049462,3184868793,3185687598,3186505846,3189129347,3189739899,3190349564,3190958292
.long 3192374722,3193181441,3193986067,3194788479,3195588556,3196322416,3196818695,3197312821,3197411377,3198000760,3198586642,3199168826,3198975188,3199651011,3200321310,3200985774
.long 3200511765,3201268682,3202017408,3202757493,3202017408,3202849373,3203669767,3204463110,3203488490,3204388786,3204860802,3205294800,3204684861,3205165495,3205635760,3206095119
.long 3205380570,3205887705,3206381521,3206861349,3206053824,3206583187,3207095813,3207590886,3206703001,3207250050,3207776457,3208281252,3207326538,3207886479,3208421379,3208930103
.long 2147483648,2147483648,2147483648,2147483648,3178965876,3179535114,3179945994,3180356788,3187323507,3187905794,3188313990,3188721847,3191566031,3192172729,3192778336,3193382799
.long 3195588556,3196222912,3196620435,3197016610,3197804678,3198294151,3198781124,3199265483,3199747114,3200321310,3200891219,3201456649,3201644097,3202295977,3202941111,3203579203
.long 3203488490,3204209959,3204684861,3205035419,3204860802,3205251785,3205635760,3206012434,3205720106,3206136320,3206543051,3206939914,3206543051,3206979043,3207402601,3207813242
.long 3207326538,3207776457,3208210498,3208628071,3208067619,3208525253,3208963061,3209380346,3208763504,3209222323,3209656863,3210066323,3209411576,3209864777,3210288746,3210682587
.long 2147483648,2147483648,2147483648,2147483648,3180767493,3181178105,3181588620,3181999034,3189129347,3189536478,3189943222,3190349564,3193986067,3194588090,3195188817,3195788196
.long 3197411377,3197804678,3198196453,3198586642,3199747114,3200225903,3200701737,3201174506,3202017408,3202573306,3203124155,3203669767,3204209959,3204640671,3204948278,3205251785
.long 3205380570,3205720106,3206053824,3206381521,3206381521,3206742739,3207095813,3207440473,3207326538,3207702557,3208067619,3208421379,3208210498,3208593916,3208963061,3209317511
.long 3209028611,3209411576,3209776445,3210122725,3209776445,3210150728,3210502599,3210831498,3210449946,3210807026,3211136904,3211438971,3211045465,3211376612,3211675326,3211940976
.long 2147483648,2147483648,2147483648,2147483648,3182409344,3182819546,3183229635,3183639609,3190755490,3191160984,3191566031,3191970615,3196222912,3196521178,3196818695,3197115436
.long 3198975188,3199362031,3199747114,3200130378,3201644097,3202110401,3202573306,3203032705,3204209959,3204596401,3204860802,3205122221,3205551053,3205845943,3206136320,3206422050
.long 3206703001,3207018070,3207326538,3207628219,3207776457,3208103509,3208421379,3208729825,3208763504,3209093674,3209411576,3209716911,3209656863,3209980731,3210288746,3210580557
.long 3210449946,3210757665,3211045465,3211312956,3211136904,3211418329,3211675326,3211907487,3211712670,3211957496,3212172998,3212358779,3212172998,3212370902,3212534268,3212662750
.long 1060439283,1059842890,1059219353,1058570176,1059842890,1059179515,1058487303,1057768137,1059219353,1058487303,1057725035,1056905138,1058570176,1057768137,1056905138,1055181822
.long 1057896922,1057023972,1055273845,1053407571,1057201213,1055549057,1053596555,1051588412,1056004842,1053973001,1051878383,1049730525,1054533760,1052359454,1050124567,1047104442
.long 1053028117,1050712805,1048104908,1043271842,1051491540,1049037530,1044486967,1038613146,1049927729,1046100375,1040830342,1029837929,1048104908,1042662796,1034104972,3142127558
.long 1044891074,1038203950,1019808432,3178965876,1041645699,1030660152,3170585018,3186914752,1036565814,1003032456,3182409344,3191160984,1028193072,3174854101,3188721847,3194988722
.long 1057896922,1057201213,1056004842,1054533760,1057023972,1055549057,1053973001,1052359454,1055273845,1053596555,1051878383,1050124567,1053407571,1051588412,1049730525,1047104442
.long 1051491540,1049532962,1046502419,1042459574,1049532962,1046301466,1042052830,1035335898,1046502419,1042052830,1034925696,1016514998,1042459574,1035335898,1016514998,3176499214
.long 1036565814,1019808432,3175676720,3187323507,1024901932,3173208523,3186505846,3192172729,3167292080,3184868793,3191566031,3196421838,3182409344,3190552580,3195987681,3198683935
.long 3189129347,3194788479,3198196453,3200891219,3193181441,3197509842,3200321310,3203032705,3196620435,3199554796,3202388559,3204772996,3198586642,3201550439,3204388786,3205762143
.long 1053028117,1051491540,1049927729,1048104908,1050712805,1049037530,1046100375,1042662796,1048104908,1044486967,1040830342,1034104972,1043271842,1038613146,1029837929,3142127558
.long 1036565814,1024901932,3167292080,3182409344,1019808432,3173208523,3184868793,3190552580,3175676720,3186505846,3191566031,3195987681,3187323507,3192172729,3196421838,3198683935
.long 3192374722,3196620435,3198975188,3201268682,3196620435,3199072060,3201456649,3203760181,3198975188,3201456649,3203850443,3205294800,3201268682,3203760181,3205294800,3206422050
.long 3203488490,3205208683,3206381521,3207478238,3205035419,3206259353,3207402601,3208456120,3206053824,3207250050,3208351547,3209348991,3207018070,3208174949,3209222323,3210150728
.long 1044891074,1041645699,1036565814,1028193072,1038203950,1030660152,1003032456,3174854101,1019808432,3170585018,3182409344,3188721847,3178965876,3186914752,3191160984,3194988722
.long 3189129347,3193181441,3196620435,3198586642,3194788479,3197509842,3199554796,3201550439,3198196453,3200321310,3202388559,3204388786,3200891219,3203032705,3204772996,3205762143
.long 3203488490,3205035419,3206053824,3207018070,3205208683,3206259353,3207250050,3208174949,3206381521,3207402601,3208351547,3209222323,3207478238,3208456120,3209348991,3210150728
.long 3208490745,3209411576,3210233939,3210951770,3209411576,3210261409,3210998899,3211618209,3210233939,3210998899,3211637395,3212144023,3210951770,3211618209,3212144023,3212524459
.long 3207922931,3208490745,3209028611,3209535234,3208490745,3209061204,3209596304,3210094590,3209028611,3209596304,3210122725,3210606270,3209535234,3210094590,3210606270,3211068537
.long 3210009393,3210554707,3211045465,3211479820,3210449946,3210975404,3211438971,3211838721,3210855832,3211355537,3211785587,3212144023,3211226072,3211694072,3212084258,3212394688
.long 3211559774,3211990087,3212334072,3212589864,3211856136,3212242779,3212534268,3212728888,3212114443,3212451460,3212684236,3212811288,3212334072,3212615562,3212783517,3212836785
.long 3212514494,3212734640,3212831811,3212805291,3212655276,3212808369,3212828969,3212716914,3212756077,3212836548,3212775000,3212571953,3212816655,3212819102,3212670068,3212370902
.long 3210009393,3210449946,3210855832,3211226072,3210554707,3210975404,3211355537,3211694072,3211045465,3211438971,3211785587,3212084258,3211479820,3211838721,3212144023,3212394688
.long 3211856136,3212172998,3212429213,3212623817,3212172998,3212440414,3212639859,3212770505,3212429213,3212639859,3212775000,3212834022,3212623817,3212770505,3212834022,3212814051
.long 3212756077,3212831811,3212816655,3212710692,3212825495,3212823522,3212722979,3212524459,3212831811,3212745673,3212553421,3212256279,3212775000,3212598586,3212308752,3211907487
.long 3212655276,3212382872,3211990087,3211479820,3212473090,3212099426,3211598877,3210975404,3212229127,3211749424,3211136904,3210396752,3211924306,3211334318,3210606270,3209746743
.long 3211559774,3211856136,3212114443,3212334072,3211990087,3212242779,3212451460,3212615562,3212334072,3212534268,3212684236,3212783517,3212589864,3212728888,3212811288,3212836785
.long 3212756077,3212825495,3212831811,3212775000,3212831811,3212823522,3212745673,3212598586,3212816655,3212722979,3212553421,3212308752,3212710692,3212524459,3212256279,3211907487
.long 3212514494,3212229127,3211856136,3211397543,3212229127,3211838721,3211355537,3210782415,3211856136,3211355537,3210757665,3210066323,3211397543,3210782415,3210066323,3209254177
.long 3210855832,3210122725,3209285906,3208351547,3210233939,3209380346,3208421379,3207364623,3209535234,3208559643,3207478238,3206300172,3208763504,3207665442,3206462482,3205165495
.long 3212514494,3212655276,3212756077,3212816655,3212734640,3212808369,3212836548,3212819102,3212831811,3212828969,3212775000,3212670068,3212805291,3212716914,3212571953,3212370902
.long 3212655276,3212473090,3212229127,3211924306,3212382872,3212099426,3211749424,3211334318,3211990087,3211598877,3211136904,3210606270,3211479820,3210975404,3210396752,3209746743
.long 3210855832,3210233939,3209535234,3208763504,3210122725,3209380346,3208559643,3207665442,3209285906,3208421379,3207478238,3206462482,3208351547,3207364623,3206300172,3205165495
.long 3207326538,3206218438,3205035419,3203124155,3206218438,3204991890,3202941111,3200225903,3205035419,3202941111,3200130378,3197214173,3203124155,3200225903,3197214173,3192172729
.long 1065353216,1065272429,1065030846,1064630795,1065353216,1065267305,1065010454,1064585291,1065353216,1065262025,1064989442,1064538431,1065353216,1065256587,1064967812,1064490219
.long 1065353216,1065250992,1064945565,1064440658,1065353216,1065245240,1064922702,1064389754,1065353216,1065239331,1064899224,1064337510,1065353216,1065233266,1064875131,1064283931
.long 1065353216,1065227044,1064850424,1064229022,1065353216,1065220664,1064825104,1064172786,1065353216,1065214129,1064799173,1064115229,1065353216,1065207436,1064772631,1064056356
.long 1065353216,1065200588,1064745479,1063996172,1065353216,1065193582,1064717719,1063934681,1065353216,1065186420,1064689350,1063871889,1065353216,1065179102,1064660375,1063807801
.long 1064076126,1063372184,1062525745,1061544963,1063996172,1063249129,1062351814,1061313417,1063913895,1063122622,1062173215,1061075995,1063829308,1062992692,1061990009,1060832809
.long 1063742424,1062859370,1061802258,1060583971,1063653256,1062722687,1061610026,1060329594,1063561817,1062582675,1061413376,1060069797,1063468122,1062439367,1061212378,1059804699
.long 1063372184,1062292797,1061007097,1059534422,1063274017,1062142999,1060797604,1059259091,1063173637,1061990009,1060583971,1058978834,1063071059,1061833863,1060366268,1058693779
.long 1062966298,1061674597,1060144571,1058404057,1062859370,1061512249,1059918953,1058109803,1062750291,1061346857,1059689493,1057811152,1062639077,1061178460,1059456266,1057508242
.long 1060439283,1059219353,1057896922,1056004842,1060144571,1058857247,1057464630,1054997354,1059842890,1058487303,1057023972,1053973001,1059534422,1058109803,1056186119,1052932949
.long 1059219353,1057725035,1055273845,1051878383,1058897873,1057333292,1054347371,1050810503,1058570176,1056905138,1053407571,1049730525,1058236458,1056095555,1052455328,1048639680
.long 1057896922,1055273845,1051491540,1046502419,1057551771,1054440633,1050517112,1044284734,1057201213,1053596555,1049532962,1042052830,1056726311,1052742255,1048504033,1039431104
.long 1056004842,1051878383,1046502419,1034925696,1055273845,1051005599,1044486967,1029015566,1054533760,1050124567,1042459574,1016514998,1053785034,1049235959,1040422146,3162198347
.long 1053028117,1049927729,1044891074,1036565814,1051878383,1048639680,1042052830,1029015566,1050712805,1046100375,1038203950,1003032456,1049532962,1043474644,1032462346,3173208523
.long 1048104908,1040830342,1019808432,3182409344,1045697793,1036155961,3163998646,3188109934,1043271842,1029837929,3178965876,3191160984,1040830342,1014714699,3184868793,3194186883
.long 1036565814,3167292080,3189129347,3196620435,1031482228,3179535114,3191970615,3198098655,1019808432,3184868793,3194788479,3199554796,3158904464,3188925642,3196818695,3200985774
.long 3175676720,3191566031,3198196453,3202388559,3182409344,3194186883,3199554796,3203760181,3187323507,3196421838,3200891219,3204772996,3189943222,3197706494,3202203257,3205423323
.long 2147483648,3184049462,3192374722,3197411377,2147483648,3184459191,3192778336,3197706494,2147483648,3184868793,3193181441,3198000760,2147483648,3185278263,3193584023,3198294151
.long 2147483648,3185687598,3193986067,3198586642,2147483648,3186096794,3194387558,3198878209,2147483648,3186505846,3194788479,3199168826,2147483648,3186914752,3195188817,3199458469
.long 2147483648,3187323507,3195588556,3199747114,2147483648,3187701573,3195987681,3200034735,2147483648,3187905794,3196222912,3200321310,2147483648,3188109934,3196421838,3200606812
.long 2147483648,3188313990,3196620435,3200891219,2147483648,3188517962,3196818695,3201174506,2147483648,3188721847,3197016610,3201456649,2147483648,3188925642,3197214173,3201737625
.long 3200511765,3203488490,3205380570,3206703001,3200891219,3203940552,3205635760,3206979043,3201268682,3204388786,3205887705,3207250050,3201644097,3204640671,3206136320,3207515895
.long 3202017408,3204860802,3206381521,3207776457,3202388559,3205078862,3206623225,3208031615,3202757493,3205294800,3206861349,3208281252,3203124155,3205508565,3207095813,3208525253
.long 3203488490,3205720106,3207326538,3208763504,3203850443,3205929375,3207553445,3208995897,3204209959,3206136320,3207776457,3209222323,3204507620,3206340895,3207995500,3209442680
.long 3204684861,3206543051,3208210498,3209656863,3204860802,3206742739,3208421379,3209864777,3205035419,3206939914,3208628071,3210066323,3205208683,3207134529,3208830505,3210261409
.long 3207922931,3209028611,3210009393,3210855832,3208210498,3209317511,3210288746,3211114256,3208490745,3209596304,3210554707,3211355537,3208763504,3209864777,3210807026,3211579399
.long 3209028611,3210122725,3211045465,3211785587,3209285906,3210369952,3211269800,3211973867,3209535234,3210606270,3211479820,3212144023,3209776445,3210831498,3211675326,3212295863
.long 3210009393,3211045465,3211856136,3212429213,3210233939,3211248007,3212022079,3212543922,3210449946,3211438971,3212172998,3212639859,3210657285,3211618209,3212308752,3212716914
.long 3210855832,3211785587,3212429213,3212775000,3211045465,3211940976,3212534268,3212814051,3211226072,3212084258,3212623817,3212834022,3211397543,3212215323,3212697777,3212834890
.long 3211559774,3212114443,3212514494,3212756077,3211785587,3212295863,3212639859,3212814051,3211990087,3212451460,3212734640,3212836548,3212172998,3212580986,3212798663,3212823522
.long 3212334072,3212684236,3212831811,3212775000,3212473090,3212761044,3212834022,3212691084,3212589864,3212811288,3212805291,3212571953,3212684236,3212834890,3212745673,3212417859
.long 3212756077,3212831811,3212655276,3212229127,3212805291,3212802056,3212534268,3212006158,3212831811,3212745673,3212382872,3211749424,3212835601,3212662750,3212201367,3211459468
.long 3212816655,3212553421,3211990087,3211136904,3212775000,3212417859,3211749424,3210782415,3212710692,3212256279,3211479820,3210396752,3212623817,3212068939,3211181772,3209980731
.long 1065353216,1065171628,1064630795,1063742424,1065353216,1065163997,1064600610,1063675761,1065353216,1065156211,1064569821,1063607819,1065353216,1065148268,1064538431,1063538604
.long 1065353216,1065140169,1064506439,1063468122,1065353216,1065131914,1064473848,1063396378,1065353216,1065123504,1064440658,1063323378,1065353216,1065114938,1064406871,1063249129
.long 1065353216,1065106216,1064372488,1063173637,1065353216,1065097338,1064337510,1063096909,1065353216,1065088305,1064301939,1063018951,1065353216,1065079117,1064265776,1062939769
.long 1065353216,1065069773,1064229022,1062859370,1065353216,1065060274,1064191678,1062777761,1065353216,1065050620,1064153747,1062694950,1065353216,1065040811,1064115229,1062610942
.long 1062525745,1061007097,1059219353,1057201213,1062410313,1060832809,1058978834,1056815803,1062292797,1060655638,1058734790,1056186119,1062173215,1060475623,1058487303,1055549057
.long 1062051586,1060292809,1058236458,1054904911,1061927928,1060107238,1057982340,1054253977,1061802258,1059918953,1057725035,1053596555,1061674597,1059728000,1057464630,1052932949
.long 1061544963,1059534422,1057201213,1052263466,1061413376,1059338266,1056905138,1051588412,1061279856,1059139577,1056366795,1050908101,1061144423,1058938402,1055822969,1050222846
.long 1061007097,1058734790,1055273845,1049532962,1060867899,1058528786,1054719609,1048838768,1060726850,1058320441,1054160449,1047705169,1060583971,1058109803,1053596555,1046301466
.long 1053028117,1048104908,1036565814,3175676720,1052263466,1046301466,1032462346,3181999034,1051491540,1044486967,1024901932,3186505846,1050712805,1042662796,1003032456,3189332960
.long 1049927729,1040830342,3167292080,3191566031,1049136787,1037794615,3177321577,3193785114,1048104908,1034104972,3182409344,3195987681,1046502419,1029015566,3186505846,3197115436
.long 1044891074,1019808432,3189129347,3198196453,1043271842,3142127558,3191160984,3199265483,1041645699,3170585018,3193181441,3200321310,1039839859,3178143800,3195188817,3201362730
.long 1036565814,3182409344,3196620435,3202388559,1033283845,3186096794,3197608215,3203397627,1028193072,3188721847,3198586642,3204388786,1019808432,3190552580,3199554796,3204904582
.long 3192374722,3198975188,3203488490,3206053824,3194788479,3200225903,3204596401,3206663163,3196620435,3201456649,3205208683,3207250050,3197804678,3202665470,3205804089,3207813242
.long 3198975188,3203850443,3206381521,3208351547,3200130378,3204728969,3206939914,3208863825,3201268682,3205294800,3207478238,3209348991,3202388559,3205845943,3207995500,3209806018
.long 3203488490,3206381521,3208490745,3210233939,3204507620,3206900683,3208963061,3210631846,3205035419,3207402601,3209411576,3210998899,3205551053,3207886479,3209835462,3211334318
.long 3206053824,3208351547,3210233939,3211637395,3206543051,3208797065,3210606270,3211907487,3207018070,3209222323,3210951770,3212144023,3207478238,3209626647,3211269800,3212346502
.long 2147483648,3189129347,3197411377,3202017408,2147483648,3189332960,3197608215,3202295977,2147483648,3189536478,3197804678,3202573306,2147483648,3189739899,3198000760,3202849373
.long 2147483648,3189943222,3198196453,3203124155,2147483648,3190146444,3198391749,3203397627,2147483648,3190349564,3198586642,3203669767,2147483648,3190552580,3198781124,3203940552
.long 2147483648,3190755490,3198975188,3204209959,2147483648,3190958292,3199168826,3204463110,2147483648,3191160984,3199362031,3204596401,2147483648,3191363564,3199554796,3204728969
.long 2147483648,3191566031,3199747114,3204860802,2147483648,3191768382,3199938976,3204991890,2147483648,3191970615,3200130378,3205122221,2147483648,3192172729,3200321310,3205251785
.long 3205380570,3207326538,3209028611,3210449946,3205551053,3207515895,3209222323,3210631846,3205720106,3207702557,3209411576,3210807026,3205887705,3207886479,3209596304,3210975404
.long 3206053824,3208067619,3209776445,3211136904,3206218438,3208245932,3209951939,3211291449,3206381521,3208421379,3210122725,3211438971,3206543051,3208593916,3210288746,3211579399
.long 3206703001,3208763504,3210449946,3211712670,3206861349,3208930103,3210606270,3211838721,3207018070,3209093674,3210757665,3211957496,3207173141,3209254177,3210904080,3212068939
.long 3207326538,3209411576,3211045465,3212172998,3207478238,3209565833,3211181772,3212269626,3207628219,3209716911,3211312956,3212358779,3207776457,3209864777,3211438971,3212440414
.long 3211559774,3212334072,3212756077,3212816655,3211712670,3212440414,3212798663,3212779337,3211856136,3212534268,3212825495,3212722979,3211990087,3212615562,3212836548,3212647645
.long 3212114443,3212684236,3212831811,3212553421,3212229127,3212740235,3212811288,3212440414,3212334072,3212783517,3212775000,3212308752,3212429213,3212814051,3212722979,3212158587
.long 3212514494,3212831811,3212655276,3211990087,3212589864,3212836785,3212571953,3211803447,3212655276,3212828969,3212473090,3211598877,3212710692,3212808369,3212358779,3211376612
.long 3212756077,3212775000,3212229127,3211136904,3212791405,3212728888,3212084258,3210880026,3212816655,3212670068,3211924306,3210606270,3212831811,3212598586,3211749424,3210315949
.long 3212514494,3211856136,3210855832,3209535234,3212382872,3211618209,3210502599,3209061204,3212229127,3211355537,3210122725,3208559643,3212053469,3211068537,3209716911,3208031615
.long 3211856136,3210757665,3209285906,3207478238,3211637395,3210423417,3208830505,3206900683,3211397543,3210066323,3208351547,3206300172,3211136904,3209686952,3207849916,3205677978
.long 3210855832,3209285906,3207326538,3205035419,3210554707,3208863825,3206782377,3204299451,3210233939,3208421379,3206218438,3202941111,3209893961,3207959271,3205635760,3201550439
.long 3209535234,3207478238,3205035419,3200130378,3209158245,3206979043,3204388786,3198683935,3208763504,3206462482,3203124155,3197214173,3208351547,3205929375,3201831019,3195388762
.long 613232946,3184049462,3192374722,3197411377,3175676720,3189332960,3195987681,3199265483,3184049462,3192778336,3197804678,3201080203,3189129347,3196123328,3199554796,3202849373
.long 3192374722,3197804678,3201268682,3204507620,3195588556,3199458469,3202941111,3205337729,3197411377,3201080203,3204507620,3206136320,3198975188,3202665470,3205294800,3206900683
.long 3200511765,3204209959,3206053824,3207628219,3202017408,3205078862,3206782377,3208316457,3203488490,3205804089,3207478238,3208963061,3204684861,3206502815,3208139286,3209565833
.long 3205380570,3207173141,3208763504,3210122725,3206053824,3207813242,3209348991,3210631846,3206703001,3208421379,3209893961,3211091467,3207326538,3208995897,3210396752,3211500027
.long 3200511765,3203488490,3205380570,3206703001,3202388559,3204904582,3206300172,3207590886,3204209959,3205804089,3207173141,3208421379,3205208683,3206663163,3207995500,3209190346
.long 3206053824,3207478238,3208763504,3209893961,3206861349,3208245932,3209473657,3210528721,3207628219,3208963061,3210122725,3211091467,3208351547,3209626647,3210707751,3211579399
.long 3209028611,3210233939,3211226072,3211990087,3209656863,3210782415,3211675326,3212321489,3210233939,3211269800,3212053469,3212571953,3210757665,3211694072,3212358779,3212740235
.long 3211226072,3212053469,3212589864,3212825495,3211637395,3212346502,3212745673,3212827311,3211990087,3212571953,3212825495,3212745673,3212282821,3212728888,3212828969,3212580986
.long 3207922931,3209028611,3210009393,3210855832,3208763504,3209806018,3210707751,3211459468,3209535234,3210502599,3211312956,3211957496,3210233939,3211114256,3211821158,3212346502
.long 3210855832,3211637395,3212229127,3212623817,3211397543,3212068939,3212534268,3212787540,3211856136,3212406350,3212734640,3212836548,3212229127,3212647645,3212828969,3212770505
.long 3212514494,3212791405,3212816655,3212589864,3212710692,3212836785,3212697777,3212295863,3212816655,3212783517,3212473090,3211890519,3212831811,3212631916,3212144023,3211376612
.long 3212756077,3212382872,3211712670,3210757665,3212589864,3212037849,3211181772,3210037924,3212334072,3211598877,3210554707,3209222323,3211990087,3211068537,3209835462,3208316457
.long 3211559774,3212114443,3212514494,3212756077,3212053469,3212483673,3212745673,3212836785,3212429213,3212722979,3212835601,3212765853,3212684236,3212830469,3212783517,3212543922
.long 3212816655,3212805291,3212589864,3212172998,3212825495,3212647645,3212256279,3211656434,3212710692,3212358779,3211785587,3210998899,3212473090,3211940976,3211181772,3210206335
.long 3212114443,3211397543,3210449946,3209285906,3211637395,3210732777,3209596304,3208245932,3211045465,3209951939,3208628071,3207095813,3210343018,3209061204,3207553445,3205845943
.long 3209535234,3208067619,3206381521,3204507620,3208628071,3206979043,3205122221,3201737625,3207628219,3205804089,3203124155,3198781124,3206543051,3204552051,3200321310,3195388762
.long 3212836864,3212756077,3212514494,3212114443,3212816655,3212647645,3212308752,3211803447,3212756077,3212494102,3212053469,3211438971,3212655276,3212295863,3211749424,3211022252
.long 3212514494,3212053469,3211397543,3210554707,3212334072,3211767579,3210998899,3210037924,3212114443,3211438971,3210554707,3209473657,3211856136,3211068537,3210066323,3208863825
.long 3211559774,3210657285,3209535234,3208210498,3211226072,3210206335,3208963061,3207515895,3210855832,3209716911,3208351547,3206782377,3210449946,3209190346,3207702557,3206012434
.long 3210009393,3208628071,3207018070,3205208683,3209535234,3208031615,3206300172,3204299451,3209028611,3207402601,3205551053,3202573306,3208490745,3206742739,3204772996,3200796540
.long 3211559774,3210855832,3210009393,3209028611,3211136904,3210315949,3209348991,3208245932,3210657285,3209716911,3208628071,3207402601,3210122725,3209061204,3207849916,3206502815
.long 3209535234,3208351547,3207018070,3205551053,3208897024,3207590886,3206136320,3204552051,3208210498,3206782377,3205208683,3202573306,3207478238,3205929375,3204030509,3200416597
.long 3206703001,3205035419,3202017408,3198196453,3205887705,3203760181,3199938976,3195788196,3205035419,3201831019,3197804678,3191160984,3203850443,3199843102,3195188817,3185278263
.long 3202017408,3197804678,3190755490,3172385580,3200130378,3195388762,3184868793,1024078895,3198196453,3191160984,3172385580,1037385145,3196222912,3186096794,1023101370,1043474644
.long 3207922931,3206703001,3205380570,3203488490,3207018070,3205677978,3204030509,3200985774,3206053824,3204596401,3201644097,3198391749,3205035419,3202481002,3199168826,3195388762
.long 3203488490,3200130378,3196620435,3189943222,3201268682,3197706494,3191970615,3181178105,3198975188,3194387558,3185687598,1003032456,3196620435,3189332960,3170585018,1035335898
.long 3192374722,3180767493,1028193072,1043271842,3187323507,994643910,1040422146,1048639680,3175676720,1034104972,1045697793,1051297476,1019808432,1042256251,1049730525,1053879082
.long 1036565814,1047304831,1052263466,1056366795,1043271842,1050419119,1054719609,1057854081,1048104908,1052837662,1057023972,1058978834,1050712805,1055181822,1058152112,1060032247
.long 3200511765,3197411377,3192374722,3184049462,3197804678,3192979953,3184868793,3142127558,3193986067,3186505846,3158904464,1035745987,3188313990,3168938618,1034104972,1044284734
.long 3175676720,1031482228,1043271842,1049532962,1024901932,1041849312,1048938190,1052551087,1039839859,1047705169,1051878383,1055457463,1045697793,1051005599,1054719609,1057595214
.long 1049927729,1053785034,1057201213,1058897873,1052646730,1056456904,1058487303,1060107238,1055273845,1057982340,1059689493,1061212378,1057377154,1059179515,1060797604,1062203304
.long 1058570176,1060292809,1061802258,1063071059,1059689493,1061313417,1062694950,1063807801,1060726850,1062233263,1063468122,1064406871,1061674597,1063045073,1064115229,1064862854
.long 3207922931,3209535234,3210855832,3211856136,3208490745,3210037924,3211269800,3212158587,3209028611,3210502599,3211637395,3212406350,3209535234,3210927995,3211957496,3212598586
.long 3210009393,3211312956,3212229127,3212734640,3210449946,3211656434,3212451460,3212814051,3210855832,3211957496,3212623817,3212836548,3211226072,3212215323,3212745673,3212802056
.long 3211559774,3212429213,3212816655,3212710692,3211856136,3212598586,3212836548,3212562765,3212114443,3212722979,3212805291,3212358779,3212334072,3212802056,3212722979,3212099426
.long 3212514494,3212835601,3212589864,3211785587,3212655276,3212823522,3212406350,3211418329,3212756077,3212765853,3212172998,3210998899,3212816655,3212662750,3211890519,3210528721
.long 3212514494,3212816655,3212756077,3212334072,3212684236,3212834890,3212607152,3212006158,3212791405,3212783517,3212382872,3211598877,3212835601,3212662750,3212084258,3211114256
.long 3212816655,3212473090,3211712670,3210554707,3212734640,3212215323,3211269800,3209923015,3212589864,3211890519,3210757665,3209222323,3212382872,3211500027,3210178598,3208456120
.long 3212114443,3211045465,3209535234,3207628219,3211785587,3210528721,3208830505,3206742739,3211397543,3209951939,3208067619,3205804089,3210951770,3209317511,3207250050,3204816940
.long 3210449946,3208628071,3206381521,3203124155,3209893961,3207886479,3205465988,3200985774,3209285906,3207095813,3204507620,3198781124,3208628071,3206259353,3202573306,3196521178
.long 3211559774,3210449946,3209028611,3207326538,3211045465,3209746743,3208139286,3206259353,3210449946,3208963061,3207173141,3205122221,3209776445,3208103509,3206136320,3203397627
.long 3209028611,3207173141,3205035419,3200891219,3208210498,3206177427,3203306617,3198294151,3207326538,3205122221,3200891219,3195188817,3206381521,3203579203,3198391749,3189739899
.long 3205380570,3201268682,3195588556,3180767493,3204209959,3198878209,3190349564,1008126808,3202017408,3196421838,3182409344,1035745987,3199747114,3191768382,3150516104,1043474644
.long 3197411377,3185687598,1033283845,1048739264,3193986067,3171562543,1042052830,1051394561,3189129347,1026547719,1047304831,1053973001,3180767493,1039431104,1050517112,1056456904
.long 3205380570,3202017408,3197411377,3189129347,3203850443,3199265483,3192778336,3176499214,3201268682,3196421838,3185687598,1026547719,3198586642,3190958292,3163998646,1041034314
.long 3195588556,3182409344,1033283845,1047304831,3189943222,994643910,1042865916,1051005599,3180767493,1035745987,1048739264,1053973001,1011420816,1043879916,1051685178,1056815803
.long 1036565814,1049136787,1054533760,1058236458,1044082383,1051974821,1057112753,1059495395,1049136787,1054719609,1058404057,1060655638,1051878383,1057157023,1059612165,1061706698
.long 1054533760,1058404057,1060726850,1062639077,1057023972,1059573345,1061738675,1063444347,1058236458,1060655638,1062639077,1064115229,1059377701,1061642373,1063420432,1064645661
.long 3207922931,3206053824,3203488490,3198975188,3207326538,3205337729,3201831019,3197115436,3206703001,3204596401,3200130378,3194387558,3206053824,3203215459,3198391749,3190552580
.long 3205380570,3201644097,3196620435,3185687598,3204684861,3200034735,3193584023,3176499214,3203488490,3198391749,3189943222,1003032456,3202017408,3196719607,3184868793,1032051466
.long 3200511765,3193986067,3175676720,1039839859,3198975188,3190552580,1003032456,1043879916,3197411377,3186505846,1031482228,1047705169,3195588556,3179535114,1039022198,1050026194
.long 3192374722,3158904464,1043271842,1051878383,3189129347,1025724875,1046903910,1053690858,3184049462,1035745987,1049532962,1055457463,3175676720,1041441994,1051297476,1057068403
.long 3192374722,3175676720,1036565814,1048104908,3188313990,1014714699,1042865916,1050615007,3180767493,1034104972,1047304831,1052837662,3158904464,1041441994,1050124567,1054997354
.long 1028193072,1045697793,1052263466,1057023972,1038203950,1049235959,1054347371,1058024917,1043271842,1051297476,1056366795,1058978834,1047304831,1053312892,1057638573,1059880975
.long 1049927729,1055273845,1058570176,1060726850,1051878383,1057068403,1059456266,1061512249,1053785034,1057982340,1060292809,1062233263,1055640507,1058857247,1061075995,1062886304
.long 1057201213,1059689493,1061802258,1063468122,1058067405,1060475623,1062468291,1063975820,1058897873,1061212378,1063071059,1064406871,1059689493,1061896698,1063607819,1064759131
.long 1053028117,1057201213,1059219353,1061007097,1055273845,1058278495,1060218909,1061896698,1057201213,1059298729,1061144423,1062694950,1058236458,1060255914,1061990009,1063396378
.long 1059219353,1061144423,1062750291,1063996172,1060144571,1061959032,1063420432,1064490219,1061007097,1062694950,1063996172,1064875131,1061802258,1063347850,1064473848,1065148268
.long 1062525745,1063913895,1064850424,1065307757,1063173637,1064389754,1065123504,1065352505,1063742424,1064772631,1065291352,1065282205,1064229022,1065060274,1065352900,1065097338
.long 1064630795,1065250992,1065307757,1064799173,1064945565,1065343663,1065156211,1064389754,1065171628,1065337743,1064899224,1063871889,1065307757,1065233266,1064538431,1063249129
.long 1062525745,1063742424,1064630795,1065171628,1063274017,1064319799,1065010454,1065330403,1063913895,1064772631,1065250992,1065337743,1064440658,1065097338,1065350374,1065193582
.long 1064850424,1065291352,1065307757,1064899224,1065140169,1065353137,1065123504,1064457328,1065307757,1065282205,1064799173,1063871889,1065351953,1065079117,1064337510,1063148198
.long 1065272429,1064745479,1063742424,1062292797,1065069773,1064283931,1063018951,1061313417,1064745479,1063698124,1062173215,1060218909,1064301939,1062992692,1061212378,1059019167
.long 1063742424,1062173215,1060144571,1057725035,1063071059,1061246177,1058978834,1055731811,1062292797,1060218909,1057725035,1052837662,1061413376,1059099539,1055822969,1049829173
.long 905969664,905969664,905969664,905969664,905969664,905969585,905969348,905968953,905969664,905969348,905968401,905966822,905969664,905968953,905966822,905963269
.long 905969664,905968401,905964611,905958295,905969664,905967690,905961769,905951902,905969664,905966822,905958295,905944088,905969664,905965795,905954191,905934856
.long 905969664,905964611,905949455,905924205,905969664,905963269,905944088,905912137,905969664,905961769,905938091,905898653,905969664,905960111,905931463,905883753
.long 905969664,905958295,905924205,905867440,905969664,905956322,905916317,905849714,905969664,905954191,905907800,905830577,905969664,905951902,905898653,905810030
.long 905969664,905969664,905969664,905969664,905968401,905967690,905966822,905965795,905964611,905961769,905958295,905954191,905958295,905951902,905944088,905934856
.long 905949455,905938091,905924205,905907800,905938091,905920340,905898653,905873035,905924205,905898653,905867440,905830577,905907800,905873035,905830577,905780445
.long 905888877,905843492,905788076,905722664,905867440,905810030,905739952,905657259,905843492,905772659,905686221,905584260,905817036,905731386,905626902,905503702
.long 905788076,905686221,905562013,905415621,905756617,905637175,905491579,905320058,905722664,905584260,905415621,905217058,905686221,905527488,905334167,905106667
.long 905969664,905969664,905969664,905969664,905964611,905963269,905961769,905960111,905949455,905944088,905938091,905931463,905924205,905912137,905898653,905883753
.long 905888877,905867440,905843492,905817036,905843492,905810030,905772659,905731386,905788076,905739952,905686221,905626902,905722664,905657259,905584260,905503702
.long 905647294,905562013,905466872,905361927,905562013,905454289,905334167,905201739,905466872,905334167,905186269,905023319,905361927,905201739,905023319,904826872
.long 905247243,905057106,904845470,904612620,905122887,904900379,904652888,904380807,904988936,904731677,904445756,904131699,904845470,904551129,904224267,903865577
.long 905969664,905969664,905969664,905969664,905958295,905956322,905954191,905951902,905924205,905916317,905907800,905898653,905867440,905849714,905830577,905810030
.long 905788076,905756617,905722664,905686221,905686221,905637175,905584260,905527488,905562013,905491579,905415621,905334167,905415621,905320058,905217058,905106667
.long 905247243,905122887,904988936,904845470,905057106,904900379,904731677,904551129,904845470,904652888,904445756,904224267,904612620,904380807,904131699,903865577
.long 904358872,904084570,903790085,903475818,904084570,903764646,903421546,903055815,903790085,903421546,903026761,902606457,903475818,903055815,902606457,902128697
.long 0,0,0,0,0,835260358,843648904,848743256,0,843648904,852037264,857131446,0,848743256,857131446,862071418
.long 0,852037264,860424880,865518380,0,855331147,863717818,867986901,0,857131446,865518380,870454377,0,858778217,867164167,872667914
.long 0,860424880,868809520,873900293,0,862071418,870454377,875131834,0,863717818,872098676,876362435,0,864695343,873078794,877591991
.long 0,865518380,873900293,878820398,0,866341323,874721420,880047552,0,867164167,875542144,881038594,0,867986901,876362435,881650762
.long 0,0,0,0,852037264,855331147,857131446,858778217,860424880,863717818,865518380,867164167,865518380,867986901,870454377,872667914
.long 868809520,872098676,873900293,875542144,872098676,874310905,876362435,878411063,873900293,876362435,878820398,881038594,875542144,878411063,881038594,882465760
.long 877182262,880456307,882262147,883888290,878820398,881650762,883482364,885305529,880456307,882669278,884698831,886716823,881446790,883685380,885911136,888121522
.long 882262147,884698831,887118867,889355712,883076022,885709391,888321617,890050496,883888290,886716823,889355712,890741015,884698831,887720890,889951495,891426951
.long 0,0,0,0,860424880,862071418,863717818,864695343,868809520,870454377,872098676,873078794,873900293,875131834,876362435,877591991
.long 877182262,878820398,880456307,881446790,880456307,881650762,882669278,883685380,882262147,883482364,884698831,885911136,883888290,885305529,886716823,888121522
.long 885507522,887118867,888721356,889753235,887118867,888920996,889951495,890839294,888721356,889951495,890937478,891913924,889753235,890839294,891913924,892975902
.long 890544177,891719442,892879914,894024019,891329253,892591269,893834537,895057081,892107988,893454110,894776897,896073911,892879914,894307306,895706106,897073352
.long 0,0,0,0,865518380,866341323,867164167,867986901,873900293,874721420,875542144,876362435,878820398,880047552,881038594,881650762
.long 882262147,883076022,883888290,884698831,884698831,885709391,886716823,887720890,887118867,888321617,889355712,889951495,889355712,890050496,890741015,891426951
.long 890544177,891329253,892107988,892879914,891719442,892591269,893454110,894307306,892879914,893834537,894776897,895706106,894024019,895057081,896073911,897073352
.long 895150208,896256955,897342759,897993602,896256955,897432251,898081078,898641365,897342759,898081078,898683853,899269120,897993602,898641365,899269120,899875539
.long 905969664,905949455,905888877,905788076,905969664,905946851,905878473,905764716,905969664,905944088,905867440,905739952,905969664,905941169,905855779,905713786
.long 905969664,905938091,905843492,905686221,905969664,905934856,905830577,905657259,905969664,905931463,905817036,905626902,905969664,905927913,905802868,905595152
.long 905969664,905924205,905788076,905562013,905969664,905920340,905772659,905527488,905969664,905916317,905756617,905491579,905969664,905912137,905739952,905454289
.long 905969664,905907800,905722664,905415621,905969664,905903305,905704753,905375579,905969664,905898653,905686221,905334167,905969664,905893844,905667068,905291387
.long 905647294,905466872,905247243,904988936,905605890,905402426,905154879,904863920,905562013,905334167,905057106,904731677,905515672,905262109,904953958,904592268
.long 905466872,905186269,904845470,904445756,905415621,905106667,904731677,904292209,905361927,905023319,904612620,904131699,905305798,904936247,904488337,903964298
.long 905247243,904845470,904358872,903790085,905186269,904751009,904224267,903609140,905122887,904652888,904084570,903421546,905057106,904551129,903939826,903227390
.long 904988936,904445756,903790085,903026761,904918387,904336793,903635399,902819752,904845470,904224267,903475818,902606457,904770195,904108204,903311398,902386977
.long 904692574,904358872,903988632,903582746,904530343,904155052,903739070,903283528,904358872,903939826,903475818,902968262,904178265,903713357,903199123,902637309
.long 903988632,903475818,902909245,902291045,903790085,903227390,902606457,901929865,903582746,902968262,902291045,901554179,903366739,902698633,901963305,901164415
.long 903142193,902418706,901623545,900761019,902909245,902128697,901272086,900344448,902668034,901828826,900909257,899915177,902418706,901519321,900535401,899473695
.long 902161411,901200419,900150870,899020505,901896304,900872362,899756025,898556123,901623545,900535401,899351238,898081078,901343298,900189793,898936889,897595910
.long 903142193,902668034,902161411,901623545,902789663,902258821,901692443,901092071,902418706,901828826,901200419,900535401,902029824,901378732,900686245,899954714
.long 901623545,900909257,900150870,899351238,901200419,900421147,899595282,898726251,900761019,899915177,899020505,898081078,900305941,899392153,898427600,897253111
.long 899835801,898852906,897817661,895890293,899351238,898298295,896802567,894495530,898852906,897729201,895521359,893071776,898341483,896712003,894213003,891622047
.long 897817661,895521359,892879914,890149410,896983243,894307306,891524549,888121522,895890293,893071776,890149410,885103415,894776897,891816735,888321617,882058442
.long 0,868809520,877182262,882262147,0,869632014,878001593,882872699,0,870454377,878820398,883482364,0,871276600,879638646,884091092
.long 0,872098676,880456307,884698831,0,872667914,881038594,885305529,0,873078794,881446790,885911136,0,873489588,881854647,886515599
.long 0,873900293,882262147,887118867,0,874310905,882669278,887720890,0,874721420,883076022,888321617,0,875131834,883482364,888920996
.long 0,875542144,883888290,889355712,0,875952346,884293784,889653978,0,876362435,884698831,889951495,0,876772409,885103415,890248236
.long 885507522,888721356,890544177,892107988,886314241,889455216,891133560,892783811,887118867,889951495,891719442,893454110,887921279,890445621,892301626,894118574
.long 888721356,890937478,892879914,894776897,889355712,891426951,893454110,895428777,889753235,891913924,894024019,896073911,890149410,892398283,894589449,896712003
.long 890544177,892879914,895150208,897342759,890937478,893358703,895706106,897773471,891329253,893834537,896256955,898081078,891719442,894307306,896802567,898384585
.long 892107988,894776897,897342759,898683853,892494831,895243201,897729201,898978743,892879914,895706106,897993602,899269120,893263178,896165505,898255021,899554850
.long 893644565,895150208,896621290,897817661,894401482,895982173,897521586,898298295,895150208,896802567,897993602,898768560,895890293,897595910,898427600,899227919
.long 896621290,897993602,898852906,899675851,897342759,898384585,899269120,900111843,897817661,898768560,899675851,900535401,898168219,899145234,900072714,900946042
.long 898513370,899514321,900459338,901343298,898852906,899875539,900835357,901726716,899186624,900228613,901200419,902095861,899514321,900573273,901554179,902450311
.long 899835801,900909257,901896304,902789663,900150870,901236309,902226474,903113531,900459338,901554179,902544376,903421546,900761019,901862625,902849711,903713357
.long 898513370,899186624,899835801,900459338,899020505,899715987,900382850,901019279,899514321,900228613,900909257,901554179,899994149,900723686,901414052,902062903
.long 900459338,901200419,901896304,902544376,900909257,901658053,902355123,902997577,901343298,902095861,902789663,903421546,901760871,902513146,903199123,903815387
.long 902161411,902909245,903582746,904178265,902544376,903283528,903939826,904509412,902909245,903635399,904269704,904808126,903255525,903964298,904571771,905073776
.long 903582746,904269704,904845470,905305798,903890465,904551129,905090296,905503702,904178265,904808126,905305798,905667068,904445756,905040287,905491579,905795550
.long 905969664,905969664,905969664,905969664,905949455,905946851,905944088,905941169,905888877,905878473,905867440,905855779,905788076,905764716,905739952,905713786
.long 905647294,905605890,905562013,905515672,905466872,905402426,905334167,905262109,905247243,905154879,905057106,904953958,904988936,904863920,904731677,904592268
.long 904692574,904530343,904358872,904178265,904358872,904155052,903939826,903713357,903988632,903739070,903475818,903199123,903582746,903283528,902968262,902637309
.long 903142193,902789663,902418706,902029824,902668034,902258821,901828826,901378732,902161411,901692443,901200419,900686245,901623545,901092071,900535401,899954714
.long 905969664,905969664,905969664,905969664,905938091,905934856,905931463,905927913,905843492,905830577,905817036,905802868,905686221,905657259,905626902,905595152
.long 905466872,905415621,905361927,905305798,905186269,905106667,905023319,904936247,904845470,904731677,904612620,904488337,904445756,904292209,904131699,903964298
.long 903988632,903790085,903582746,903366739,903475818,903227390,902968262,902698633,902909245,902606457,902291045,901963305,902291045,901929865,901554179,901164415
.long 901623545,901200419,900761019,900305941,900909257,900421147,899915177,899392153,900150870,899595282,899020505,898427600,899351238,898726251,898081078,897253111
.long 905969664,905969664,905969664,905969664,905924205,905920340,905916317,905912137,905788076,905772659,905756617,905739952,905562013,905527488,905491579,905454289
.long 905247243,905186269,905122887,905057106,904845470,904751009,904652888,904551129,904358872,904224267,904084570,903939826,903790085,903609140,903421546,903227390
.long 903142193,902909245,902668034,902418706,902418706,902128697,901828826,901519321,901623545,901272086,900909257,900535401,900761019,900344448,899915177,899473695
.long 899835801,899351238,898852906,898341483,898852906,898298295,897729201,896712003,897817661,896802567,895521359,894213003,895890293,894495530,893071776,891622047
.long 905969664,905969664,905969664,905969664,905907800,905903305,905898653,905893844,905722664,905704753,905686221,905667068,905415621,905375579,905334167,905291387
.long 904988936,904918387,904845470,904770195,904445756,904336793,904224267,904108204,903790085,903635399,903475818,903311398,903026761,902819752,902606457,902386977
.long 902161411,901896304,901623545,901343298,901200419,900872362,900535401,900189793,900150870,899756025,899351238,898936889,899020505,898556123,898081078,897595910
.long 897817661,896983243,895890293,894776897,895521359,894307306,893071776,891816735,892879914,891524549,890149410,888321617,890149410,888121522,885103415,882058442
.long 0,0,0,0,868809520,869632014,870454377,871276600,877182262,878001593,878820398,879638646,882262147,882872699,883482364,884091092
.long 885507522,886314241,887118867,887921279,888721356,889455216,889951495,890445621,890544177,891133560,891719442,892301626,892107988,892783811,893454110,894118574
.long 893644565,894401482,895150208,895890293,895150208,895982173,896802567,897595910,896621290,897521586,897993602,898427600,897817661,898298295,898768560,899227919
.long 898513370,899020505,899514321,899994149,899186624,899715987,900228613,900723686,899835801,900382850,900909257,901414052,900459338,901019279,901554179,902062903
.long 0,0,0,0,872098676,872667914,873078794,873489588,880456307,881038594,881446790,881854647,884698831,885305529,885911136,886515599
.long 888721356,889355712,889753235,890149410,890937478,891426951,891913924,892398283,892879914,893454110,894024019,894589449,894776897,895428777,896073911,896712003
.long 896621290,897342759,897817661,898168219,897993602,898384585,898768560,899145234,898852906,899269120,899675851,900072714,899675851,900111843,900535401,900946042
.long 900459338,900909257,901343298,901760871,901200419,901658053,902095861,902513146,901896304,902355123,902789663,903199123,902544376,902997577,903421546,903815387
.long 0,0,0,0,873900293,874310905,874721420,875131834,882262147,882669278,883076022,883482364,887118867,887720890,888321617,888920996
.long 890544177,890937478,891329253,891719442,892879914,893358703,893834537,894307306,895150208,895706106,896256955,896802567,897342759,897773471,898081078,898384585
.long 898513370,898852906,899186624,899514321,899514321,899875539,900228613,900573273,900459338,900835357,901200419,901554179,901343298,901726716,902095861,902450311
.long 902161411,902544376,902909245,903255525,902909245,903283528,903635399,903964298,903582746,903939826,904269704,904571771,904178265,904509412,904808126,905073776
.long 0,0,0,0,875542144,875952346,876362435,876772409,883888290,884293784,884698831,885103415,889355712,889653978,889951495,890248236
.long 892107988,892494831,892879914,893263178,894776897,895243201,895706106,896165505,897342759,897729201,897993602,898255021,898683853,898978743,899269120,899554850
.long 899835801,900150870,900459338,900761019,900909257,901236309,901554179,901862625,901896304,902226474,902544376,902849711,902789663,903113531,903421546,903713357
.long 903582746,903890465,904178265,904445756,904269704,904551129,904808126,905040287,904845470,905090296,905305798,905491579,905305798,905503702,905667068,905795550
.long 901055731,900459338,899835801,899186624,900459338,899795963,899103751,898384585,899835801,899103751,898341483,897521586,899186624,898384585,897521586,895798270
.long 898513370,897640420,895890293,894024019,897817661,896165505,894213003,892204860,896621290,894589449,892494831,890346973,895150208,892975902,890741015,887720890
.long 893644565,891329253,888721356,883888290,892107988,889653978,885103415,879229594,890544177,886716823,881446790,870454377,888721356,883279244,874721420,2982744006
.long 885507522,878820398,860424880,3019582324,882262147,871276600,3011201466,3027531200,877182262,843648904,3023025792,3031777432,868809520,3015470549,3029338295,3035605170
.long 898513370,897817661,896621290,895150208,897640420,896165505,894589449,892975902,895890293,894213003,892494831,890741015,894024019,892204860,890346973,887720890
.long 892107988,890149410,887118867,883076022,890149410,886917914,882669278,875952346,887118867,882669278,875542144,857131446,883076022,875952346,857131446,3017115662
.long 877182262,860424880,3016293168,3027939955,865518380,3013824971,3027122294,3032789177,3007908528,3025485241,3032182479,3037038286,3023025792,3031169028,3036604129,3039300383
.long 3029745795,3035404927,3038812901,3041507667,3033797889,3038126290,3040937758,3043649153,3037236883,3040171244,3043005007,3045389444,3039203090,3042166887,3045005234,3046378591
.long 893644565,892107988,890544177,888721356,891329253,889653978,886716823,883279244,888721356,885103415,881446790,874721420,883888290,879229594,870454377,2982744006
.long 877182262,865518380,3007908528,3023025792,860424880,3013824971,3025485241,3031169028,3016293168,3027122294,3032182479,3036604129,3027939955,3032789177,3037038286,3039300383
.long 3032991170,3037236883,3039591636,3041885130,3037236883,3039688508,3042073097,3044376629,3039591636,3042073097,3044466891,3045911248,3041885130,3044376629,3045911248,3047038498
.long 3044104938,3045825131,3046997969,3048094686,3045651867,3046875801,3048019049,3049072568,3046670272,3047866498,3048967995,3049965439,3047634518,3048791397,3049838771,3050767176
.long 885507522,882262147,877182262,868809520,878820398,871276600,843648904,3015470549,860424880,3011201466,3023025792,3029338295,3019582324,3027531200,3031777432,3035605170
.long 3029745795,3033797889,3037236883,3039203090,3035404927,3038126290,3040171244,3042166887,3038812901,3040937758,3043005007,3045005234,3041507667,3043649153,3045389444,3046378591
.long 3044104938,3045651867,3046670272,3047634518,3045825131,3046875801,3047866498,3048791397,3046997969,3048019049,3048967995,3049838771,3048094686,3049072568,3049965439,3050767176
.long 3049107193,3050028024,3050850387,3051568218,3050028024,3050877857,3051615347,3052234657,3050850387,3051615347,3052253843,3052760471,3051568218,3052234657,3052760471,3053140907
.long 901055731,901623545,902161411,902668034,901623545,902194004,902729104,903227390,902161411,902729104,903255525,903739070,902668034,903227390,903739070,904201337
.long 903142193,903687507,904178265,904612620,903582746,904108204,904571771,904971521,903988632,904488337,904918387,905276823,904358872,904826872,905217058,905527488
.long 904692574,905122887,905466872,905722664,904988936,905375579,905667068,905861688,905247243,905584260,905817036,905944088,905466872,905748362,905916317,905969585
.long 905647294,905867440,905964611,905938091,905788076,905941169,905961769,905849714,905888877,905969348,905907800,905704753,905949455,905951902,905802868,905503702
.long 903142193,903582746,903988632,904358872,903687507,904108204,904488337,904826872,904178265,904571771,904918387,905217058,904612620,904971521,905276823,905527488
.long 904988936,905305798,905562013,905756617,905305798,905573214,905772659,905903305,905562013,905772659,905907800,905966822,905756617,905903305,905966822,905946851
.long 905888877,905964611,905949455,905843492,905958295,905956322,905855779,905657259,905964611,905878473,905686221,905389079,905907800,905731386,905441552,905040287
.long 905788076,905515672,905122887,904612620,905605890,905232226,904731677,904108204,905361927,904882224,904269704,903529552,905057106,904467118,903739070,902879543
.long 904692574,904988936,905247243,905466872,905122887,905375579,905584260,905748362,905466872,905667068,905817036,905916317,905722664,905861688,905944088,905969585
.long 905888877,905958295,905964611,905907800,905964611,905956322,905878473,905731386,905949455,905855779,905686221,905441552,905843492,905657259,905389079,905040287
.long 905647294,905361927,904988936,904530343,905361927,904971521,904488337,903915215,904988936,904488337,903890465,903199123,904530343,903915215,903199123,902386977
.long 903988632,903255525,902418706,901484347,903366739,902513146,901554179,900497423,902668034,901692443,900611038,899432972,901896304,900798242,899595282,898298295
.long 905647294,905788076,905888877,905949455,905867440,905941169,905969348,905951902,905964611,905961769,905907800,905802868,905938091,905849714,905704753,905503702
.long 905788076,905605890,905361927,905057106,905515672,905232226,904882224,904467118,905122887,904731677,904269704,903739070,904612620,904108204,903529552,902879543
.long 903988632,903366739,902668034,901896304,903255525,902513146,901692443,900798242,902418706,901554179,900611038,899595282,901484347,900497423,899432972,898298295
.long 900459338,899351238,898168219,896256955,899351238,898124690,896073911,893358703,898168219,896073911,893263178,890346973,896256955,893358703,890346973,885305529
.long 905969664,905969664,905969664,905969664,905888877,905883753,905878473,905873035,905647294,905626902,905605890,905584260,905247243,905201739,905154879,905106667
.long 904692574,904612620,904530343,904445756,903988632,903865577,903739070,903609140,903142193,902968262,902789663,902606457,902161411,901929865,901692443,901449257
.long 901055731,900761019,900459338,900150870,899835801,899473695,899103751,898726251,898513370,898081078,897640420,896802567,896621290,895613802,894589449,893549397
.long 893644565,892494831,891329253,890149410,890544177,889256128,886716823,884091092,885507522,882669278,878820398,873078794,877182262,869632014,843648904,3013824971
.long 905969664,905969664,905969664,905969664,905867440,905861688,905855779,905849714,905562013,905539150,905515672,905491579,905057106,905006202,904953958,904900379
.long 904358872,904269704,904178265,904084570,903475818,903339135,903199123,903055815,902418706,902226474,902029824,901828826,901200419,900946042,900686245,900421147
.long 899835801,899514321,899186624,898852906,898341483,897949740,897521586,896712003,895890293,894963819,894024019,893071776,892494831,891426951,890346973,889256128
.long 888721356,886314241,883888290,881446790,881446790,876772409,870454377,855331147,860424880,3004615094,3019582324,3025485241,3023025792,3028726382,3031777432,3034803331
.long 905969664,905969664,905969664,905969664,905843492,905837112,905830577,905823884,905466872,905441552,905415621,905389079,904845470,904789234,904731677,904672804
.long 903988632,903890465,903790085,903687507,902909245,902759447,902606457,902450311,901623545,901414052,901200419,900982716,900150870,899875539,899595282,899310227
.long 898513370,898168219,897817661,897342759,895890293,895057081,894213003,893358703,892107988,891133560,890149410,889120481,887118867,884901182,882669278,880047552
.long 877182262,872098676,860424880,2999520912,3007908528,3020151562,3025485241,3029542090,3029745795,3032587063,3035404927,3037435143,3037236883,3038715103,3040171244,3041602222
.long 905969664,905969664,905969664,905969664,905817036,905810030,905802868,905795550,905361927,905334167,905305798,905276823,904612620,904551129,904488337,904424249
.long 903582746,903475818,903366739,903255525,902291045,902128697,901963305,901794908,900761019,900535401,900305941,900072714,899020505,898726251,898427600,898124690
.long 896621290,895890293,895150208,894401482,892494831,891622047,890741015,889852407,887118867,885103415,883076022,881038594,875542144,869632014,857131446,3002814795
.long 3016293168,3023025792,3027939955,3030559670,3032182479,3034803331,3037038286,3038322942,3038812901,3040171244,3041507667,3042819705,3043005007,3044376629,3045389444,3046039771
.long 0,0,0,0,877182262,877591991,878001593,878411063,885507522,885911136,886314241,886716823,890544177,890839294,891133560,891426951
.long 893644565,894024019,894401482,894776897,896621290,897073352,897521586,897773471,898513370,898768560,899020505,899269120,899835801,900111843,900382850,900648695
.long 901055731,901343298,901623545,901896304,902161411,902450311,902729104,902997577,903142193,903421546,903687507,903939826,903988632,904247056,904488337,904712199
.long 904692574,904918387,905122887,905305798,905247243,905428663,905584260,905713786,905647294,905772659,905867440,905931463,905888877,905946851,905969348,905956322
.long 0,0,0,0,878820398,879229594,879638646,880047552,887118867,887520358,887921279,888321617,891719442,892011009,892301626,892591269
.long 895150208,895521359,895890293,896256955,897993602,898211662,898427600,898641365,899514321,899756025,899994149,900228613,900909257,901164415,901414052,901658053
.long 902161411,902418706,902668034,902909245,903255525,903502752,903739070,903964298,904178265,904402600,904612620,904808126,904918387,905106667,905276823,905428663
.long 905466872,905605890,905722664,905817036,905817036,905893844,905944088,905967690,905964611,905966822,905938091,905878473,905907800,905823884,905704753,905550659
.long 0,0,0,0,880456307,880834373,881038594,881242734,888721356,889120481,889355712,889554638,892879914,893167535,893454110,893739612
.long 896621290,896983243,897342759,897640420,898852906,899062175,899269120,899473695,900459338,900686245,900909257,901128300,901896304,902128697,902355123,902575480
.long 903142193,903366739,903582746,903790085,904178265,904380807,904571771,904751009,904988936,905154879,905305798,905441552,905562013,905676722,905772659,905849714
.long 905888877,905938091,905964611,905968401,905964611,905934856,905878473,905795550,905788076,905667068,905515672,905334167,905361927,905138958,904882224,904592268
.long 0,0,0,0,881446790,881650762,881854647,882058442,889753235,889951495,890149410,890346973,894024019,894307306,894589449,894870425
.long 897817661,897993602,898168219,898341483,899675851,899875539,900072714,900267329,901343298,901554179,901760871,901963305,902789663,902997577,903199123,903394209
.long 903988632,904178265,904358872,904530343,904918387,905073776,905217058,905348123,905562013,905667068,905756617,905830577,905907800,905946851,905966822,905967690
.long 905949455,905907800,905843492,905756617,905686221,905550659,905389079,905201739,905122887,904882224,904612620,904314572,904269704,903915215,903529552,903113531
.long 453849394,3016293168,3024665910,3029745795,3024665910,3029949408,3033394784,3036739776,3032991170,3036604129,3038421126,3040171244,3038027825,3039881931,3041696651,3043465821
.long 3041128213,3043005007,3044826407,3045825131,3044104938,3045521030,3046420537,3047279611,3045997018,3046916620,3047789589,3048611948,3047319449,3048207334,3049037827,3049806794
.long 3048539379,3049379952,3050151682,3050850387,3049645059,3050422466,3051119047,3051730704,3050625841,3051324199,3051929404,3052437606,3051472280,3052075916,3052573944,3052962950
.long 3052176222,3052669917,3053045661,3053300684,3052730891,3053100121,3053339427,3053446917,3053130942,3053362121,3053452049,3053399965,3053372525,3053453233,3053382301,3053160370
.long 3032991170,3036205004,3038027825,3039591636,3038421126,3040074917,3041696651,3043281918,3041885130,3043557559,3045124068,3045911248,3045124068,3045954177,3046752768,3047517131
.long 3046670272,3047477797,3048244667,3048967995,3048094686,3048862380,3049579509,3050243095,3049379952,3050090105,3050739173,3051324199,3050510409,3051145169,3051707915,3052195847
.long 3051472280,3052013991,3052472584,3052845575,3052253843,3052685387,3053022798,3053264093,3052845575,3053150716,3053351088,3053445417,3053240265,3053403988,3053452996,3053386953
.long 3053433103,3053441943,3053327140,3053089538,3053421739,3053264093,3052975227,3052557424,3053206312,3052872727,3052402035,3051798220,3052789446,3052272882,3051615347,3050822783
.long 3041128213,3042633856,3044104938,3045301309,3044826407,3045695310,3046420537,3047119263,3046670272,3047398825,3048094686,3048755734,3048244667,3048932905,3049579509,3050182281
.long 3049645059,3050273311,3050850387,3051374113,3050850387,3051398863,3051886248,3052310520,3051842520,3052291774,3052669917,3052975227,3052606535,3052937937,3053188401,3053356683
.long 3053130942,3053327140,3053433103,3053448259,3053407853,3053453233,3053399965,3053248364,3053433103,3053314225,3053089538,3052760471,3053206312,3052912311,3052506967,3051993060
.long 3052730891,3052253843,3051661913,3050959466,3052013991,3051349225,3050568387,3049677652,3051066394,3050212752,3049244519,3048169893,3049902354,3048862380,3047712261,3046462391
.long 3045997018,3046670272,3047319449,3047942986,3047789589,3048429690,3049037827,3049612345,3049379952,3049965439,3050510409,3051013200,3050739173,3051248294,3051707915,3052116475
.long 3051842520,3052253843,3052606535,3052899269,3052669917,3052962950,3053188401,3053345336,3053206312,3053362121,3053441943,3053445417,3053441943,3053443759,3053362121,3053197434
.long 3053372525,3053206312,3052950520,3052606535,3052999320,3052654297,3052215325,3051684985,3052329118,3051798220,3051171155,3050451910,3051374113,3050654372,3049838771,3048932905
.long 3050151682,3049244519,3048244667,3047159499,3048684067,3047595491,3046420537,3045168499,3046997969,3045738669,3043740603,3040937758,3045124068,3042354073,3039397572,3036005210
.long 905969664,905949455,905888877,905788076,905888877,905780445,905626902,905428663,905647294,905441552,905186269,904882224,905247243,904936247,904571771,904155052
.long 904692574,904269704,903790085,903255525,903988632,903448749,902849711,902194004,903142193,902481791,901760871,900982716,902161411,901378732,900535401,899635615
.long 901055731,900150870,899186624,898168219,899835801,898810778,897729201,895613802,898513370,897163309,894776897,892301626,896621290,894118574,891524549,888521562
.long 893644565,890937478,887118867,881446790,890544177,886112753,879638646,862071418,885507522,878001593,852037264,3022205068,877182262,835260358,3023846083,3032384830
.long 905647294,905466872,905247243,904988936,905186269,904900379,904571771,904201337,904530343,904131699,903687507,903199123,903687507,903170724,902606457,901996625
.long 902668034,902029824,901343298,900611038,901484347,900723686,899915177,899062175,900150870,899269120,898341483,897163309,898683853,897684851,895706106,893549397
.long 896621290,894401482,892107988,889753235,893263178,890839294,887520358,882465760,889753235,885103415,878820398,863717818,883076022,874310905,2991132552,3023435994
.long 868809520,3013002028,3027939955,3033797889,3019582324,3029949408,3035805265,3039105695,3031371938,3037038286,3039978479,3042819705,3037633058,3040651183,3043557559,3045695310
.long 904692574,904358872,903988632,903582746,903790085,903339135,902849711,902323146,902668034,902095861,901484347,900835357,901343298,900648695,899915177,899145234
.long 899835801,899020505,898168219,896983243,898168219,896892981,894963819,892975902,895150208,893071776,890937478,888321617,891329253,888920996,884293784,878411063
.long 885507522,880456307,868809520,3007908528,873900293,2982744006,3022205068,3030356347,3016293168,3028522242,3033797889,3037830621,3031371938,3036739776,3039397572,3041979178
.long 3038027825,3040746826,3043373941,3045477250,3041885130,3044557000,3046082436,3047279611,3045301309,3046587399,3047789589,3048897700,3046997969,3048207334,3049312474,3050303400
.long 903142193,902668034,902161411,901623545,901760871,901164415,900535401,899875539,900150870,899432972,898683853,897905796,898341483,897432251,895706106,893929340
.long 895150208,893263178,891329253,889355712,890937478,888521562,884293784,879229594,883888290,878001593,865518380,3011201466,865518380,3012178991,3025485241,3031574740
.long 3024665910,3031371938,3036205004,3038812901,3035404927,3038519215,3040937758,3043281918,3040363562,3042819705,3045124068,3046252208,3044466891,3045954177,3047078930,3048132343
.long 3046670272,3047789589,3048826946,3049774693,3048392905,3049413513,3050333359,3051145169,3049902354,3050795046,3051568218,3052215325,3051171155,3051907897,3052506967,3052962950
.long 905969664,905969664,905969664,905969664,905788076,905780445,905772659,905764716,905247243,905217058,905186269,905154879,904358872,904292209,904224267,904155052
.long 903142193,903026761,902909245,902789663,901623545,901449257,901272086,901092071,899835801,899595282,899351238,899103751,897817661,897432251,896802567,896165505
.long 893644565,892879914,892107988,891329253,888721356,886917914,885103415,883279244,877182262,873078794,865518380,843648904,3016293168,3022615482,3027122294,3029949408
.long 3032991170,3035404927,3037236883,3038421126,3039591636,3040842351,3042073097,3043281918,3044104938,3045212849,3045825131,3046420537,3046670272,3047279611,3047866498,3048429690
.long 905969664,905969664,905969664,905969664,905756617,905748362,905739952,905731386,905122887,905090296,905057106,905023319,904084570,904012826,903939826,903865577
.long 902668034,902544376,902418706,902291045,900909257,900723686,900535401,900344448,898852906,898598788,898341483,898081078,895521359,894870425,894213003,893549397
.long 890544177,889753235,888721356,887118867,881446790,878411063,874721420,869632014,3007908528,3017938025,3023025792,3027122294,3032182479,3034401562,3036604129,3037731884
.long 3039591636,3040746826,3041885130,3043005007,3044466891,3045345417,3045911248,3046462391,3046997969,3047556362,3048094686,3048611948,3048967995,3049480273,3049965439,3050422466
.long 905969664,905969664,905969664,905969664,905722664,905713786,905704753,905695565,904988936,904953958,904918387,904882224,903790085,903713357,903635399,903556217
.long 902161411,902029824,901896304,901760871,900150870,899954714,899756025,899554850,897817661,897521586,896983243,896439417,892879914,892204860,891524549,890839294
.long 885507522,883888290,882262147,880456307,860424880,2982744006,3011201466,3018760248,3029745795,3031777432,3033797889,3035805265,3038812901,3039881931,3040937758,3041979178
.long 3044104938,3045124068,3045651867,3046167501,3046997969,3047517131,3048019049,3048502927,3049107193,3049579509,3050028024,3050451910,3050850387,3051248294,3051615347,3051950766
.long 905969664,905969664,905969664,905969664,905686221,905676722,905667068,905657259,904845470,904808126,904770195,904731677,903475818,903394209,903311398,903227390
.long 901623545,901484347,901343298,901200419,899351238,899145234,898936889,898726251,895890293,895336057,894776897,894213003,890149410,889455216,888321617,886917914
.long 877182262,873900293,868809520,860424880,3023025792,3026713242,3029338295,3031169028,3037236883,3038224663,3039203090,3040171244,3043005007,3044014075,3045005234,3045521030
.long 3046670272,3047159499,3047634518,3048094686,3048967995,3049413513,3049838771,3050243095,3050850387,3051222718,3051568218,3051886248,3052253843,3052523935,3052760471,3052962950
.long 0,0,0,0,882262147,882465760,882669278,882872699,890544177,890741015,890937478,891133560,895150208,895428777,895706106,895982173
.long 898513370,898683853,898852906,899020505,900459338,900648695,900835357,901019279,902161411,902355123,902544376,902729104,903582746,903764646,903939826,904108204
.long 904692574,904845470,904988936,905122887,905466872,905573214,905667068,905748362,905888877,905931463,905958295,905969348,905949455,905912137,905855779,905780445
.long 905647294,905515672,905361927,905186269,904988936,904751009,904488337,904201337,903988632,903635399,903255525,902849711,902668034,902194004,901692443,901164415
.long 0,0,0,0,883076022,883279244,883482364,883685380,891329253,891524549,891719442,891913924,896256955,896530427,896802567,897073352
.long 899186624,899351238,899514321,899675851,901200419,901378732,901554179,901726716,902909245,903084739,903255525,903421546,904269704,904424249,904571771,904712199
.long 905247243,905361927,905466872,905562013,905817036,905873035,905916317,905946851,905964611,905944088,905907800,905855779,905686221,905573214,905441552,905291387
.long 904988936,904770195,904530343,904269704,903890465,903556217,903199123,902819752,902418706,901963305,901484347,900982716,900611038,900033483,899432972,898810778
.long 0,0,0,0,883888290,884091092,884293784,884496364,892107988,892301626,892494831,892687596,897342759,897595910,897729201,897861769
.long 899835801,899994149,900150870,900305941,901896304,902062903,902226474,902386977,903582746,903739070,903890465,904036880,904845470,904971521,905090296,905201739
.long 905647294,905722664,905788076,905843492,905964611,905969585,905961769,905941169,905788076,905704753,905605890,905491579,905122887,904936247,904731677,904509412
.long 903988632,903687507,903366739,903026761,902418706,901996625,901554179,901092071,900459338,899915177,899351238,898768560,898168219,897432251,896073911,894683239
.long 0,0,0,0,884698831,884901182,885103415,885305529,892879914,893071776,893263178,893454110,897993602,898124690,898255021,898384585
.long 900459338,900611038,900761019,900909257,902544376,902698633,902849711,902997577,904178265,904314572,904445756,904571771,905305798,905402426,905491579,905573214
.long 905888877,905924205,905949455,905964611,905907800,905861688,905802868,905731386,905361927,905217058,905057106,904882224,904269704,904012826,903739070,903448749
.long 902668034,902291045,901896304,901484347,900611038,900111843,899595282,899062175,898168219,897521586,896256955,894963819,893263178,891816735,890346973,888521562
.long 3048539379,3049107193,3049645059,3050151682,3050151682,3050654372,3051119047,3051544443,3051472280,3051886248,3052253843,3052573944,3052472584,3052775035,3053022798,3053215034
.long 3053130942,3053300684,3053407853,3053452049,3053433103,3053451338,3053399965,3053279198,3053372525,3053223600,3052999320,3052700706,3052950520,3052622606,3052215325,3051730704
.long 3052176222,3051661913,3051066394,3050392893,3051066394,3050363191,3049579509,3048719957,3049645059,3048755734,3047789589,3046752768,3047942986,3046875801,3045738669,3044014075
.long 3045997018,3044466891,3041885130,3039203090,3042633856,3039881931,3037038286,3031574740,3038027825,3033394784,3026304046,3004615094,3029745795,3017115662,867164167,881650762
.long 3050625841,3051066394,3051472280,3051842520,3051929404,3052272882,3052573944,3052831771,3052845575,3053067908,3053240265,3053362121,3053351088,3053430499,3053452996,3053418504
.long 3053433103,3053351088,3053206312,3052999320,3053089538,3052831771,3052506967,3052116475,3052329118,3051886248,3051374113,3050795046,3051171155,3050539463,3049838771,3049072568
.long 3049645059,3048826946,3047942986,3046997969,3047789589,3046793875,3045738669,3044195651,3045651867,3043923065,3041507667,3039008197,3041507667,3038910599,3035805265,3030356347
.long 3036205004,3030559670,3021383941,852037264,3023025792,835260358,876362435,884496364,873900293,883482364,889355712,892301626,887921279,891622047,894589449,897432251
.long 3052176222,3052472584,3052730891,3052950520,3053045661,3053215034,3053339427,3053418504,3053433103,3053452996,3053421739,3053339427,3053327140,3053179213,3052975227,3052715874
.long 3052730891,3052402035,3052013991,3051568218,3051661913,3051145169,3050568387,3049933959,3050151682,3049446953,3048684067,3047866498,3048244667,3047359187,3046420537,3045433388
.long 3045997018,3044826407,3042633856,3040363562,3041885130,3039494657,3037038286,3032384830,3036205004,3030966012,3023025792,2991132552,3021383941,848743256,876362435,884091092
.long 877182262,884698831,889753235,892494831,889753235,892591269,895336057,897773471,895150208,897729201,899020505,900228613,898852906,900111843,901272086,902323146
.long 3053130942,3053271724,3053372525,3053433103,3053452049,3053439970,3053382301,3053279198,3053206312,3053022798,3052789446,3052506967,3052402035,3052034777,3051615347,3051145169
.long 3051066394,3050510409,3049902354,3049244519,3049244519,3048502927,3047712261,3046875801,3046997969,3046082436,3045124068,3043189754,3043740603,3041602222,3039397572,3037137626
.long 3038027825,3034602515,3029745795,3021383941,3026304046,3012178991,867164167,880047552,873900293,882669278,887921279,891133560,889355712,892011009,894589449,897073352
.long 895150208,897640420,898852906,899994149,899020505,900189793,901272086,902258821,901343298,902355123,903255525,904036880,903255525,904060795,904731677,905262109
.long 901055731,900459338,899835801,899186624,899186624,898470529,897729201,896348259,896621290,894963819,893263178,891524549,892107988,890248236,887520358,883685380
.long 885507522,881446790,873900293,852037264,868809520,3002814795,3022205068,3029542090,3024665910,3030966012,3035404927,3038224663,3036205004,3038715103,3040937758,3043097450
.long 3041128213,3043373941,3045301309,3046336554,3045301309,3046378591,3047398825,3048356010,3047319449,3048319005,3049244519,3050090105,3049107193,3049996794,3050795046,3051496474
.long 3050625841,3051374113,3052013991,3052540754,3051842520,3052419895,3052872727,3053197434,3052730891,3053110550,3053351088,3053450470,3053271724,3053430499,3053437839,3053293678
.long 898513370,897817661,896621290,895150208,894776897,893167535,891524549,889852407,889753235,886716823,883076022,878001593,878820398,869632014,2991132552,3020151562
.long 3016293168,3026304046,3031371938,3035404927,3033797889,3037336055,3039397572,3041412988,3040363562,3042447467,3044466891,3045738669,3045124068,3046125013,3047078930,3047981071
.long 3047319449,3048244667,3049107193,3049902354,3049244519,3050059128,3050795046,3051447946,3050850387,3051520528,3052096268,3052573944,3052096268,3052590315,3052975227,3053248364
.long 3052950520,3053240265,3053407853,3053452049,3053391448,3053453233,3053382301,3053179213,3053407853,3053223600,3052899269,3052437606,3052999320,3052557424,3051971985,3051248294
.long 893644565,892107988,890544177,888721356,887118867,883685380,879638646,872667914,868809520,2991132552,3019582324,3027122294,3027939955,3031980012,3035805265,3038126290
.long 3038027825,3039978479,3041885130,3043740603,3043373941,3045168499,3046082436,3046957343,3046670272,3047556362,3048392905,3049176091,3048826946,3049612345,3050333359,3050986400
.long 3050625841,3051273733,3051842520,3052329118,3052013991,3052489850,3052872727,3053160370,3052950520,3053223600,3053391448,3053452996,3053407853,3053452601,3053382301,3053197434
.long 3053372525,3053169869,3052845575,3052402035,3052845575,3052384027,3051798220,3051092788,3051842520,3051119047,3050273311,3049312474,3050392893,3049413513,3048319005,3047119263
.long 885507522,882262147,877182262,868809520,852037264,3013824971,3023846083,3029542090,3031371938,3035004006,3037633058,3039397572,3039978479,3041790954,3043557559,3045168499
.long 3045301309,3046167501,3046997969,3047789589,3047789589,3048575719,3049312474,3049996794,3049902354,3050568387,3051171155,3051707915,3051568218,3052075916,3052506967,3052859227
.long 3052730891,3053045661,3053271724,3053407853,3053351088,3053443759,3053437839,3053333362,3053407853,3053256307,3052999320,3052638527,3052899269,3052489850,3051971985,3051349225
.long 3051842520,3051171155,3050392893,3049513472,3050273311,3049346273,3048319005,3047199635,3048244667,3047078930,3045825131,3043923065,3045825131,3043831907,3040937758,3037929269
.long 0,131328,131328,141568,128,131408,131408,141712,256,131488,131488,141856,384,131568,131568,142000
.long 512,131648,131648,142144,640,131728,131728,142288,768,131808,131808,142432,896,131888,131888,142576
.long 1024,131968,131968,142720,1152,132048,132048,142864,1280,132128,132128,143008,1408,132208,132208,143152
.long 1536,132288,132288,143296,1664,132368,132368,143440,1792,132448,132448,143584,1920,132528,132528,143728
.long 16,131344,131344,141576,144,131424,131424,141720,272,131504,131504,141864,400,131584,131584,142008
.long 528,131664,131664,142152,656,131744,131744,142296,784,131824,131824,142440,912,131904,131904,142584
.long 1040,131984,131984,142728,1168,132064,132064,142872,1296,132144,132144,143016,1424,132224,132224,143160
.long 1552,132304,132304,143304,1680,132384,132384,143448,1808,132464,132464,143592,1936,132544,132544,143736
.long 32,131360,131360,141584,160,131440,131440,141728,288,131520,131520,141872,416,131600,131600,142016
.long 544,131680,131680,142160,672,131760,131760,142304,800,131840,131840,142448,928,131920,131920,142592
.long 1056,132000,132000,142736,1184,132080,132080,142880,1312,132160,132160,143024,1440,132240,132240,143168
.long 1568,132320,132320,143312,1696,132400,132400,143456,1824,132480,132480,143600,1952,132560,132560,143744
.long 48,131376,131376,141592,176,131456,131456,141736,304,131536,131536,141880,432,131616,131616,142024
.long 560,131696,131696,142168,688,131776,131776,142312,816,131856,131856,142456,944,131936,131936,142600
.long 1072,132016,132016,142744,1200,132096,132096,142888,1328,132176,132176,143032,1456,132256,132256,143176
.long 1584,132336,132336,143320,1712,132416,132416,143464,1840,132496,132496,143608,1968,132576,132576,143752
.long 141568,65536,65600,0,141712,65568,65632,0,141856,65544,65608,0,142000,65576,65640,0
.long 142144,65664,65728,0,142288,65696,65760,0,142432,65672,65736,0,142576,65704,65768,0
.long 142720,65856,65792,0,142864,65888,65824,0,143008,65864,65800,0,143152,65896,65832,0
.long 143296,65984,65920,0,143440,66016,65952,0,143584,65992,65928,0,143728,66024,65960,0
.long 141584,65552,65616,0,141728,65584,65648,0,141872,65560,65624,0,142016,65592,65656,0
.long 142160,65680,65744,0,142304,65712,65776,0,142448,65688,65752,0,142592,65720,65784,0
.long 142736,65872,65808,0,142880,65904,65840,0,143024,65880,65816,0,143168,65912,65848,0
.long 143312,66000,65936,0,143456,66032,65968,0,143600,66008,65944,0,143744,66040,65976,0
.long 141600,66048,66112,0,141744,66080,66144,0,141888,66056,66120,0,142032,66088,66152,0
.long 142176,66176,66240,0,142320,66208,66272,0,142464,66184,66248,0,142608,66216,66280,0
.long 142752,66368,66304,0,142896,66400,66336,0,143040,66376,66312,0,143184,66408,66344,0
.long 143328,66496,66432,0,143472,66528,66464,0,143616,66504,66440,0,143760,66536,66472,0
.long 141616,66064,66128,0,141760,66096,66160,0,141904,66072,66136,0,142048,66104,66168,0
.long 142192,66192,66256,0,142336,66224,66288,0,142480,66200,66264,0,142624,66232,66296,0
.long 142768,66384,66320,0,142912,66416,66352,0,143056,66392,66328,0,143200,66424,66360,0
.long 143344,66512,66448,0,143488,66544,66480,0,143632,66520,66456,0,143776,66552,66488,0
.long 1,131104,0,0,1,131108,1,0,1,131112,2,0,1,131116,3,0
.long 1,131104,4,0,1,131108,5,0,1,131112,6,0,1,131116,7,0
.long 1,131104,8,0,1,131108,9,0,1,131112,10,0,1,131116,11,0
.long 1,131104,12,0,1,131108,13,0,1,131112,14,0,1,131116,15,0
.long 1,131104,256,0,1,131108,257,0,1,131112,258,0,1,131116,259,0
.long 1,131104,260,0,1,131108,261,0,1,131112,262,0,1,131116,263,0
.long 1,131104,264,0,1,131108,265,0,1,131112,266,0,1,131116,267,0
.long 1,131104,268,0,1,131108,269,0,1,131112,270,0,1,131116,271,0
.long 1,131104,512,0,1,131108,513,0,1,131112,514,0,1,131116,515,0
.long 1,131104,516,0,1,131108,517,0,1,131112,518,0,1,131116,519,0
.long 1,131104,520,0,1,131108,521,0,1,131112,522,0,1,131116,523,0
.long 1,131104,524,0,1,131108,525,0,1,131112,526,0,1,131116,527,0
.long 1,131104,768,0,1,131108,769,0,1,131112,770,0,1,131116,771,0
.long 1,131104,772,0,1,131108,773,0,1,131112,774,0,1,131116,775,0
.long 1,131104,776,0,1,131108,777,0,1,131112,778,0,1,131116,779,0
.long 1,131104,780,0,1,131108,781,0,1,131112,782,0,1,131116,783,0
.long 0,49152,65536,0,16,49168,65544,32768,32,49184,65552,65536,48,49200,65560,98304
.long 64,49216,65664,524288,80,49232,65672,557056,96,49248,65680,589824,112,49264,65688,622592
.long 4096,49280,66112,131072,4112,49296,66120,163840,4128,49312,66128,196608,4144,49328,66136,229376
.long 4160,49344,66240,655360,4176,49360,66248,688128,4192,49376,66256,720896,4208,49392,66264,753664
.long 8192,49408,65568,262144,8208,49424,65576,294912,8224,49440,65584,327680,8240,49456,65592,360448
.long 8256,49472,65696,786432,8272,49488,65704,819200,8288,49504,65712,851968,8304,49520,65720,884736
.long 12288,49536,66144,393216,12304,49552,66152,425984,12320,49568,66160,458752,12336,49584,66168,491520
.long 12352,49600,66272,917504,12368,49616,66280,950272,12384,49632,66288,983040,12400,49648,66296,1015808
.long 16448,49664,67584,32,16464,49680,67592,32800,16480,49696,67600,65568,16496,49712,67608,98336
.long 16384,49728,67712,524320,16400,49744,67720,557088,16416,49760,67728,589856,16432,49776,67736,622624
.long 20544,49792,68160,131104,20560,49808,68168,163872,20576,49824,68176,196640,20592,49840,68184,229408
.long 20480,49856,68288,655392,20496,49872,68296,688160,20512,49888,68304,720928,20528,49904,68312,753696
.long 24640,49920,67616,262176,24656,49936,67624,294944,24672,49952,67632,327712,24688,49968,67640,360480
.long 24576,49984,67744,786464,24592,50000,67752,819232,24608,50016,67760,852000,24624,50032,67768,884768
.long 28736,50048,68192,393248,28752,50064,68200,426016,28768,50080,68208,458784,28784,50096,68216,491552
.long 28672,50112,68320,917536,28688,50128,68328,950304,28704,50144,68336,983072,28720,50160,68344,1015840
.long 0,0,131072,131080,4,16,131072,131080,8,32,131072,131080,12,48,131072,131080
.long 16,512,131072,131080,20,528,131072,131080,24,544,131072,131080,28,560,131072,131080
.long 32,1024,131072,131080,36,1040,131072,131080,40,1056,131072,131080,44,1072,131072,131080
.long 48,1536,131072,131080,52,1552,131072,131080,56,1568,131072,131080,60,1584,131072,131080
.long 64,2560,131072,131080,68,2576,131072,131080,72,2592,131072,131080,76,2608,131072,131080
.long 80,2048,131072,131080,84,2064,131072,131080,88,2080,131072,131080,92,2096,131072,131080
.long 96,3584,131072,131080,100,3600,131072,131080,104,3616,131072,131080,108,3632,131072,131080
.long 112,3072,131072,131080,116,3088,131072,131080,120,3104,131072,131080,124,3120,131072,131080
.long 0,4096,131072,131080,4,4112,131072,131080,8,4128,131072,131080,12,4144,131072,131080
.long 16,4608,131072,131080,20,4624,131072,131080,24,4640,131072,131080,28,4656,131072,131080
.long 32,5120,131072,131080,36,5136,131072,131080,40,5152,131072,131080,44,5168,131072,131080
.long 48,5632,131072,131080,52,5648,131072,131080,56,5664,131072,131080,60,5680,131072,131080
.long 64,6656,131072,131080,68,6672,131072,131080,72,6688,131072,131080,76,6704,131072,131080
.long 80,6144,131072,131080,84,6160,131072,131080,88,6176,131072,131080,92,6192,131072,131080
.long 96,7680,131072,131080,100,7696,131072,131080,104,7712,131072,131080,108,7728,131072,131080
.long 112,7168,131072,131080,116,7184,131072,131080,120,7200,131072,131080,124,7216,131072,131080
.long 0,131336,132608,141600,128,131416,132688,141744,256,131496,132768,141888,384,131576,132848,142032
.long 512,131656,132928,142176,640,131736,133008,142320,768,131816,133088,142464,896,131896,133168,142608
.long 1024,131976,133248,142752,1152,132056,133328,142896,1280,132136,133408,143040,1408,132216,133488,143184
.long 1536,132296,133568,143328,1664,132376,133648,143472,1792,132456,133728,143616,1920,132536,133808,143760
.long 16,131352,132624,141608,144,131432,132704,141752,272,131512,132784,141896,400,131592,132864,142040
.long 528,131672,132944,142184,656,131752,133024,142328,784,131832,133104,142472,912,131912,133184,142616
.long 1040,131992,133264,142760,1168,132072,133344,142904,1296,132152,133424,143048,1424,132232,133504,143192
.long 1552,132312,133584,143336,1680,132392,133664,143480,1808,132472,133744,143624,1936,132552,133824,143768
.long 32,131368,132640,141616,160,131448,132720,141760,288,131528,132800,141904,416,131608,132880,142048
.long 544,131688,132960,142192,672,131768,133040,142336,800,131848,133120,142480,928,131928,133200,142624
.long 1056,132008,133280,142768,1184,132088,133360,142912,1312,132168,133440,143056,1440,132248,133520,143200
.long 1568,132328,133600,143344,1696,132408,133680,143488,1824,132488,133760,143632,1952,132568,133840,143776
.long 48,131384,132656,141624,176,131464,132736,141768,304,131544,132816,141912,432,131624,132896,142056
.long 560,131704,132976,142200,688,131784,133056,142344,816,131864,133136,142488,944,131944,133216,142632
.long 1072,132024,133296,142776,1200,132104,133376,142920,1328,132184,133456,143064,1456,132264,133536,143208
.long 1584,132344,133616,143352,1712,132424,133696,143496,1840,132504,133776,143640,1968,132584,133856,143784
.long 143872,65536,65600,0,144016,65568,65632,0,144160,65544,65608,0,144304,65576,65640,0
.long 144448,65664,65728,0,144592,65696,65760,0,144736,65672,65736,0,144880,65704,65768,0
.long 145024,65856,65792,0,145168,65888,65824,0,145312,65864,65800,0,145456,65896,65832,0
.long 145600,65984,65920,0,145744,66016,65952,0,145888,65992,65928,0,146032,66024,65960,0
.long 143888,65552,65616,0,144032,65584,65648,0,144176,65560,65624,0,144320,65592,65656,0
.long 144464,65680,65744,0,144608,65712,65776,0,144752,65688,65752,0,144896,65720,65784,0
.long 145040,65872,65808,0,145184,65904,65840,0,145328,65880,65816,0,145472,65912,65848,0
.long 145616,66000,65936,0,145760,66032,65968,0,145904,66008,65944,0,146048,66040,65976,0
.long 143904,66048,66112,0,144048,66080,66144,0,144192,66056,66120,0,144336,66088,66152,0
.long 144480,66176,66240,0,144624,66208,66272,0,144768,66184,66248,0,144912,66216,66280,0
.long 145056,66368,66304,0,145200,66400,66336,0,145344,66376,66312,0,145488,66408,66344,0
.long 145632,66496,66432,0,145776,66528,66464,0,145920,66504,66440,0,146064,66536,66472,0
.long 143920,66064,66128,0,144064,66096,66160,0,144208,66072,66136,0,144352,66104,66168,0
.long 144496,66192,66256,0,144640,66224,66288,0,144784,66200,66264,0,144928,66232,66296,0
.long 145072,66384,66320,0,145216,66416,66352,0,145360,66392,66328,0,145504,66424,66360,0
.long 145648,66512,66448,0,145792,66544,66480,0,145936,66520,66456,0,146080,66552,66488,0
.long 1,131104,16,0,1,131108,17,0,1,131112,18,0,1,131116,19,0
.long 1,131104,20,0,1,131108,21,0,1,131112,22,0,1,131116,23,0
.long 1,131104,24,0,1,131108,25,0,1,131112,26,0,1,131116,27,0
.long 1,131104,28,0,1,131108,29,0,1,131112,30,0,1,131116,31,0
.long 1,131104,272,0,1,131108,273,0,1,131112,274,0,1,131116,275,0
.long 1,131104,276,0,1,131108,277,0,1,131112,278,0,1,131116,279,0
.long 1,131104,280,0,1,131108,281,0,1,131112,282,0,1,131116,283,0
.long 1,131104,284,0,1,131108,285,0,1,131112,286,0,1,131116,287,0
.long 1,131104,528,0,1,131108,529,0,1,131112,530,0,1,131116,531,0
.long 1,131104,532,0,1,131108,533,0,1,131112,534,0,1,131116,535,0
.long 1,131104,536,0,1,131108,537,0,1,131112,538,0,1,131116,539,0
.long 1,131104,540,0,1,131108,541,0,1,131112,542,0,1,131116,543,0
.long 1,131104,784,0,1,131108,785,0,1,131112,786,0,1,131116,787,0
.long 1,131104,788,0,1,131108,789,0,1,131112,790,0,1,131116,791,0
.long 1,131104,792,0,1,131108,793,0,1,131112,794,0,1,131116,795,0
.long 1,131104,796,0,1,131108,797,0,1,131112,798,0,1,131116,799,0
.long 0,53248,65600,0,16,53264,65608,32768,32,53280,65616,65536,48,53296,65624,98304
.long 64,53312,65728,524288,80,53328,65736,557056,96,53344,65744,589824,112,53360,65752,622592
.long 4096,53376,66048,131072,4112,53392,66056,163840,4128,53408,66064,196608,4144,53424,66072,229376
.long 4160,53440,66176,655360,4176,53456,66184,688128,4192,53472,66192,720896,4208,53488,66200,753664
.long 8192,53504,65632,262144,8208,53520,65640,294912,8224,53536,65648,327680,8240,53552,65656,360448
.long 8256,53568,65760,786432,8272,53584,65768,819200,8288,53600,65776,851968,8304,53616,65784,884736
.long 12288,53632,66080,393216,12304,53648,66088,425984,12320,53664,66096,458752,12336,53680,66104,491520
.long 12352,53696,66208,917504,12368,53712,66216,950272,12384,53728,66224,983040,12400,53744,66232,1015808
.long 16448,53760,67648,32,16464,53776,67656,32800,16480,53792,67664,65568,16496,53808,67672,98336
.long 16384,53824,67776,524320,16400,53840,67784,557088,16416,53856,67792,589856,16432,53872,67800,622624
.long 20544,53888,68096,131104,20560,53904,68104,163872,20576,53920,68112,196640,20592,53936,68120,229408
.long 20480,53952,68224,655392,20496,53968,68232,688160,20512,53984,68240,720928,20528,54000,68248,753696
.long 24640,54016,67680,262176,24656,54032,67688,294944,24672,54048,67696,327712,24688,54064,67704,360480
.long 24576,54080,67808,786464,24592,54096,67816,819232,24608,54112,67824,852000,24624,54128,67832,884768
.long 28736,54144,68128,393248,28752,54160,68136,426016,28768,54176,68144,458784,28784,54192,68152,491552
.long 28672,54208,68256,917536,28688,54224,68264,950304,28704,54240,68272,983072,28720,54256,68280,1015840
.long 0,0,131076,131084,4,16,131076,131084,8,32,131076,131084,12,48,131076,131084
.long 16,512,131076,131084,20,528,131076,131084,24,544,131076,131084,28,560,131076,131084
.long 32,1024,131076,131084,36,1040,131076,131084,40,1056,131076,131084,44,1072,131076,131084
.long 48,1536,131076,131084,52,1552,131076,131084,56,1568,131076,131084,60,1584,131076,131084
.long 64,2560,131076,131084,68,2576,131076,131084,72,2592,131076,131084,76,2608,131076,131084
.long 80,2048,131076,131084,84,2064,131076,131084,88,2080,131076,131084,92,2096,131076,131084
.long 96,3584,131076,131084,100,3600,131076,131084,104,3616,131076,131084,108,3632,131076,131084
.long 112,3072,131076,131084,116,3088,131076,131084,120,3104,131076,131084,124,3120,131076,131084
.long 0,4096,131076,131084,4,4112,131076,131084,8,4128,131076,131084,12,4144,131076,131084
.long 16,4608,131076,131084,20,4624,131076,131084,24,4640,131076,131084,28,4656,131076,131084
.long 32,5120,131076,131084,36,5136,131076,131084,40,5152,131076,131084,44,5168,131076,131084
.long 48,5632,131076,131084,52,5648,131076,131084,56,5664,131076,131084,60,5680,131076,131084
.long 64,6656,131076,131084,68,6672,131076,131084,72,6688,131076,131084,76,6704,131076,131084
.long 80,6144,131076,131084,84,6160,131076,131084,88,6176,131076,131084,92,6192,131076,131084
.long 96,7680,131076,131084,100,7696,131076,131084,104,7712,131076,131084,108,7728,131076,131084
.long 112,7168,131076,131084,116,7184,131076,131084,120,7200,131076,131084,124,7216,131076,131084
.long 0,133888,133888,141632,128,133968,133968,141776,256,134048,134048,141920,384,134128,134128,142064
.long 512,134208,134208,142208,640,134288,134288,142352,768,134368,134368,142496,896,134448,134448,142640
.long 1024,134528,134528,142784,1152,134608,134608,142928,1280,134688,134688,143072,1408,134768,134768,143216
.long 1536,134848,134848,143360,1664,134928,134928,143504,1792,135008,135008,143648,1920,135088,135088,143792
.long 16,133904,133904,141640,144,133984,133984,141784,272,134064,134064,141928,400,134144,134144,142072
.long 528,134224,134224,142216,656,134304,134304,142360,784,134384,134384,142504,912,134464,134464,142648
.long 1040,134544,134544,142792,1168,134624,134624,142936,1296,134704,134704,143080,1424,134784,134784,143224
.long 1552,134864,134864,143368,1680,134944,134944,143512,1808,135024,135024,143656,1936,135104,135104,143800
.long 32,133920,133920,141648,160,134000,134000,141792,288,134080,134080,141936,416,134160,134160,142080
.long 544,134240,134240,142224,672,134320,134320,142368,800,134400,134400,142512,928,134480,134480,142656
.long 1056,134560,134560,142800,1184,134640,134640,142944,1312,134720,134720,143088,1440,134800,134800,143232
.long 1568,134880,134880,143376,1696,134960,134960,143520,1824,135040,135040,143664,1952,135120,135120,143808
.long 48,133936,133936,141656,176,134016,134016,141800,304,134096,134096,141944,432,134176,134176,142088
.long 560,134256,134256,142232,688,134336,134336,142376,816,134416,134416,142520,944,134496,134496,142664
.long 1072,134576,134576,142808,1200,134656,134656,142952,1328,134736,134736,143096,1456,134816,134816,143240
.long 1584,134896,134896,143384,1712,134976,134976,143528,1840,135056,135056,143672,1968,135136,135136,143816
.long 141568,98368,98304,0,141712,98400,98336,0,141856,98376,98312,0,142000,98408,98344,0
.long 142144,98496,98432,0,142288,98528,98464,0,142432,98504,98440,0,142576,98536,98472,0
.long 142720,98560,98624,0,142864,98592,98656,0,143008,98568,98632,0,143152,98600,98664,0
.long 143296,98688,98752,0,143440,98720,98784,0,143584,98696,98760,0,143728,98728,98792,0
.long 141584,98384,98320,0,141728,98416,98352,0,141872,98392,98328,0,142016,98424,98360,0
.long 142160,98512,98448,0,142304,98544,98480,0,142448,98520,98456,0,142592,98552,98488,0
.long 142736,98576,98640,0,142880,98608,98672,0,143024,98584,98648,0,143168,98616,98680,0
.long 143312,98704,98768,0,143456,98736,98800,0,143600,98712,98776,0,143744,98744,98808,0
.long 141600,98880,98816,0,141744,98912,98848,0,141888,98888,98824,0,142032,98920,98856,0
.long 142176,99008,98944,0,142320,99040,98976,0,142464,99016,98952,0,142608,99048,98984,0
.long 142752,99072,99136,0,142896,99104,99168,0,143040,99080,99144,0,143184,99112,99176,0
.long 143328,99200,99264,0,143472,99232,99296,0,143616,99208,99272,0,143760,99240,99304,0
.long 141616,98896,98832,0,141760,98928,98864,0,141904,98904,98840,0,142048,98936,98872,0
.long 142192,99024,98960,0,142336,99056,98992,0,142480,99032,98968,0,142624,99064,99000,0
.long 142768,99088,99152,0,142912,99120,99184,0,143056,99096,99160,0,143200,99128,99192,0
.long 143344,99216,99280,0,143488,99248,99312,0,143632,99224,99288,0,143776,99256,99320,0
.long 1,131104,32,0,1,131108,33,0,1,131112,34,0,1,131116,35,0
.long 1,131104,36,0,1,131108,37,0,1,131112,38,0,1,131116,39,0
.long 1,131104,40,0,1,131108,41,0,1,131112,42,0,1,131116,43,0
.long 1,131104,44,0,1,131108,45,0,1,131112,46,0,1,131116,47,0
.long 1,131104,288,0,1,131108,289,0,1,131112,290,0,1,131116,291,0
.long 1,131104,292,0,1,131108,293,0,1,131112,294,0,1,131116,295,0
.long 1,131104,296,0,1,131108,297,0,1,131112,298,0,1,131116,299,0
.long 1,131104,300,0,1,131108,301,0,1,131112,302,0,1,131116,303,0
.long 1,131104,544,0,1,131108,545,0,1,131112,546,0,1,131116,547,0
.long 1,131104,548,0,1,131108,549,0,1,131112,550,0,1,131116,551,0
.long 1,131104,552,0,1,131108,553,0,1,131112,554,0,1,131116,555,0
.long 1,131104,556,0,1,131108,557,0,1,131112,558,0,1,131116,559,0
.long 1,131104,800,0,1,131108,801,0,1,131112,802,0,1,131116,803,0
.long 1,131104,804,0,1,131108,805,0,1,131112,806,0,1,131116,807,0
.long 1,131104,808,0,1,131108,809,0,1,131112,810,0,1,131116,811,0
.long 1,131104,812,0,1,131108,813,0,1,131112,814,0,1,131116,815,0
.long 0,57344,65792,0,16,57360,65800,32768,32,57376,65808,65536,48,57392,65816,98304
.long 64,57408,65920,524288,80,57424,65928,557056,96,57440,65936,589824,112,57456,65944,622592
.long 4096,57472,66368,131072,4112,57488,66376,163840,4128,57504,66384,196608,4144,57520,66392,229376
.long 4160,57536,66496,655360,4176,57552,66504,688128,4192,57568,66512,720896,4208,57584,66520,753664
.long 8192,57600,65824,262144,8208,57616,65832,294912,8224,57632,65840,327680,8240,57648,65848,360448
.long 8256,57664,65952,786432,8272,57680,65960,819200,8288,57696,65968,851968,8304,57712,65976,884736
.long 12288,57728,66400,393216,12304,57744,66408,425984,12320,57760,66416,458752,12336,57776,66424,491520
.long 12352,57792,66528,917504,12368,57808,66536,950272,12384,57824,66544,983040,12400,57840,66552,1015808
.long 16448,57856,67840,32,16464,57872,67848,32800,16480,57888,67856,65568,16496,57904,67864,98336
.long 16384,57920,67968,524320,16400,57936,67976,557088,16416,57952,67984,589856,16432,57968,67992,622624
.long 20544,57984,68416,131104,20560,58000,68424,163872,20576,58016,68432,196640,20592,58032,68440,229408
.long 20480,58048,68544,655392,20496,58064,68552,688160,20512,58080,68560,720928,20528,58096,68568,753696
.long 24640,58112,67872,262176,24656,58128,67880,294944,24672,58144,67888,327712,24688,58160,67896,360480
.long 24576,58176,68000,786464,24592,58192,68008,819232,24608,58208,68016,852000,24624,58224,68024,884768
.long 28736,58240,68448,393248,28752,58256,68456,426016,28768,58272,68464,458784,28784,58288,68472,491552
.long 28672,58304,68576,917536,28688,58320,68584,950304,28704,58336,68592,983072,28720,58352,68600,1015840
.long 0,0,131080,131072,4,16,131080,131072,8,32,131080,131072,12,48,131080,131072
.long 16,512,131080,131072,20,528,131080,131072,24,544,131080,131072,28,560,131080,131072
.long 32,1024,131080,131072,36,1040,131080,131072,40,1056,131080,131072,44,1072,131080,131072
.long 48,1536,131080,131072,52,1552,131080,131072,56,1568,131080,131072,60,1584,131080,131072
.long 64,2560,131080,131072,68,2576,131080,131072,72,2592,131080,131072,76,2608,131080,131072
.long 80,2048,131080,131072,84,2064,131080,131072,88,2080,131080,131072,92,2096,131080,131072
.long 96,3584,131080,131072,100,3600,131080,131072,104,3616,131080,131072,108,3632,131080,131072
.long 112,3072,131080,131072,116,3088,131080,131072,120,3104,131080,131072,124,3120,131080,131072
.long 0,4096,131080,131072,4,4112,131080,131072,8,4128,131080,131072,12,4144,131080,131072
.long 16,4608,131080,131072,20,4624,131080,131072,24,4640,131080,131072,28,4656,131080,131072
.long 32,5120,131080,131072,36,5136,131080,131072,40,5152,131080,131072,44,5168,131080,131072
.long 48,5632,131080,131072,52,5648,131080,131072,56,5664,131080,131072,60,5680,131080,131072
.long 64,6656,131080,131072,68,6672,131080,131072,72,6688,131080,131072,76,6704,131080,131072
.long 80,6144,131080,131072,84,6160,131080,131072,88,6176,131080,131072,92,6192,131080,131072
.long 96,7680,131080,131072,100,7696,131080,131072,104,7712,131080,131072,108,7728,131080,131072
.long 112,7168,131080,131072,116,7184,131080,131072,120,7200,131080,131072,124,7216,131080,131072
.long 0,133896,135168,141664,128,133976,135248,141808,256,134056,135328,141952,384,134136,135408,142096
.long 512,134216,135488,142240,640,134296,135568,142384,768,134376,135648,142528,896,134456,135728,142672
.long 1024,134536,135808,142816,1152,134616,135888,142960,1280,134696,135968,143104,1408,134776,136048,143248
.long 1536,134856,136128,143392,1664,134936,136208,143536,1792,135016,136288,143680,1920,135096,136368,143824
.long 16,133912,135184,141672,144,133992,135264,141816,272,134072,135344,141960,400,134152,135424,142104
.long 528,134232,135504,142248,656,134312,135584,142392,784,134392,135664,142536,912,134472,135744,142680
.long 1040,134552,135824,142824,1168,134632,135904,142968,1296,134712,135984,143112,1424,134792,136064,143256
.long 1552,134872,136144,143400,1680,134952,136224,143544,1808,135032,136304,143688,1936,135112,136384,143832
.long 32,133928,135200,141680,160,134008,135280,141824,288,134088,135360,141968,416,134168,135440,142112
.long 544,134248,135520,142256,672,134328,135600,142400,800,134408,135680,142544,928,134488,135760,142688
.long 1056,134568,135840,142832,1184,134648,135920,142976,1312,134728,136000,143120,1440,134808,136080,143264
.long 1568,134888,136160,143408,1696,134968,136240,143552,1824,135048,136320,143696,1952,135128,136400,143840
.long 48,133944,135216,141688,176,134024,135296,141832,304,134104,135376,141976,432,134184,135456,142120
.long 560,134264,135536,142264,688,134344,135616,142408,816,134424,135696,142552,944,134504,135776,142696
.long 1072,134584,135856,142840,1200,134664,135936,142984,1328,134744,136016,143128,1456,134824,136096,143272
.long 1584,134904,136176,143416,1712,134984,136256,143560,1840,135064,136336,143704,1968,135144,136416,143848
.long 143872,98368,98304,0,144016,98400,98336,0,144160,98376,98312,0,144304,98408,98344,0
.long 144448,98496,98432,0,144592,98528,98464,0,144736,98504,98440,0,144880,98536,98472,0
.long 145024,98560,98624,0,145168,98592,98656,0,145312,98568,98632,0,145456,98600,98664,0
.long 145600,98688,98752,0,145744,98720,98784,0,145888,98696,98760,0,146032,98728,98792,0
.long 143888,98384,98320,0,144032,98416,98352,0,144176,98392,98328,0,144320,98424,98360,0
.long 144464,98512,98448,0,144608,98544,98480,0,144752,98520,98456,0,144896,98552,98488,0
.long 145040,98576,98640,0,145184,98608,98672,0,145328,98584,98648,0,145472,98616,98680,0
.long 145616,98704,98768,0,145760,98736,98800,0,145904,98712,98776,0,146048,98744,98808,0
.long 143904,98880,98816,0,144048,98912,98848,0,144192,98888,98824,0,144336,98920,98856,0
.long 144480,99008,98944,0,144624,99040,98976,0,144768,99016,98952,0,144912,99048,98984,0
.long 145056,99072,99136,0,145200,99104,99168,0,145344,99080,99144,0,145488,99112,99176,0
.long 145632,99200,99264,0,145776,99232,99296,0,145920,99208,99272,0,146064,99240,99304,0
.long 143920,98896,98832,0,144064,98928,98864,0,144208,98904,98840,0,144352,98936,98872,0
.long 144496,99024,98960,0,144640,99056,98992,0,144784,99032,98968,0,144928,99064,99000,0
.long 145072,99088,99152,0,145216,99120,99184,0,145360,99096,99160,0,145504,99128,99192,0
.long 145648,99216,99280,0,145792,99248,99312,0,145936,99224,99288,0,146080,99256,99320,0
.long 1,131104,48,0,1,131108,49,0,1,131112,50,0,1,131116,51,0
.long 1,131104,52,0,1,131108,53,0,1,131112,54,0,1,131116,55,0
.long 1,131104,56,0,1,131108,57,0,1,131112,58,0,1,131116,59,0
.long 1,131104,60,0,1,131108,61,0,1,131112,62,0,1,131116,63,0
.long 1,131104,304,0,1,131108,305,0,1,131112,306,0,1,131116,307,0
.long 1,131104,308,0,1,131108,309,0,1,131112,310,0,1,131116,311,0
.long 1,131104,312,0,1,131108,313,0,1,131112,314,0,1,131116,315,0
.long 1,131104,316,0,1,131108,317,0,1,131112,318,0,1,131116,319,0
.long 1,131104,560,0,1,131108,561,0,1,131112,562,0,1,131116,563,0
.long 1,131104,564,0,1,131108,565,0,1,131112,566,0,1,131116,567,0
.long 1,131104,568,0,1,131108,569,0,1,131112,570,0,1,131116,571,0
.long 1,131104,572,0,1,131108,573,0,1,131112,574,0,1,131116,575,0
.long 1,131104,816,0,1,131108,817,0,1,131112,818,0,1,131116,819,0
.long 1,131104,820,0,1,131108,821,0,1,131112,822,0,1,131116,823,0
.long 1,131104,824,0,1,131108,825,0,1,131112,826,0,1,131116,827,0
.long 1,131104,828,0,1,131108,829,0,1,131112,830,0,1,131116,831,0
.long 0,61440,65856,0,16,61456,65864,32768,32,61472,65872,65536,48,61488,65880,98304
.long 64,61504,65984,524288,80,61520,65992,557056,96,61536,66000,589824,112,61552,66008,622592
.long 4096,61568,66304,131072,4112,61584,66312,163840,4128,61600,66320,196608,4144,61616,66328,229376
.long 4160,61632,66432,655360,4176,61648,66440,688128,4192,61664,66448,720896,4208,61680,66456,753664
.long 8192,61696,65888,262144,8208,61712,65896,294912,8224,61728,65904,327680,8240,61744,65912,360448
.long 8256,61760,66016,786432,8272,61776,66024,819200,8288,61792,66032,851968,8304,61808,66040,884736
.long 12288,61824,66336,393216,12304,61840,66344,425984,12320,61856,66352,458752,12336,61872,66360,491520
.long 12352,61888,66464,917504,12368,61904,66472,950272,12384,61920,66480,983040,12400,61936,66488,1015808
.long 16448,61952,67904,32,16464,61968,67912,32800,16480,61984,67920,65568,16496,62000,67928,98336
.long 16384,62016,68032,524320,16400,62032,68040,557088,16416,62048,68048,589856,16432,62064,68056,622624
.long 20544,62080,68352,131104,20560,62096,68360,163872,20576,62112,68368,196640,20592,62128,68376,229408
.long 20480,62144,68480,655392,20496,62160,68488,688160,20512,62176,68496,720928,20528,62192,68504,753696
.long 24640,62208,67936,262176,24656,62224,67944,294944,24672,62240,67952,327712,24688,62256,67960,360480
.long 24576,62272,68064,786464,24592,62288,68072,819232,24608,62304,68080,852000,24624,62320,68088,884768
.long 28736,62336,68384,393248,28752,62352,68392,426016,28768,62368,68400,458784,28784,62384,68408,491552
.long 28672,62400,68512,917536,28688,62416,68520,950304,28704,62432,68528,983072,28720,62448,68536,1015840
.long 0,0,131084,131076,4,16,131084,131076,8,32,131084,131076,12,48,131084,131076
.long 16,512,131084,131076,20,528,131084,131076,24,544,131084,131076,28,560,131084,131076
.long 32,1024,131084,131076,36,1040,131084,131076,40,1056,131084,131076,44,1072,131084,131076
.long 48,1536,131084,131076,52,1552,131084,131076,56,1568,131084,131076,60,1584,131084,131076
.long 64,2560,131084,131076,68,2576,131084,131076,72,2592,131084,131076,76,2608,131084,131076
.long 80,2048,131084,131076,84,2064,131084,131076,88,2080,131084,131076,92,2096,131084,131076
.long 96,3584,131084,131076,100,3600,131084,131076,104,3616,131084,131076,108,3632,131084,131076
.long 112,3072,131084,131076,116,3088,131084,131076,120,3104,131084,131076,124,3120,131084,131076
.long 0,4096,131084,131076,4,4112,131084,131076,8,4128,131084,131076,12,4144,131084,131076
.long 16,4608,131084,131076,20,4624,131084,131076,24,4640,131084,131076,28,4656,131084,131076
.long 32,5120,131084,131076,36,5136,131084,131076,40,5152,131084,131076,44,5168,131084,131076
.long 48,5632,131084,131076,52,5648,131084,131076,56,5664,131084,131076,60,5680,131084,131076
.long 64,6656,131084,131076,68,6672,131084,131076,72,6688,131084,131076,76,6704,131084,131076
.long 80,6144,131084,131076,84,6160,131084,131076,88,6176,131084,131076,92,6192,131084,131076
.long 96,7680,131084,131076,100,7696,131084,131076,104,7712,131084,131076,108,7728,131084,131076
.long 112,7168,131084,131076,116,7184,131084,131076,120,7200,131084,131076,124,7216,131084,131076
.set C512, 16128
.set C513, 48896
.set C514, 48896
.set C515, 16128
.macro G8 d, f0
EC %(((\f0+0)*\d+0)&511)
EC %(((\f0 + ((\f0 == 0) & 256))*\d + (128 & (\f0 != 0)))&511)
EC %(((\f0+2)*\d+0)&511)
EC %(((\f0+2)*\d+128)&511)
EC %(((\f0+4)*\d+0)&511)
EC %(((\f0+4)*\d+128)&511)
EC %(((((\f0+6)*\d+0)&511) & (\f0 != 250)) + ((512 + ((\d+0)&3)) & (\f0 == 250)))
EC %(((((\f0+6)*\d+128)&511) & (\f0 != 250)) + ((512 + ((\d+1)&3)) & (\f0 == 250)))
.endm
.p2align 8
TAB_FINV:
.set tI, 0
.rept 16384
  .set tL, tI & 63
  .set tD, ((tI >> 11) << 5) + (((tL >> 2) & 1) << 4) + (((tL >> 3) & 3) << 2) + (tL & 3)
  .set tJ, (tI >> 7) & 15
  .set tM, (tI >> 6) & 1
  .set tF, ((tL >> 5) << 3) + (tM ^ (tJ & 1)) + ((tJ >> 1) << 4) + ((241 - ((tJ >> 1) << 5)) & (0 - (tJ & 1)))
  G8 %tD, %tF
  .set tI, tI + 1
.endr
```
